```python
import torch

def _softmax(x, axis=-1):
    return torch.softmax(x, dim=axis)

def _gelu(x):
    return torch.nn.functional.gelu(x, approximate='tanh')

def _silu(x):
    return torch.nn.functional.silu(x)

def _sigmoid(x):
    return torch.sigmoid(x)

def _layernorm(x, axis=-1, eps=1e-05):
    m = x.mean(dim=axis, keepdim=True)
    v = x.var(dim=axis, keepdim=True, unbiased=False)
    return (x - m) / torch.sqrt(v + eps)

def _scatter_add(tgt, idx, src, axis=0):
    return tgt.clone().index_add_(axis, idx, src)

def _segment_sum(src, seg, n):
    out = torch.zeros((n,) + src.shape[1:], dtype=src.dtype)
    return out.index_add_(0, seg, src)

def _pad(x, pw):
    flat = tuple((v for pair in reversed(pw) for v in pair))
    return torch.nn.functional.pad(x, flat)
kernel_name = 'adaLN_cond__grouped_kv_mqa__dense_activation_relu__prompt'

def setup_inputs():

    _w = lambda a: (lambda t: t.to(torch.bfloat16) if t.is_floating_point() else t)(torch.as_tensor(a))

    def _A_setup():
        B, S, D, H = (1, 2048, 576, 32)
        Dh = D // H
        return {'x': _w((lambda *s: torch.randn(*s, dtype=torch.bfloat16) * 0.05)(B, S, D)), 'wq': _w((lambda *s: torch.randn(*s, dtype=torch.bfloat16) * 0.05)(D, H * Dh)), 'wk': _w((lambda *s: torch.randn(*s, dtype=torch.bfloat16) * 0.05)(D, Dh)), 'wv': _w((lambda *s: torch.randn(*s, dtype=torch.bfloat16) * 0.05)(D, Dh)), 'wo': _w((lambda *s: torch.randn(*s, dtype=torch.bfloat16) * 0.05)(H * Dh, D))}
    _A_in = _A_setup()

    def _B_setup():
        B, S, D, Dff = (1, 2048, 576, 4608)
        return {'x': _w((lambda *s: torch.randn(*s, dtype=torch.bfloat16) * 0.05)(B, S, D)), 'w1': _w((lambda *s: torch.randn(*s, dtype=torch.bfloat16) * 0.05)(D, Dff)), 'w2': _w((lambda *s: torch.randn(*s, dtype=torch.bfloat16) * 0.05)(Dff, D))}
    _B_in = _B_setup()
    return {'A_x': _A_in['x'], 'A_wq': _A_in['wq'], 'A_wk': _A_in['wk'], 'A_wv': _A_in['wv'], 'A_wo': _A_in['wo'], 'B_x': _B_in['x'], 'B_w1': _B_in['w1'], 'B_w2': _B_in['w2'], 'c': _w((lambda *s: torch.randn(*s, dtype=torch.bfloat16) * 0.1)(1, 576) * 8.0), 'w_mod': _w((lambda *s: torch.randn(*s, dtype=torch.bfloat16) * 0.1)(576, 6 * 576) * 576 ** (-0.5) * 8.0)}

def reference(A_x, A_wq, A_wk, A_wv, A_wo, B_x, B_w1, B_w2, c, w_mod):

    def _A_ref(x, wq, wk, wv, wo):
        B, S, D = x.shape
        H = 32
        Dh = D // H
        q = (lambda x, *d: x.permute(*d))((x @ wq).reshape(B, S, H, Dh), 0, 2, 1, 3)
        k = x @ wk
        v = x @ wv
        scores = torch.einsum('bhqd,bkd->bhqk', q, k) * Dh ** (-0.5)
        p = _softmax(scores, axis=-1)
        o = torch.einsum('bhqk,bkd->bhqd', p, v)
        return (lambda x, *d: x.permute(*d))(o, 0, 2, 1, 3).reshape(B, S, H * Dh) @ wo

    def _B_ref(x, w1, w2):
        h = torch.einsum('bsd,df->bsf', x, w1)
        zero = torch.zeros_like(h)
        h = torch.maximum(h, zero)
        return torch.einsum('bsf,fd->bsd', h, w2)
    x = A_x
    mod = (_silu(c) @ w_mod).reshape(c.shape[0], 6, 1, -1)
    sa, ca, ga, sb, cb, gb = (mod[:, 0].clone(), mod[:, 1].clone(), mod[:, 2].clone(), mod[:, 3].clone(), mod[:, 4].clone(), mod[:, 5].clone())
    h = _layernorm(x, axis=-1) * (1 + ca) + sa
    x = x + ga * _A_ref(h, A_wq, A_wk, A_wv, A_wo)
    h = _layernorm(x, axis=-1) * (1 + cb) + sb
    x = x + gb * _B_ref(h, B_w1, B_w2)
    return x
```

```asm
; @launch kernel=k3_kernel grid=(256,1,1) block=(768,1,1) lds=160512
; @launch kernel=k8_kernel grid=(256,1,1) block=(256,1,1) lds=149760
.amdgcn_target "amdgcn-amd-amdhsa--gfx950"
.text
.globl k3_kernel
.p2align 8
.type k3_kernel,@function
k3_kernel:
    s_cmp_ge_u32 s2, 256
    s_cbranch_scc1 k3_end
    s_load_dwordx4 s[52:55], s[0:1], 0
    s_load_dwordx4 s[60:63], s[0:1], 64
    s_load_dwordx4 s[56:59], s[0:1], 16
    s_load_dwordx2 s[16:17], s[0:1], 96
    s_load_dwordx2 s[50:51], s[0:1], 88
    s_load_dwordx2 s[4:5], s[0:1], 32
    s_load_dwordx4 s[8:11], s[0:1], 48
    v_lshrrev_b32 v1, 6, v0
    v_and_b32 v2, 63, v0
    v_readfirstlane_b32 s18, v1
    v_lshlrev_b32 v3, 4, v2
    s_and_b32 s19, s2, 7
    s_lshl_b32 s14, s19, 5
    s_lshl_b32 s19, s19, 3
    s_lshr_b32 s20, s2, 5
    s_add_u32 s19, s19, s20
    s_lshr_b32 s20, s2, 3
    s_add_u32 s14, s14, s20
    s_and_b32 s20, s20, 3
    v_and_b32 v6, 31, v2
    v_lshrrev_b32 v7, 5, v2
    s_cmp_ge_u32 s18, 8
    s_cbranch_scc1 k3_w8
    v_lshrrev_b32 v61, 4, v0
    v_and_b32 v62, 15, v0
    v_mul_u32_u24 v63, 1152, v61
    v_lshl_add_u32 v63, v62, 3, v63
    s_mul_i32 s24, s19, 36864
    s_memrealtime s[22:23]
    s_add_u32 s3, s2, s18
    s_cmp_lg_u32 s3, 0
    s_waitcnt lgkmcnt(0)
    s_cbranch_scc1 k3_notok
    s_mov_b32 s40, s50
    s_mov_b32 s41, s51
    s_mov_b32 s42, 256
    s_mov_b32 s43, 0x00020000
    s_or_b32 s22, s22, 1
    v_mov_b32 v4, s22
    v_lshlrev_b32 v5, 2, v2
    buffer_store_dword v4, v5, s[40:43], 0 offen sc1
k3_notok:
    s_mov_b32 s32, s52
    s_mov_b32 s33, s53
    s_mov_b32 s34, 2359296
    s_mov_b32 s35, 0x00020000
    s_cmp_lt_u32 s20, 2
    s_cbranch_scc1 k3_eb0
    s_barrier
k3_eb0:
    buffer_load_dwordx2 v[8:9], v63, s[32:35], s24 offen offset:0
    buffer_load_dwordx2 v[10:11], v63, s[32:35], s24 offen offset:128
    buffer_load_dwordx2 v[12:13], v63, s[32:35], s24 offen offset:256
    buffer_load_dwordx2 v[14:15], v63, s[32:35], s24 offen offset:384
    buffer_load_dwordx2 v[16:17], v63, s[32:35], s24 offen offset:512
    buffer_load_dwordx2 v[18:19], v63, s[32:35], s24 offen offset:640
    buffer_load_dwordx2 v[20:21], v63, s[32:35], s24 offen offset:768
    buffer_load_dwordx2 v[22:23], v63, s[32:35], s24 offen offset:896
    buffer_load_dwordx2 v[24:25], v63, s[32:35], s24 offen offset:1024
    s_mov_b32 s13, 0
    s_cmp_ge_u32 s20, 2
    s_cbranch_scc1 k3_nog
    s_cmp_ge_u32 s18, 6
    s_cbranch_scc1 k3_nog
    s_mov_b32 s13, 1
    s_mov_b32 s26, 20736
    s_mov_b32 s27, 0x00020000
    s_cmp_eq_u32 s20, 1
    s_cbranch_scc1 k3_gv
    v_and_b32 v5, 19, v6
    v_and_b32 v4, 4, v6
    v_lshl_or_b32 v5, v4, 1, v5
    v_and_b32 v4, 8, v6
    v_lshrrev_b32 v4, 1, v4
    v_or_b32 v5, v5, v4
    v_and_b32 v4, 17, v5
    v_cmp_gt_u32 vcc, 16, v5
    s_mov_b32 s24, s56
    s_mov_b32 s25, s57
    v_cndmask_b32 v4, v4, v5, vcc
    s_branch k3_gg
k3_gv:
    v_mov_b32 v26, 0x9ac18820
    v_mov_b32 v27, 0x0400117b
    v_mov_b32 v28, 0xcc522d49
    v_mov_b32 v29, 0x00000081
    v_cmp_le_u32 vcc, 12, v6
    v_subrev_u32 v4, 12, v6
    v_min_u32 v4, 11, v4
    v_cndmask_b32 v4, v6, v4, vcc
    v_cndmask_b32 v26, v26, v28, vcc
    v_cndmask_b32 v27, v27, v29, vcc
    v_mul_u32_u24 v4, 5, v4
    v_lshrrev_b64 v[26:27], v4, v[26:27]
    v_and_b32 v4, 31, v26
    s_mov_b32 s24, s58
    s_mov_b32 s25, s59
k3_gg:
    v_mul_u32_u24 v5, 288, v7
    v_lshl_add_u32 v5, v4, 1, v5
    s_mul_i32 s23, s18, 3456
    buffer_load_ushort v100, v5, s[24:27], s23 offen offset:0
    buffer_load_ushort v101, v5, s[24:27], s23 offen offset:36
    buffer_load_ushort v102, v5, s[24:27], s23 offen offset:72
    buffer_load_ushort v103, v5, s[24:27], s23 offen offset:108
    buffer_load_ushort v104, v5, s[24:27], s23 offen offset:144
    buffer_load_ushort v105, v5, s[24:27], s23 offen offset:180
    buffer_load_ushort v106, v5, s[24:27], s23 offen offset:216
    buffer_load_ushort v107, v5, s[24:27], s23 offen offset:252
    buffer_load_ushort v108, v5, s[24:27], s23 offen offset:576
    buffer_load_ushort v109, v5, s[24:27], s23 offen offset:612
    buffer_load_ushort v110, v5, s[24:27], s23 offen offset:648
    buffer_load_ushort v111, v5, s[24:27], s23 offen offset:684
    buffer_load_ushort v112, v5, s[24:27], s23 offen offset:720
    buffer_load_ushort v113, v5, s[24:27], s23 offen offset:756
    buffer_load_ushort v114, v5, s[24:27], s23 offen offset:792
    buffer_load_ushort v115, v5, s[24:27], s23 offen offset:828
    buffer_load_ushort v116, v5, s[24:27], s23 offen offset:1152
    buffer_load_ushort v117, v5, s[24:27], s23 offen offset:1188
    buffer_load_ushort v118, v5, s[24:27], s23 offen offset:1224
    buffer_load_ushort v119, v5, s[24:27], s23 offen offset:1260
    buffer_load_ushort v120, v5, s[24:27], s23 offen offset:1296
    buffer_load_ushort v121, v5, s[24:27], s23 offen offset:1332
    buffer_load_ushort v122, v5, s[24:27], s23 offen offset:1368
    buffer_load_ushort v123, v5, s[24:27], s23 offen offset:1404
    buffer_load_ushort v124, v5, s[24:27], s23 offen offset:1728
    buffer_load_ushort v125, v5, s[24:27], s23 offen offset:1764
    buffer_load_ushort v126, v5, s[24:27], s23 offen offset:1800
    buffer_load_ushort v127, v5, s[24:27], s23 offen offset:1836
    buffer_load_ushort v128, v5, s[24:27], s23 offen offset:1872
    buffer_load_ushort v129, v5, s[24:27], s23 offen offset:1908
    buffer_load_ushort v130, v5, s[24:27], s23 offen offset:1944
    buffer_load_ushort v131, v5, s[24:27], s23 offen offset:1980
    buffer_load_ushort v132, v5, s[24:27], s23 offen offset:2304
    buffer_load_ushort v133, v5, s[24:27], s23 offen offset:2340
    buffer_load_ushort v134, v5, s[24:27], s23 offen offset:2376
    buffer_load_ushort v135, v5, s[24:27], s23 offen offset:2412
    buffer_load_ushort v136, v5, s[24:27], s23 offen offset:2448
    buffer_load_ushort v137, v5, s[24:27], s23 offen offset:2484
    buffer_load_ushort v138, v5, s[24:27], s23 offen offset:2520
    buffer_load_ushort v139, v5, s[24:27], s23 offen offset:2556
    buffer_load_ushort v140, v5, s[24:27], s23 offen offset:2880
    buffer_load_ushort v141, v5, s[24:27], s23 offen offset:2916
    buffer_load_ushort v142, v5, s[24:27], s23 offen offset:2952
    buffer_load_ushort v143, v5, s[24:27], s23 offen offset:2988
    buffer_load_ushort v144, v5, s[24:27], s23 offen offset:3024
    buffer_load_ushort v145, v5, s[24:27], s23 offen offset:3060
    buffer_load_ushort v146, v5, s[24:27], s23 offen offset:3096
    buffer_load_ushort v147, v5, s[24:27], s23 offen offset:3132
    s_waitcnt vmcnt(48)
    s_branch k3_ln
k3_nog:
    s_waitcnt vmcnt(0)
k3_ln:
    s_mov_b32 s3, 0xffff0000
    v_lshlrev_b32 v64, 16, v8
    v_and_b32 v65, s3, v8
    v_lshlrev_b32 v66, 16, v9
    v_and_b32 v67, s3, v9
    v_lshlrev_b32 v68, 16, v10
    v_and_b32 v69, s3, v10
    v_lshlrev_b32 v70, 16, v11
    v_and_b32 v71, s3, v11
    v_lshlrev_b32 v72, 16, v12
    v_and_b32 v73, s3, v12
    v_lshlrev_b32 v74, 16, v13
    v_and_b32 v75, s3, v13
    v_lshlrev_b32 v76, 16, v14
    v_and_b32 v77, s3, v14
    v_lshlrev_b32 v78, 16, v15
    v_and_b32 v79, s3, v15
    v_lshlrev_b32 v80, 16, v16
    v_and_b32 v81, s3, v16
    v_lshlrev_b32 v82, 16, v17
    v_and_b32 v83, s3, v17
    v_lshlrev_b32 v84, 16, v18
    v_and_b32 v85, s3, v18
    v_lshlrev_b32 v86, 16, v19
    v_and_b32 v87, s3, v19
    v_lshlrev_b32 v88, 16, v20
    v_and_b32 v89, s3, v20
    v_lshlrev_b32 v90, 16, v21
    v_and_b32 v91, s3, v21
    v_lshlrev_b32 v92, 16, v22
    v_and_b32 v93, s3, v22
    v_lshlrev_b32 v94, 16, v23
    v_and_b32 v95, s3, v23
    v_lshlrev_b32 v96, 16, v24
    v_and_b32 v97, s3, v24
    v_lshlrev_b32 v98, 16, v25
    v_and_b32 v99, s3, v25
    v_add_f32 v4, v64, v65
    v_add_f32 v5, v66, v67
    v_add_f32 v4, v4, v68
    v_add_f32 v5, v5, v69
    v_add_f32 v4, v4, v70
    v_add_f32 v5, v5, v71
    v_add_f32 v4, v4, v72
    v_add_f32 v5, v5, v73
    v_add_f32 v4, v4, v74
    v_add_f32 v5, v5, v75
    v_add_f32 v4, v4, v76
    v_add_f32 v5, v5, v77
    v_add_f32 v4, v4, v78
    v_add_f32 v5, v5, v79
    v_add_f32 v4, v4, v80
    v_add_f32 v5, v5, v81
    v_add_f32 v4, v4, v82
    v_add_f32 v5, v5, v83
    v_add_f32 v4, v4, v84
    v_add_f32 v5, v5, v85
    v_add_f32 v4, v4, v86
    v_add_f32 v5, v5, v87
    v_add_f32 v4, v4, v88
    v_add_f32 v5, v5, v89
    v_add_f32 v4, v4, v90
    v_add_f32 v5, v5, v91
    v_add_f32 v4, v4, v92
    v_add_f32 v5, v5, v93
    v_add_f32 v4, v4, v94
    v_add_f32 v5, v5, v95
    v_add_f32 v4, v4, v96
    v_add_f32 v5, v5, v97
    v_add_f32 v4, v4, v98
    v_add_f32 v5, v5, v99
    v_add_f32 v4, v4, v5
    s_nop 1
    v_add_f32_dpp v4, v4, v4 quad_perm:[1,0,3,2] row_mask:0xf bank_mask:0xf
    s_nop 1
    v_add_f32_dpp v4, v4, v4 quad_perm:[2,3,0,1] row_mask:0xf bank_mask:0xf
    s_nop 1
    v_add_f32_dpp v4, v4, v4 row_ror:4 row_mask:0xf bank_mask:0xf
    s_nop 1
    v_add_f32_dpp v4, v4, v4 row_ror:8 row_mask:0xf bank_mask:0xf
    v_mul_f32 v4, 0x3ae38e39, v4
    v_sub_f32 v64, v64, v4
    v_sub_f32 v65, v65, v4
    v_sub_f32 v66, v66, v4
    v_sub_f32 v67, v67, v4
    v_sub_f32 v68, v68, v4
    v_sub_f32 v69, v69, v4
    v_sub_f32 v70, v70, v4
    v_sub_f32 v71, v71, v4
    v_sub_f32 v72, v72, v4
    v_sub_f32 v73, v73, v4
    v_sub_f32 v74, v74, v4
    v_sub_f32 v75, v75, v4
    v_sub_f32 v76, v76, v4
    v_sub_f32 v77, v77, v4
    v_sub_f32 v78, v78, v4
    v_sub_f32 v79, v79, v4
    v_sub_f32 v80, v80, v4
    v_sub_f32 v81, v81, v4
    v_sub_f32 v82, v82, v4
    v_sub_f32 v83, v83, v4
    v_sub_f32 v84, v84, v4
    v_sub_f32 v85, v85, v4
    v_sub_f32 v86, v86, v4
    v_sub_f32 v87, v87, v4
    v_sub_f32 v88, v88, v4
    v_sub_f32 v89, v89, v4
    v_sub_f32 v90, v90, v4
    v_sub_f32 v91, v91, v4
    v_sub_f32 v92, v92, v4
    v_sub_f32 v93, v93, v4
    v_sub_f32 v94, v94, v4
    v_sub_f32 v95, v95, v4
    v_sub_f32 v96, v96, v4
    v_sub_f32 v97, v97, v4
    v_sub_f32 v98, v98, v4
    v_sub_f32 v99, v99, v4
    v_mul_f32 v4, v64, v64
    v_mul_f32 v5, v65, v65
    v_fmac_f32 v4, v66, v66
    v_fmac_f32 v5, v67, v67
    v_fmac_f32 v4, v68, v68
    v_fmac_f32 v5, v69, v69
    v_fmac_f32 v4, v70, v70
    v_fmac_f32 v5, v71, v71
    v_fmac_f32 v4, v72, v72
    v_fmac_f32 v5, v73, v73
    v_fmac_f32 v4, v74, v74
    v_fmac_f32 v5, v75, v75
    v_fmac_f32 v4, v76, v76
    v_fmac_f32 v5, v77, v77
    v_fmac_f32 v4, v78, v78
    v_fmac_f32 v5, v79, v79
    v_fmac_f32 v4, v80, v80
    v_fmac_f32 v5, v81, v81
    v_fmac_f32 v4, v82, v82
    v_fmac_f32 v5, v83, v83
    v_fmac_f32 v4, v84, v84
    v_fmac_f32 v5, v85, v85
    v_fmac_f32 v4, v86, v86
    v_fmac_f32 v5, v87, v87
    v_fmac_f32 v4, v88, v88
    v_fmac_f32 v5, v89, v89
    v_fmac_f32 v4, v90, v90
    v_fmac_f32 v5, v91, v91
    v_fmac_f32 v4, v92, v92
    v_fmac_f32 v5, v93, v93
    v_fmac_f32 v4, v94, v94
    v_fmac_f32 v5, v95, v95
    v_fmac_f32 v4, v96, v96
    v_fmac_f32 v5, v97, v97
    v_fmac_f32 v4, v98, v98
    v_fmac_f32 v5, v99, v99
    v_add_f32 v4, v4, v5
    s_nop 1
    v_add_f32_dpp v4, v4, v4 quad_perm:[1,0,3,2] row_mask:0xf bank_mask:0xf
    s_nop 1
    v_add_f32_dpp v4, v4, v4 quad_perm:[2,3,0,1] row_mask:0xf bank_mask:0xf
    s_nop 1
    v_add_f32_dpp v4, v4, v4 row_ror:4 row_mask:0xf bank_mask:0xf
    s_nop 1
    v_add_f32_dpp v4, v4, v4 row_ror:8 row_mask:0xf bank_mask:0xf
    v_mov_b32 v5, 0x3727c5ac
    v_fmac_f32 v5, 0x3ae38e39, v4
    v_rsq_f32 v4, v5
    s_nop 0
    v_mul_f32 v64, v64, v4
    v_mul_f32 v65, v65, v4
    v_mul_f32 v66, v66, v4
    v_mul_f32 v67, v67, v4
    v_mul_f32 v68, v68, v4
    v_mul_f32 v69, v69, v4
    v_mul_f32 v70, v70, v4
    v_mul_f32 v71, v71, v4
    v_mul_f32 v72, v72, v4
    v_mul_f32 v73, v73, v4
    v_mul_f32 v74, v74, v4
    v_mul_f32 v75, v75, v4
    v_mul_f32 v76, v76, v4
    v_mul_f32 v77, v77, v4
    v_mul_f32 v78, v78, v4
    v_mul_f32 v79, v79, v4
    v_mul_f32 v80, v80, v4
    v_mul_f32 v81, v81, v4
    v_mul_f32 v82, v82, v4
    v_mul_f32 v83, v83, v4
    v_mul_f32 v84, v84, v4
    v_mul_f32 v85, v85, v4
    v_mul_f32 v86, v86, v4
    v_mul_f32 v87, v87, v4
    v_mul_f32 v88, v88, v4
    v_mul_f32 v89, v89, v4
    v_mul_f32 v90, v90, v4
    v_mul_f32 v91, v91, v4
    v_mul_f32 v92, v92, v4
    v_mul_f32 v93, v93, v4
    v_mul_f32 v94, v94, v4
    v_mul_f32 v95, v95, v4
    v_mul_f32 v96, v96, v4
    v_mul_f32 v97, v97, v4
    v_mul_f32 v98, v98, v4
    v_mul_f32 v99, v99, v4
    s_cmp_eq_u32 s13, 0
    s_cbranch_scc1 k3_nog2
    s_mul_i32 s23, s18, 6336
    s_add_u32 s23, s23, 96256
    v_add_u32 v5, s23, v3
    s_waitcnt vmcnt(0)
    v_lshl_or_b32 v8, v101, 16, v100
    v_lshl_or_b32 v9, v103, 16, v102
    v_lshl_or_b32 v10, v105, 16, v104
    v_lshl_or_b32 v11, v107, 16, v106
    ds_write_b128 v5, v[8:11] offset:0
    v_lshl_or_b32 v12, v109, 16, v108
    v_lshl_or_b32 v13, v111, 16, v110
    v_lshl_or_b32 v14, v113, 16, v112
    v_lshl_or_b32 v15, v115, 16, v114
    ds_write_b128 v5, v[12:15] offset:1056
    v_lshl_or_b32 v16, v117, 16, v116
    v_lshl_or_b32 v17, v119, 16, v118
    v_lshl_or_b32 v18, v121, 16, v120
    v_lshl_or_b32 v19, v123, 16, v122
    ds_write_b128 v5, v[16:19] offset:2112
    v_lshl_or_b32 v20, v125, 16, v124
    v_lshl_or_b32 v21, v127, 16, v126
    v_lshl_or_b32 v22, v129, 16, v128
    v_lshl_or_b32 v23, v131, 16, v130
    ds_write_b128 v5, v[20:23] offset:3168
    v_lshl_or_b32 v24, v133, 16, v132
    v_lshl_or_b32 v25, v135, 16, v134
    v_lshl_or_b32 v26, v137, 16, v136
    v_lshl_or_b32 v27, v139, 16, v138
    ds_write_b128 v5, v[24:27] offset:4224
    v_lshl_or_b32 v28, v141, 16, v140
    v_lshl_or_b32 v29, v143, 16, v142
    v_lshl_or_b32 v30, v145, 16, v144
    v_lshl_or_b32 v31, v147, 16, v146
    ds_write_b128 v5, v[28:31] offset:5280
k3_nog2:
    v_lshlrev_b32 v4, 4, v62
    v_lshrrev_b32 v5, 1, v62
    v_mul_u32_u24 v5, 528, v5
    v_lshl_add_u32 v5, v61, 4, v5
    v_and_b32 v63, 1, v62
    v_lshl_add_u32 v5, v63, 3, v5
    v_add_u32 v5, 57344, v5
    s_waitcnt lgkmcnt(0)
    s_barrier
    ds_read_b128 v[8:11], v4 offset:2304
    ds_read_b128 v[12:15], v4 offset:0
    ds_read_b128 v[16:19], v4 offset:2560
    ds_read_b128 v[20:23], v4 offset:256
    ds_read_b128 v[24:27], v4 offset:2816
    ds_read_b128 v[28:31], v4 offset:512
    ds_read_b128 v[32:35], v4 offset:3072
    ds_read_b128 v[36:39], v4 offset:768
    ds_read_b128 v[40:43], v4 offset:3328
    ds_read_b128 v[44:47], v4 offset:1024
    ds_read_b128 v[48:51], v4 offset:3584
    ds_read_b128 v[52:55], v4 offset:1280
    s_waitcnt lgkmcnt(6)
    v_fma_f32 v64, v64, v8, v12
    v_fma_f32 v65, v65, v9, v13
    v_fma_f32 v66, v66, v10, v14
    v_fma_f32 v67, v67, v11, v15
    v_fma_f32 v68, v68, v16, v20
    v_fma_f32 v69, v69, v17, v21
    v_fma_f32 v70, v70, v18, v22
    v_fma_f32 v71, v71, v19, v23
    v_fma_f32 v72, v72, v24, v28
    v_fma_f32 v73, v73, v25, v29
    v_fma_f32 v74, v74, v26, v30
    v_fma_f32 v75, v75, v27, v31
    ds_read_b128 v[8:11], v4 offset:3840
    ds_read_b128 v[12:15], v4 offset:1536
    ds_read_b128 v[16:19], v4 offset:4096
    ds_read_b128 v[20:23], v4 offset:1792
    ds_read_b128 v[24:27], v4 offset:4352
    ds_read_b128 v[28:31], v4 offset:2048
    v_cvt_pk_bf16_f32 v64, v64, v65
    v_cvt_pk_bf16_f32 v65, v66, v67
    ds_write_b64 v5, v[64:65] offset:0
    v_cvt_pk_bf16_f32 v68, v68, v69
    v_cvt_pk_bf16_f32 v69, v70, v71
    ds_write_b64 v5, v[68:69] offset:4224
    v_cvt_pk_bf16_f32 v72, v72, v73
    v_cvt_pk_bf16_f32 v73, v74, v75
    ds_write_b64 v5, v[72:73] offset:8448
    s_waitcnt lgkmcnt(9)
    v_fma_f32 v76, v76, v32, v36
    v_fma_f32 v77, v77, v33, v37
    v_fma_f32 v78, v78, v34, v38
    v_fma_f32 v79, v79, v35, v39
    v_fma_f32 v80, v80, v40, v44
    v_fma_f32 v81, v81, v41, v45
    v_fma_f32 v82, v82, v42, v46
    v_fma_f32 v83, v83, v43, v47
    v_fma_f32 v84, v84, v48, v52
    v_fma_f32 v85, v85, v49, v53
    v_fma_f32 v86, v86, v50, v54
    v_fma_f32 v87, v87, v51, v55
    v_cvt_pk_bf16_f32 v76, v76, v77
    v_cvt_pk_bf16_f32 v77, v78, v79
    ds_write_b64 v5, v[76:77] offset:12672
    v_cvt_pk_bf16_f32 v80, v80, v81
    v_cvt_pk_bf16_f32 v81, v82, v83
    ds_write_b64 v5, v[80:81] offset:16896
    v_cvt_pk_bf16_f32 v84, v84, v85
    v_cvt_pk_bf16_f32 v85, v86, v87
    ds_write_b64 v5, v[84:85] offset:21120
    s_waitcnt lgkmcnt(3)
    v_fma_f32 v88, v88, v8, v12
    v_fma_f32 v89, v89, v9, v13
    v_fma_f32 v90, v90, v10, v14
    v_fma_f32 v91, v91, v11, v15
    v_fma_f32 v92, v92, v16, v20
    v_fma_f32 v93, v93, v17, v21
    v_fma_f32 v94, v94, v18, v22
    v_fma_f32 v95, v95, v19, v23
    v_fma_f32 v96, v96, v24, v28
    v_fma_f32 v97, v97, v25, v29
    v_fma_f32 v98, v98, v26, v30
    v_fma_f32 v99, v99, v27, v31
    v_cvt_pk_bf16_f32 v88, v88, v89
    v_cvt_pk_bf16_f32 v89, v90, v91
    ds_write_b64 v5, v[88:89] offset:25344
    v_cvt_pk_bf16_f32 v92, v92, v93
    v_cvt_pk_bf16_f32 v93, v94, v95
    ds_write_b64 v5, v[92:93] offset:29568
    v_cvt_pk_bf16_f32 v96, v96, v97
    v_cvt_pk_bf16_f32 v97, v98, v99
    ds_write_b64 v5, v[96:97] offset:33792
k3_qw:
    s_cmp_ge_u32 s18, 5
    s_cselect_b32 s21, 1, 0
    s_mul_i32 s22, s21, 5
    s_sub_u32 s22, s18, s22
    s_lshl_b32 s23, s20, 2
    s_add_u32 s23, s23, s22
    s_lshr_b32 s24, s20, 1
    s_add_u32 s24, s24, 16
    s_cmp_eq_u32 s22, 4
    s_cselect_b32 s23, s24, s23
    s_mul_i32 s25, s23, 36
    s_mul_i32 s26, s21, 18
    s_add_u32 s25, s25, s26
    s_lshl_b32 s25, s25, 10
    s_add_u32 s25, s25, 1724416
    v_mul_u32_u24 v60, 528, v7
    v_lshl_add_u32 v60, v6, 4, v60
    s_mul_i32 s26, s21, 19008
    s_add_u32 s26, s26, 57344
    v_add_u32 v60, s26, v60
    s_mov_b32 s28, s16
    s_mov_b32 s29, s17
    s_mov_b32 s30, 53587968
    s_mov_b32 s31, 0x00020000
    s_waitcnt lgkmcnt(0)
    s_barrier
    v_mov_b32 v4, 8192
    s_mov_b32 s3, 0
k3_qf:
    ds_read_b32 v5, v4
    s_add_u32 s3, s3, 1
    s_waitcnt lgkmcnt(0)
    v_readfirstlane_b32 s26, v5
    s_nop 0
    s_cmp_lg_u32 s26, 0
    s_cbranch_scc1 k3_qf_ok
    s_sleep 2
    s_cmp_lt_u32 s3, 0x400000
    s_cbranch_scc1 k3_qf
k3_qf_ok:
    buffer_load_dwordx4 v[64:67], v3, s[28:31], s25 offen offset:0 sc1
    buffer_load_dwordx4 v[68:71], v3, s[28:31], s25 offen offset:1024 sc1
    buffer_load_dwordx4 v[72:75], v3, s[28:31], s25 offen offset:2048 sc1
    buffer_load_dwordx4 v[76:79], v3, s[28:31], s25 offen offset:3072 sc1
    s_add_u32 s25, s25, 4096
    ds_read_b128 v[8:11], v60 offset:0
    ds_read_b128 v[12:15], v60 offset:1056
    ds_read_b128 v[16:19], v60 offset:2112
    ds_read_b128 v[20:23], v60 offset:3168
    ds_read_b128 v[24:27], v60 offset:4224
    ds_read_b128 v[28:31], v60 offset:5280
    buffer_load_dwordx4 v[80:83], v3, s[28:31], s25 offen offset:0 sc1
    buffer_load_dwordx4 v[84:87], v3, s[28:31], s25 offen offset:1024 sc1
    s_waitcnt vmcnt(5) lgkmcnt(5)
    v_mfma_f32_32x32x16_bf16 v[44:59], v[64:67], v[8:11], 0
    ds_read_b128 v[8:11], v60 offset:6336
    buffer_load_dwordx4 v[88:91], v3, s[28:31], s25 offen offset:2048 sc1
    buffer_load_dwordx4 v[92:95], v3, s[28:31], s25 offen offset:3072 sc1
    s_add_u32 s25, s25, 4096
    s_waitcnt vmcnt(6) lgkmcnt(5)
    v_mfma_f32_32x32x16_bf16 v[44:59], v[68:71], v[12:15], v[44:59]
    ds_read_b128 v[12:15], v60 offset:7392
    buffer_load_dwordx4 v[96:99], v3, s[28:31], s25 offen offset:0 sc1
    buffer_load_dwordx4 v[100:103], v3, s[28:31], s25 offen offset:1024 sc1
    s_waitcnt vmcnt(7) lgkmcnt(5)
    v_mfma_f32_32x32x16_bf16 v[44:59], v[72:75], v[16:19], v[44:59]
    ds_read_b128 v[16:19], v60 offset:8448
    buffer_load_dwordx4 v[104:107], v3, s[28:31], s25 offen offset:2048 sc1
    buffer_load_dwordx4 v[108:111], v3, s[28:31], s25 offen offset:3072 sc1
    s_add_u32 s25, s25, 4096
    s_waitcnt vmcnt(8) lgkmcnt(5)
    v_mfma_f32_32x32x16_bf16 v[44:59], v[76:79], v[20:23], v[44:59]
    ds_read_b128 v[20:23], v60 offset:9504
    buffer_load_dwordx4 v[112:115], v3, s[28:31], s25 offen offset:0 sc1
    buffer_load_dwordx4 v[116:119], v3, s[28:31], s25 offen offset:1024 sc1
    s_waitcnt vmcnt(9) lgkmcnt(5)
    v_mfma_f32_32x32x16_bf16 v[44:59], v[80:83], v[24:27], v[44:59]
    ds_read_b128 v[24:27], v60 offset:10560
    buffer_load_dwordx4 v[120:123], v3, s[28:31], s25 offen offset:2048 sc1
    buffer_load_dwordx4 v[124:127], v3, s[28:31], s25 offen offset:3072 sc1
    s_add_u32 s25, s25, 4096
    s_waitcnt vmcnt(10) lgkmcnt(5)
    v_mfma_f32_32x32x16_bf16 v[44:59], v[84:87], v[28:31], v[44:59]
    ds_read_b128 v[28:31], v60 offset:11616
    buffer_load_dwordx4 v[128:131], v3, s[28:31], s25 offen offset:0 sc1
    buffer_load_dwordx4 v[132:135], v3, s[28:31], s25 offen offset:1024 sc1
    s_waitcnt vmcnt(11) lgkmcnt(5)
    v_mfma_f32_32x32x16_bf16 v[44:59], v[88:91], v[8:11], v[44:59]
    ds_read_b128 v[8:11], v60 offset:12672
    s_waitcnt vmcnt(10) lgkmcnt(5)
    v_mfma_f32_32x32x16_bf16 v[44:59], v[92:95], v[12:15], v[44:59]
    ds_read_b128 v[12:15], v60 offset:13728
    s_waitcnt vmcnt(9) lgkmcnt(5)
    v_mfma_f32_32x32x16_bf16 v[44:59], v[96:99], v[16:19], v[44:59]
    ds_read_b128 v[16:19], v60 offset:14784
    s_waitcnt vmcnt(8) lgkmcnt(5)
    v_mfma_f32_32x32x16_bf16 v[44:59], v[100:103], v[20:23], v[44:59]
    ds_read_b128 v[20:23], v60 offset:15840
    s_waitcnt vmcnt(7) lgkmcnt(5)
    v_mfma_f32_32x32x16_bf16 v[44:59], v[104:107], v[24:27], v[44:59]
    ds_read_b128 v[24:27], v60 offset:16896
    s_waitcnt vmcnt(6) lgkmcnt(5)
    v_mfma_f32_32x32x16_bf16 v[44:59], v[108:111], v[28:31], v[44:59]
    ds_read_b128 v[28:31], v60 offset:17952
    s_waitcnt vmcnt(5) lgkmcnt(5)
    v_mfma_f32_32x32x16_bf16 v[44:59], v[112:115], v[8:11], v[44:59]
    s_waitcnt vmcnt(4) lgkmcnt(4)
    v_mfma_f32_32x32x16_bf16 v[44:59], v[116:119], v[12:15], v[44:59]
    s_waitcnt vmcnt(3) lgkmcnt(3)
    v_mfma_f32_32x32x16_bf16 v[44:59], v[120:123], v[16:19], v[44:59]
    s_waitcnt vmcnt(2) lgkmcnt(2)
    v_mfma_f32_32x32x16_bf16 v[44:59], v[124:127], v[20:23], v[44:59]
    s_waitcnt vmcnt(1) lgkmcnt(1)
    v_mfma_f32_32x32x16_bf16 v[44:59], v[128:131], v[24:27], v[44:59]
    s_waitcnt vmcnt(0) lgkmcnt(0)
    v_mfma_f32_32x32x16_bf16 v[44:59], v[132:135], v[28:31], v[44:59]
    s_lshl_b32 s26, s22, 12
    s_add_u32 s26, s26, 135168
    v_add_u32 v60, s26, v3
    s_cmp_eq_u32 s21, 0
    s_cbranch_scc1 k3_lo
    s_nop 6
    ds_write_b128 v60, v[44:47]
    ds_write_b128 v60, v[48:51] offset:1024
    ds_write_b128 v60, v[52:55] offset:2048
    ds_write_b128 v60, v[56:59] offset:3072
    s_waitcnt lgkmcnt(0)
    s_barrier
    s_branch k3_b3
k3_lo:
    s_barrier
    ds_read_b128 v[8:11], v60
    ds_read_b128 v[12:15], v60 offset:1024
    ds_read_b128 v[16:19], v60 offset:2048
    ds_read_b128 v[20:23], v60 offset:3072
    s_mov_b32 s3, 0x3eae1a93
    s_lshl_b32 s26, s22, 11
    s_add_u32 s26, s26, 96256
    v_add_u32 v60, s26, v3
    v_lshlrev_b32 v61, 5, v6
    v_add_u32 v61, 104448, v61
    s_and_b32 s26, s20, 1
    v_cmp_eq_u32 vcc, s26, v7
    s_waitcnt lgkmcnt(0)
    v_add_f32 v44, v44, v8
    v_add_f32 v45, v45, v9
    v_add_f32 v46, v46, v10
    v_add_f32 v47, v47, v11
    v_add_f32 v48, v48, v12
    v_add_f32 v49, v49, v13
    v_add_f32 v50, v50, v14
    v_add_f32 v51, v51, v15
    v_add_f32 v52, v52, v16
    v_add_f32 v53, v53, v17
    v_add_f32 v54, v54, v18
    v_add_f32 v55, v55, v19
    v_add_f32 v56, v56, v20
    v_add_f32 v57, v57, v21
    v_add_f32 v58, v58, v22
    v_add_f32 v59, v59, v23
    v_mul_f32 v44, s3, v44
    v_mul_f32 v45, s3, v45
    v_mul_f32 v46, s3, v46
    v_mul_f32 v47, s3, v47
    v_mul_f32 v48, s3, v48
    v_mul_f32 v49, s3, v49
    v_mul_f32 v50, s3, v50
    v_mul_f32 v51, s3, v51
    v_mul_f32 v52, s3, v52
    v_mul_f32 v53, s3, v53
    v_mul_f32 v54, s3, v54
    v_mul_f32 v55, s3, v55
    v_mul_f32 v56, s3, v56
    v_mul_f32 v57, s3, v57
    v_mul_f32 v58, s3, v58
    v_mul_f32 v59, s3, v59
    v_cvt_pk_bf16_f32 v8, v44, v45
    v_cvt_pk_bf16_f32 v9, v46, v47
    v_cvt_pk_bf16_f32 v10, v48, v49
    v_cvt_pk_bf16_f32 v11, v50, v51
    v_cvt_pk_bf16_f32 v12, v52, v53
    v_cvt_pk_bf16_f32 v13, v54, v55
    v_cvt_pk_bf16_f32 v14, v56, v57
    v_cvt_pk_bf16_f32 v15, v58, v59
    s_cmp_eq_u32 s22, 4
    s_cbranch_scc1 k3_q2w
    ds_write_b128 v60, v[8:11]
    ds_write_b128 v60, v[12:15] offset:1024
    s_branch k3_qwd
k3_q2w:
    s_and_saveexec_b64 s[40:41], vcc
    ds_write_b128 v61, v[8:11]
    ds_write_b128 v61, v[12:15] offset:16
    s_mov_b64 exec, s[40:41]
k3_qwd:
    s_waitcnt lgkmcnt(0)
k3_b3:
    s_barrier
    s_lshl_b32 s22, s18, 10
    s_cmp_ge_u32 s18, 8
    s_cbranch_scc1 k3_helper
    s_lshl_b32 s21, s20, 3
    s_add_u32 s21, s21, s18
    v_add_u32 v60, s22, v3
    s_lshl_b32 s23, s18, 2
    v_lshl_add_u32 v61, v6, 5, s23
    v_add_u32 v60, 96256, v60
    v_add_u32 v61, 104448, v61
    ds_read_b128 v[8:11], v60
    ds_read_b32 v12, v61
    s_add_u32 s36, s16, 7581696
    s_addc_u32 s37, s17, 0
    s_mov_b32 s38, 2359296
    s_mov_b32 s39, 0x00020000
    v_mov_b32 v56, 0x58b18820
    v_mov_b32 v57, 0x09460f73
    v_mov_b32 v58, 0x933398a4
    v_mov_b32 v59, 0x05292852
    v_cmp_le_u32 vcc, 12, v6
    v_subrev_u32 v1, 12, v6
    v_min_u32 v1, 11, v1
    v_cndmask_b32 v1, v6, v1, vcc
    v_cndmask_b32 v56, v56, v58, vcc
    v_cndmask_b32 v57, v57, v59, vcc
    v_mul_u32_u24 v1, 5, v1
    v_lshrrev_b64 v[56:57], v1, v[56:57]
    v_and_b32 v4, 31, v56
    v_lshlrev_b32 v4, 4, v4
    s_movk_i32 s3, 320
    v_mad_u32_u24 v4, v7, s3, v4
    v_cmp_eq_u32 s[44:45], 0, v7
    v_lshlrev_b32 v5, 2, v6
    v_add_u32 v5, 2304, v5
    v_mov_b32 v1, 1184
    v_cndmask_b32 v5, v1, v5, s[44:45]
    v_mov_b32 v1, 0x3f803f80
    v_cndmask_b32 v21, 0, v1, s[44:45]
    v_mov_b32 v22, 0
    v_mov_b32 v23, 0
    v_mov_b32 v13, 0
    v_mov_b32 v14, 0
    v_mov_b32 v15, 0
    s_mov_b32 s40, 0x12
    s_mov_b32 s42, 0
    s_cmp_lt_u32 s18, 4
    s_cbranch_scc1 k3_old
    s_setprio 1
    s_bitset1_b32 s40, 13
k3_old:
    s_waitcnt lgkmcnt(0)
    v_cndmask_b32 v12, 0, v12, s[44:45]
    ds_read_b128 v[16:19], v3
    ds_read_b32 v20, v5
    s_waitcnt lgkmcnt(0)
    v_mfma_f32_32x32x16_bf16 v[56:71], v[16:19], v[8:11], 0
    v_mfma_f32_32x32x8_bf16 v[56:71], v[20:21], v[12:13], v[56:71]
    s_nop 11
    v_max3_f32 v1, v56, v57, v58
    v_max3_f32 v6, v59, v60, v61
    v_max3_f32 v1, v1, v62, v63
    v_max3_f32 v6, v6, v64, v65
    v_max3_f32 v1, v1, v66, v67
    v_max3_f32 v6, v6, v68, v69
    v_max3_f32 v1, v1, v70, v71
    v_max_f32 v1, v1, v6
k3_restart:
    v_mov_b32 v6, v1
    s_nop 1
    v_permlane32_swap_b32 v1, v6
    v_max_f32 v1, v1, v6
    v_sub_f32 v1, 0, v1
    v_cvt_pk_bf16_f32 v6, v1, v1
    v_lshlrev_b32 v6, 16, v6
    v_sub_f32 v1, v1, v6
    v_cvt_pk_bf16_f32 v1, v6, v1
    v_cndmask_b32 v13, 0, v1, s[44:45]
    v_mfma_f32_32x32x16_bf16 v[56:71], v[16:19], v[8:11], 0
    v_mov_b32 v36, 0
    v_mov_b32 v37, 0
    v_mov_b32 v38, 0
    v_mov_b32 v39, 0
    v_mfma_f32_32x32x8_bf16 v[56:71], v[20:21], v[12:13], v[56:71]
    ds_read_b128 v[16:19], v3 offset:2432
    ds_read_b128 v[28:31], v4 offset:1664
    ds_read_b32 v20, v5 offset:2432
    ds_read_b128 v[24:27], v4 offset:1024
    s_mov_b32 s43, 0
    v_mov_b32 v40, 0
    v_mov_b32 v41, 0
    v_mov_b32 v42, 0
    v_mov_b32 v43, 0
    v_mov_b32 v44, 0
    v_mov_b32 v45, 0
    v_mov_b32 v46, 0
    v_mov_b32 v47, 0
    v_mov_b32 v48, 0
    v_mov_b32 v49, 0
    v_mov_b32 v50, 0
    v_mov_b32 v51, 0
    v_mov_b32 v52, 0
    v_mov_b32 v53, 0
    v_mov_b32 v54, 0
    v_mov_b32 v55, 0
.p2align 3
k3_loop:
    s_bitcmp1_b32 s40, s43
    s_cbranch_scc1 k3_sync
k3_body:
    s_waitcnt lgkmcnt(3)
    v_mfma_f32_32x32x16_bf16 v[72:87], v[16:19], v[8:11], 0
    ds_read_b128 v[16:19], v3 offset:4864
    v_exp_f32 v56, v56
    v_exp_f32 v57, v57
    v_exp_f32 v58, v58
    v_exp_f32 v59, v59
    s_waitcnt lgkmcnt(3)
    v_mfma_f32_32x32x16_bf16 v[40:55], v[28:31], v[36:39], v[40:55]
    ds_read_b128 v[28:31], v4 offset:1664
    v_exp_f32 v60, v60
    v_exp_f32 v61, v61
    v_exp_f32 v62, v62
    v_exp_f32 v63, v63
    v_cvt_pk_bf16_f32 v32, v56, v57
    v_cvt_pk_bf16_f32 v33, v58, v59
    v_cvt_pk_bf16_f32 v34, v60, v61
    v_cvt_pk_bf16_f32 v35, v62, v63
    s_waitcnt lgkmcnt(3)
    v_mfma_f32_32x32x8_bf16 v[72:87], v[20:21], v[12:13], v[72:87]
    ds_read_b32 v20, v5 offset:4864
    v_exp_f32 v64, v64
    v_exp_f32 v65, v65
    v_exp_f32 v66, v66
    v_exp_f32 v67, v67
    s_waitcnt lgkmcnt(3)
    v_mfma_f32_32x32x16_bf16 v[40:55], v[24:27], v[32:35], v[40:55]
    ds_read_b128 v[24:27], v4 offset:3456
    v_exp_f32 v68, v68
    v_exp_f32 v69, v69
    v_exp_f32 v70, v70
    v_exp_f32 v71, v71
    v_cvt_pk_bf16_f32 v36, v64, v65
    v_cvt_pk_bf16_f32 v37, v66, v67
    v_cvt_pk_bf16_f32 v38, v68, v69
    v_cvt_pk_bf16_f32 v39, v70, v71
    s_waitcnt lgkmcnt(3)
    v_mfma_f32_32x32x16_bf16 v[56:71], v[16:19], v[8:11], 0
    ds_read_b128 v[16:19], v3 offset:7296
    v_exp_f32 v72, v72
    v_exp_f32 v73, v73
    v_exp_f32 v74, v74
    v_exp_f32 v75, v75
    s_waitcnt lgkmcnt(3)
    v_mfma_f32_32x32x16_bf16 v[40:55], v[28:31], v[36:39], v[40:55]
    ds_read_b128 v[28:31], v4 offset:4096
    v_exp_f32 v76, v76
    v_exp_f32 v77, v77
    v_exp_f32 v78, v78
    v_exp_f32 v79, v79
    v_cvt_pk_bf16_f32 v32, v72, v73
    v_cvt_pk_bf16_f32 v33, v74, v75
    v_cvt_pk_bf16_f32 v34, v76, v77
    v_cvt_pk_bf16_f32 v35, v78, v79
    s_waitcnt lgkmcnt(3)
    v_mfma_f32_32x32x8_bf16 v[56:71], v[20:21], v[12:13], v[56:71]
    ds_read_b32 v20, v5 offset:7296
    v_exp_f32 v80, v80
    v_exp_f32 v81, v81
    v_exp_f32 v82, v82
    v_exp_f32 v83, v83
    s_waitcnt lgkmcnt(3)
    v_mfma_f32_32x32x16_bf16 v[40:55], v[24:27], v[32:35], v[40:55]
    ds_read_b128 v[24:27], v4 offset:5888
    v_exp_f32 v84, v84
    v_exp_f32 v85, v85
    v_exp_f32 v86, v86
    v_exp_f32 v87, v87
    v_cvt_pk_bf16_f32 v36, v80, v81
    v_cvt_pk_bf16_f32 v37, v82, v83
    v_cvt_pk_bf16_f32 v38, v84, v85
    v_cvt_pk_bf16_f32 v39, v86, v87
    s_waitcnt lgkmcnt(3)
    v_mfma_f32_32x32x16_bf16 v[72:87], v[16:19], v[8:11], 0
    ds_read_b128 v[16:19], v3 offset:9728
    v_exp_f32 v56, v56
    v_exp_f32 v57, v57
    v_exp_f32 v58, v58
    v_exp_f32 v59, v59
    s_waitcnt lgkmcnt(3)
    v_mfma_f32_32x32x16_bf16 v[40:55], v[28:31], v[36:39], v[40:55]
    ds_read_b128 v[28:31], v4 offset:6528
    v_exp_f32 v60, v60
    v_exp_f32 v61, v61
    v_exp_f32 v62, v62
    v_exp_f32 v63, v63
    v_cvt_pk_bf16_f32 v32, v56, v57
    v_cvt_pk_bf16_f32 v33, v58, v59
    v_cvt_pk_bf16_f32 v34, v60, v61
    v_cvt_pk_bf16_f32 v35, v62, v63
    s_waitcnt lgkmcnt(3)
    v_mfma_f32_32x32x8_bf16 v[72:87], v[20:21], v[12:13], v[72:87]
    ds_read_b32 v20, v5 offset:9728
    v_exp_f32 v64, v64
    v_exp_f32 v65, v65
    v_exp_f32 v66, v66
    v_exp_f32 v67, v67
    s_waitcnt lgkmcnt(3)
    v_mfma_f32_32x32x16_bf16 v[40:55], v[24:27], v[32:35], v[40:55]
    ds_read_b128 v[24:27], v4 offset:8320
    v_exp_f32 v68, v68
    v_exp_f32 v69, v69
    v_exp_f32 v70, v70
    v_exp_f32 v71, v71
    v_cvt_pk_bf16_f32 v36, v64, v65
    v_cvt_pk_bf16_f32 v37, v66, v67
    v_cvt_pk_bf16_f32 v38, v68, v69
    v_cvt_pk_bf16_f32 v39, v70, v71
    s_waitcnt lgkmcnt(3)
    v_mfma_f32_32x32x16_bf16 v[56:71], v[16:19], v[8:11], 0
    ds_read_b128 v[16:19], v3 offset:12160
    v_exp_f32 v72, v72
    v_exp_f32 v73, v73
    v_exp_f32 v74, v74
    v_exp_f32 v75, v75
    s_waitcnt lgkmcnt(3)
    v_mfma_f32_32x32x16_bf16 v[40:55], v[28:31], v[36:39], v[40:55]
    ds_read_b128 v[28:31], v4 offset:8960
    v_exp_f32 v76, v76
    v_exp_f32 v77, v77
    v_exp_f32 v78, v78
    v_exp_f32 v79, v79
    v_cvt_pk_bf16_f32 v32, v72, v73
    v_cvt_pk_bf16_f32 v33, v74, v75
    v_cvt_pk_bf16_f32 v34, v76, v77
    v_cvt_pk_bf16_f32 v35, v78, v79
    s_waitcnt lgkmcnt(3)
    v_mfma_f32_32x32x8_bf16 v[56:71], v[20:21], v[12:13], v[56:71]
    ds_read_b32 v20, v5 offset:12160
    v_exp_f32 v80, v80
    v_exp_f32 v81, v81
    v_exp_f32 v82, v82
    v_exp_f32 v83, v83
    s_waitcnt lgkmcnt(3)
    v_mfma_f32_32x32x16_bf16 v[40:55], v[24:27], v[32:35], v[40:55]
    ds_read_b128 v[24:27], v4 offset:10752
    s_add_u32 s43, s43, 1
    s_cmp_lt_u32 s43, 16
    v_exp_f32 v84, v84
    v_exp_f32 v85, v85
    v_exp_f32 v86, v86
    v_exp_f32 v87, v87
    v_cvt_pk_bf16_f32 v36, v80, v81
    v_cvt_pk_bf16_f32 v37, v82, v83
    v_cvt_pk_bf16_f32 v38, v84, v85
    v_cvt_pk_bf16_f32 v39, v86, v87
    v_add_u32 v3, 9728, v3
    v_add_u32 v4, 9728, v4
    v_add_u32 v5, 9728, v5
    s_cbranch_scc1 k3_loop
    s_waitcnt lgkmcnt(0)
    v_mfma_f32_32x32x16_bf16 v[40:55], v[28:31], v[36:39], v[40:55]
    v_subrev_u32 v3, 155648, v3
    v_subrev_u32 v4, 155648, v4
    v_subrev_u32 v5, 155648, v5
    s_mov_b32 s3, 0x5d800000
    s_mov_b32 s46, 0x21800000
    v_and_b32 v6, 16, v2
    v_mul_u32_u24 v6, 1152, v6
    v_and_b32 v7, 15, v2
    v_lshl_add_u32 v6, v7, 4, v6
    v_lshrrev_b32 v7, 5, v2
    v_lshl_add_u32 v6, v7, 8, v6
    s_mul_i32 s22, s19, 36864
    s_lshl_b32 s23, s21, 9
    s_add_u32 s23, s23, s22
    s_lshl_b32 s24, s20, 9
    s_add_u32 s22, s22, s24
    s_add_u32 s22, s22, 16384
    s_lshl_b32 s24, s18, 1
    s_add_u32 s22, s22, s24
    v_cmp_gt_f32 vcc, s3, v49
    v_cmp_lt_f32 s[46:47], s46, v49
    v_rcp_f32 v1, v49
    s_and_b64 vcc, vcc, s[46:47]
    s_cmp_eq_u64 vcc, -1
    s_cbranch_scc1 k3_fin
    s_cmp_eq_u32 s42, 0
    s_cbranch_scc1 k3_fallback
k3_fin:
    v_mul_f32 v40, v40, v1
    v_mul_f32 v41, v41, v1
    v_mul_f32 v42, v42, v1
    v_mul_f32 v43, v43, v1
    v_mul_f32 v44, v44, v1
    v_mul_f32 v45, v45, v1
    v_mul_f32 v46, v46, v1
    v_mul_f32 v47, v47, v1
    v_mul_f32 v48, v48, v1
    v_cvt_pk_bf16_f32 v32, v40, v41
    v_cvt_pk_bf16_f32 v33, v42, v43
    v_cvt_pk_bf16_f32 v34, v44, v45
    v_cvt_pk_bf16_f32 v35, v46, v47
    v_cvt_pk_bf16_f32 v36, v48, v48
    buffer_store_dwordx4 v[32:35], v6, s[36:39], s23 offen
    buffer_store_short v36, v6, s[36:39], s22 offen
    s_endpgm
k3_sync:
    s_cmp_eq_u32 s43, 13
    s_cbranch_scc1 k3_psw
    s_barrier
    s_branch k3_body
k3_psw:
    s_setprio 0
    s_branch k3_body
k3_fallback:
    s_mov_b32 s42, 1
    s_mov_b32 s40, 0
    v_mov_b32 v13, 0
    v_mov_b32 v1, 0xff7fffff
    v_mov_b32 v32, v3
    v_mov_b32 v33, v5
    s_mov_b32 s43, 0
k3_fb_loop:
    ds_read_b128 v[16:19], v32
    ds_read_b32 v20, v33
    s_waitcnt lgkmcnt(0)
    v_mfma_f32_32x32x16_bf16 v[56:71], v[16:19], v[8:11], 0
    v_mfma_f32_32x32x8_bf16 v[56:71], v[20:21], v[12:13], v[56:71]
    v_add_u32 v32, 2432, v32
    v_add_u32 v33, 2432, v33
    s_nop 9
    v_max3_f32 v1, v1, v56, v57
    v_max3_f32 v1, v1, v58, v59
    v_max3_f32 v1, v1, v60, v61
    v_max3_f32 v1, v1, v62, v63
    v_max3_f32 v1, v1, v64, v65
    v_max3_f32 v1, v1, v66, v67
    v_max3_f32 v1, v1, v68, v69
    v_max3_f32 v1, v1, v70, v71
    s_add_u32 s43, s43, 1
    s_cmp_lt_u32 s43, 64
    s_cbranch_scc1 k3_fb_loop
    ds_read_b128 v[16:19], v3
    ds_read_b32 v20, v5
    s_waitcnt lgkmcnt(0)
    s_branch k3_restart
k3_w8:
    v_mov_b32 v62, 0
    s_and_b32 s6, s18, 2
    s_lshl_b32 s6, s6, 6
    v_mul_u32_u24 v63, 88064, v2
    s_and_b32 s12, s2, 3
    s_lshl_b32 s21, s14, 1
    s_and_b32 s22, s18, 1
    s_add_u32 s21, s21, s22
    s_waitcnt lgkmcnt(0)
    s_mov_b32 s28, s16
    s_mov_b32 s29, s17
    s_mov_b32 s30, 53587968
    s_mov_b32 s31, 0x00020000
    s_mov_b32 s40, s50
    s_mov_b32 s41, s51
    s_mov_b32 s42, 256
    s_mov_b32 s43, 0x00020000
    s_cmp_ge_u32 s18, 10
    s_cbranch_scc1 k3_w10
    s_cmp_lt_u32 s20, 2
    s_cbranch_scc1 k3_g_idle
    s_lshr_b32 s22, s2, 5
    s_lshl_b32 s22, s22, 1
    s_and_b32 s23, s20, 1
    s_add_u32 s22, s22, s23
    s_and_b32 s23, s18, 1
    s_lshl_b32 s23, s23, 4
    s_add_u32 s22, s22, s23
    s_cmp_ge_u32 s22, 18
    s_cbranch_scc1 k3_g_idle
    s_and_b32 s21, s2, 3
    s_mul_i32 s21, s21, 18
    s_add_u32 s21, s21, s22
    s_bfe_u32 s23, s2, 0x10002
    s_lshl_b32 s22, s21, 5
    s_mul_i32 s24, s23, 1990656
    s_add_u32 s22, s22, s24
    s_mul_i32 s24, s23, 576
    s_lshl_b32 s21, s21, 1
    s_add_u32 s21, s21, s23
    v_lshrrev_b32 v5, 1, v2
    v_mul_u32_u24 v4, 6912, v5
    v_and_b32 v30, 1, v2
    v_lshl_add_u32 v4, v30, 4, v4
    v_lshlrev_b32 v5, 1, v5
    s_mov_b32 s26, 221184
    s_mov_b32 s27, 64
    s_mov_b32 s13, 0
    s_setprio 3
    s_branch k3_gemv2
k3_gemv:
    v_mul_u32_u24 v4, 6912, v2
    v_lshlrev_b32 v5, 1, v2
    s_lshl_b32 s22, s21, 4
    s_mov_b32 s24, 0
    s_mov_b32 s26, 442368
    s_movk_i32 s27, 128
k3_gemv2:
    s_mov_b32 s40, s50
    s_mov_b32 s41, s51
    s_mov_b32 s42, 256
    s_mov_b32 s43, 0x00020000
    s_mov_b32 s32, s60
    s_mov_b32 s33, s61
    s_mov_b32 s34, 1152
    s_mov_b32 s35, 0x00020000
    s_mov_b32 s36, s62
    s_mov_b32 s37, s63
    s_mov_b32 s38, 3981312
    s_mov_b32 s39, 0x00020000
    buffer_load_ushort v8, v5, s[32:35], s24 offen
    s_add_u32 s24, s24, s27
    buffer_load_ushort v9, v5, s[32:35], s24 offen
    s_add_u32 s24, s24, s27
    buffer_load_ushort v10, v5, s[32:35], s24 offen
    s_add_u32 s24, s24, s27
    buffer_load_ushort v11, v5, s[32:35], s24 offen
    s_add_u32 s24, s24, s27
    buffer_load_ushort v12, v5, s[32:35], s24 offen
    s_add_u32 s24, s24, s27
    buffer_load_ushort v13, v5, s[32:35], s24 offen
    s_add_u32 s24, s24, s27
    buffer_load_ushort v14, v5, s[32:35], s24 offen
    s_add_u32 s24, s24, s27
    buffer_load_ushort v15, v5, s[32:35], s24 offen
    s_add_u32 s24, s24, s27
    buffer_load_ushort v16, v5, s[32:35], s24 offen
    s_add_u32 s24, s24, s27
    buffer_load_dwordx4 v[64:67], v4, s[36:39], s22 offen
    s_add_u32 s22, s22, s26
    buffer_load_dwordx4 v[68:71], v4, s[36:39], s22 offen
    s_add_u32 s22, s22, s26
    buffer_load_dwordx4 v[72:75], v4, s[36:39], s22 offen
    s_add_u32 s22, s22, s26
    buffer_load_dwordx4 v[76:79], v4, s[36:39], s22 offen
    s_add_u32 s22, s22, s26
    buffer_load_dwordx4 v[80:83], v4, s[36:39], s22 offen
    s_add_u32 s22, s22, s26
    buffer_load_dwordx4 v[84:87], v4, s[36:39], s22 offen
    s_add_u32 s22, s22, s26
    buffer_load_dwordx4 v[88:91], v4, s[36:39], s22 offen
    s_add_u32 s22, s22, s26
    buffer_load_dwordx4 v[92:95], v4, s[36:39], s22 offen
    s_add_u32 s22, s22, s26
    buffer_load_dwordx4 v[96:99], v4, s[36:39], s22 offen
    s_mov_b32 s22, 0xbfb8aa3b
    s_cmp_eq_u32 s13, 0
    s_cbranch_scc1 k3_g_bar
    s_waitcnt vmcnt(18)
k3_g_bar:
    s_barrier
k3_g_nos1:
    s_waitcnt vmcnt(9)
    buffer_load_dword v1, v62, s[40:43], s6 offen sc1
    v_lshlrev_b32 v8, 16, v8
    v_lshlrev_b32 v9, 16, v9
    v_lshlrev_b32 v10, 16, v10
    v_lshlrev_b32 v11, 16, v11
    v_lshlrev_b32 v12, 16, v12
    v_lshlrev_b32 v13, 16, v13
    v_lshlrev_b32 v14, 16, v14
    v_lshlrev_b32 v15, 16, v15
    v_lshlrev_b32 v16, 16, v16
    v_mul_f32 v20, s22, v8
    v_mul_f32 v21, s22, v9
    v_mul_f32 v22, s22, v10
    v_mul_f32 v23, s22, v11
    v_mul_f32 v24, s22, v12
    v_mul_f32 v25, s22, v13
    v_mul_f32 v26, s22, v14
    v_mul_f32 v27, s22, v15
    v_mul_f32 v28, s22, v16
    v_exp_f32 v20, v20
    v_exp_f32 v21, v21
    v_exp_f32 v22, v22
    v_exp_f32 v23, v23
    v_exp_f32 v24, v24
    v_exp_f32 v25, v25
    v_exp_f32 v26, v26
    v_exp_f32 v27, v27
    v_exp_f32 v28, v28
    v_add_f32 v20, 1.0, v20
    v_add_f32 v21, 1.0, v21
    v_add_f32 v22, 1.0, v22
    v_add_f32 v23, 1.0, v23
    v_add_f32 v24, 1.0, v24
    v_add_f32 v25, 1.0, v25
    v_add_f32 v26, 1.0, v26
    v_add_f32 v27, 1.0, v27
    v_add_f32 v28, 1.0, v28
    v_rcp_f32 v20, v20
    v_rcp_f32 v21, v21
    v_rcp_f32 v22, v22
    v_rcp_f32 v23, v23
    v_rcp_f32 v24, v24
    v_rcp_f32 v25, v25
    v_rcp_f32 v26, v26
    v_rcp_f32 v27, v27
    v_rcp_f32 v28, v28
    v_mul_f32 v8, v8, v20
    v_mul_f32 v9, v9, v21
    v_mul_f32 v10, v10, v22
    v_mul_f32 v11, v11, v23
    v_mul_f32 v12, v12, v24
    v_mul_f32 v13, v13, v25
    v_mul_f32 v14, v14, v26
    v_mul_f32 v15, v15, v27
    v_mul_f32 v16, v16, v28
    v_cvt_pk_bf16_f32 v8, v8, v8
    v_cvt_pk_bf16_f32 v9, v9, v9
    v_cvt_pk_bf16_f32 v10, v10, v10
    v_cvt_pk_bf16_f32 v11, v11, v11
    v_cvt_pk_bf16_f32 v12, v12, v12
    v_cvt_pk_bf16_f32 v13, v13, v13
    v_cvt_pk_bf16_f32 v14, v14, v14
    v_cvt_pk_bf16_f32 v15, v15, v15
    v_cvt_pk_bf16_f32 v16, v16, v16
    v_lshlrev_b32 v8, 16, v8
    v_lshlrev_b32 v9, 16, v9
    v_lshlrev_b32 v10, 16, v10
    v_lshlrev_b32 v11, 16, v11
    v_lshlrev_b32 v12, 16, v12
    v_lshlrev_b32 v13, 16, v13
    v_lshlrev_b32 v14, 16, v14
    v_lshlrev_b32 v15, 16, v15
    v_lshlrev_b32 v16, 16, v16
    s_mov_b32 s3, 0xffff0000
    s_mul_i32 s22, s21, 911
    s_lshr_b32 s22, s22, 16
    s_mov_b32 s23, 0x12
    s_bitcmp1_b32 s23, s22
    s_cselect_b32 s22, 1.0, 0
    s_movk_i32 s24, 18432
    v_lshrrev_b32 v4, 4, v2
    v_lshlrev_b32 v5, 2, v4
    v_lshlrev_b32 v4, 4, v4
    v_and_b32 v30, 1, v2
    v_lshl_add_u32 v4, v30, 6, v4
    v_bfe_u32 v30, v2, 1, 3
    v_mad_u32_u24 v4, v30, s24, v4
    v_cmp_gt_u32 s[44:45], 4, v30
    s_lshl_b32 s23, s21, 7
    s_add_u32 s23, s23, 258048
    s_lshl_b32 s24, s21, 4
    s_add_u32 s24, s24, 16384
    s_lshl_b32 s25, s21, 7
    s_add_u32 s25, s25, 405504
    s_waitcnt vmcnt(9)
    v_lshlrev_b32 v40, 16, v64
    v_and_b32 v41, s3, v64
    v_mul_f32 v32, v8, v40
    v_mul_f32 v33, v8, v41
    v_lshlrev_b32 v42, 16, v65
    v_and_b32 v43, s3, v65
    v_mul_f32 v34, v8, v42
    v_mul_f32 v35, v8, v43
    v_lshlrev_b32 v40, 16, v66
    v_and_b32 v41, s3, v66
    v_mul_f32 v36, v8, v40
    v_mul_f32 v37, v8, v41
    v_lshlrev_b32 v42, 16, v67
    v_and_b32 v43, s3, v67
    v_mul_f32 v38, v8, v42
    v_mul_f32 v39, v8, v43
    s_waitcnt vmcnt(8)
    v_lshlrev_b32 v40, 16, v68
    v_and_b32 v41, s3, v68
    v_fmac_f32 v32, v9, v40
    v_fmac_f32 v33, v9, v41
    v_lshlrev_b32 v42, 16, v69
    v_and_b32 v43, s3, v69
    v_fmac_f32 v34, v9, v42
    v_fmac_f32 v35, v9, v43
    v_lshlrev_b32 v40, 16, v70
    v_and_b32 v41, s3, v70
    v_fmac_f32 v36, v9, v40
    v_fmac_f32 v37, v9, v41
    v_lshlrev_b32 v42, 16, v71
    v_and_b32 v43, s3, v71
    v_fmac_f32 v38, v9, v42
    v_fmac_f32 v39, v9, v43
    s_waitcnt vmcnt(7)
    v_lshlrev_b32 v40, 16, v72
    v_and_b32 v41, s3, v72
    v_fmac_f32 v32, v10, v40
    v_fmac_f32 v33, v10, v41
    v_lshlrev_b32 v42, 16, v73
    v_and_b32 v43, s3, v73
    v_fmac_f32 v34, v10, v42
    v_fmac_f32 v35, v10, v43
    v_lshlrev_b32 v40, 16, v74
    v_and_b32 v41, s3, v74
    v_fmac_f32 v36, v10, v40
    v_fmac_f32 v37, v10, v41
    v_lshlrev_b32 v42, 16, v75
    v_and_b32 v43, s3, v75
    v_fmac_f32 v38, v10, v42
    v_fmac_f32 v39, v10, v43
    s_waitcnt vmcnt(6)
    v_lshlrev_b32 v40, 16, v76
    v_and_b32 v41, s3, v76
    v_fmac_f32 v32, v11, v40
    v_fmac_f32 v33, v11, v41
    v_lshlrev_b32 v42, 16, v77
    v_and_b32 v43, s3, v77
    v_fmac_f32 v34, v11, v42
    v_fmac_f32 v35, v11, v43
    v_lshlrev_b32 v40, 16, v78
    v_and_b32 v41, s3, v78
    v_fmac_f32 v36, v11, v40
    v_fmac_f32 v37, v11, v41
    v_lshlrev_b32 v42, 16, v79
    v_and_b32 v43, s3, v79
    v_fmac_f32 v38, v11, v42
    v_fmac_f32 v39, v11, v43
    s_waitcnt vmcnt(5)
    v_lshlrev_b32 v40, 16, v80
    v_and_b32 v41, s3, v80
    v_fmac_f32 v32, v12, v40
    v_fmac_f32 v33, v12, v41
    v_lshlrev_b32 v42, 16, v81
    v_and_b32 v43, s3, v81
    v_fmac_f32 v34, v12, v42
    v_fmac_f32 v35, v12, v43
    v_lshlrev_b32 v40, 16, v82
    v_and_b32 v41, s3, v82
    v_fmac_f32 v36, v12, v40
    v_fmac_f32 v37, v12, v41
    v_lshlrev_b32 v42, 16, v83
    v_and_b32 v43, s3, v83
    v_fmac_f32 v38, v12, v42
    v_fmac_f32 v39, v12, v43
    s_waitcnt vmcnt(4)
    v_lshlrev_b32 v40, 16, v84
    v_and_b32 v41, s3, v84
    v_fmac_f32 v32, v13, v40
    v_fmac_f32 v33, v13, v41
    v_lshlrev_b32 v42, 16, v85
    v_and_b32 v43, s3, v85
    v_fmac_f32 v34, v13, v42
    v_fmac_f32 v35, v13, v43
    v_lshlrev_b32 v40, 16, v86
    v_and_b32 v41, s3, v86
    v_fmac_f32 v36, v13, v40
    v_fmac_f32 v37, v13, v41
    v_lshlrev_b32 v42, 16, v87
    v_and_b32 v43, s3, v87
    v_fmac_f32 v38, v13, v42
    v_fmac_f32 v39, v13, v43
    s_waitcnt vmcnt(3)
    v_lshlrev_b32 v40, 16, v88
    v_and_b32 v41, s3, v88
    v_fmac_f32 v32, v14, v40
    v_fmac_f32 v33, v14, v41
    v_lshlrev_b32 v42, 16, v89
    v_and_b32 v43, s3, v89
    v_fmac_f32 v34, v14, v42
    v_fmac_f32 v35, v14, v43
    v_lshlrev_b32 v40, 16, v90
    v_and_b32 v41, s3, v90
    v_fmac_f32 v36, v14, v40
    v_fmac_f32 v37, v14, v41
    v_lshlrev_b32 v42, 16, v91
    v_and_b32 v43, s3, v91
    v_fmac_f32 v38, v14, v42
    v_fmac_f32 v39, v14, v43
    s_waitcnt vmcnt(2)
    v_lshlrev_b32 v40, 16, v92
    v_and_b32 v41, s3, v92
    v_fmac_f32 v32, v15, v40
    v_fmac_f32 v33, v15, v41
    v_lshlrev_b32 v42, 16, v93
    v_and_b32 v43, s3, v93
    v_fmac_f32 v34, v15, v42
    v_fmac_f32 v35, v15, v43
    v_lshlrev_b32 v40, 16, v94
    v_and_b32 v41, s3, v94
    v_fmac_f32 v36, v15, v40
    v_fmac_f32 v37, v15, v41
    v_lshlrev_b32 v42, 16, v95
    v_and_b32 v43, s3, v95
    v_fmac_f32 v38, v15, v42
    v_fmac_f32 v39, v15, v43
    s_waitcnt vmcnt(1)
    v_lshlrev_b32 v40, 16, v96
    v_and_b32 v41, s3, v96
    v_fmac_f32 v32, v16, v40
    v_fmac_f32 v33, v16, v41
    v_lshlrev_b32 v42, 16, v97
    v_and_b32 v43, s3, v97
    v_fmac_f32 v34, v16, v42
    v_fmac_f32 v35, v16, v43
    v_lshlrev_b32 v40, 16, v98
    v_and_b32 v41, s3, v98
    v_fmac_f32 v36, v16, v40
    v_fmac_f32 v37, v16, v41
    v_lshlrev_b32 v42, 16, v99
    v_and_b32 v43, s3, v99
    v_fmac_f32 v38, v16, v42
    v_fmac_f32 v39, v16, v43
    v_permlane32_swap_b32 v32, v36
    v_permlane32_swap_b32 v33, v37
    v_permlane32_swap_b32 v34, v38
    v_permlane32_swap_b32 v35, v39
    v_add_f32 v32, v32, v36
    v_add_f32 v33, v33, v37
    v_add_f32 v34, v34, v38
    v_add_f32 v35, v35, v39
    s_nop 0
    v_permlane16_swap_b32 v32, v34
    v_permlane16_swap_b32 v33, v35
    v_add_f32 v32, v32, v34
    v_add_f32 v33, v33, v35
    s_nop 0
    v_add_f32_dpp v32, v32, v32 quad_perm:[2,3,0,1] row_mask:0xf bank_mask:0xf
    v_add_f32_dpp v33, v33, v33 quad_perm:[2,3,0,1] row_mask:0xf bank_mask:0xf
    s_nop 0
    v_add_f32_dpp v32, v32, v32 row_ror:4 row_mask:0xf bank_mask:0xf
    v_add_f32_dpp v33, v33, v33 row_ror:4 row_mask:0xf bank_mask:0xf
    s_nop 0
    v_add_f32_dpp v32, v32, v32 row_ror:8 row_mask:0xf bank_mask:0xf
    v_add_f32_dpp v33, v33, v33 row_ror:8 row_mask:0xf bank_mask:0xf
    s_waitcnt vmcnt(0)
    s_mov_b32 s3, 0
k3_kernel_tok1:
    v_readfirstlane_b32 s15, v1
    s_nop 0
    s_cmp_lg_u32 s15, 0
    s_cbranch_scc1 k3_kernel_toke2
    s_sleep 2
    buffer_load_dword v1, v62, s[40:43], s6 offen sc1
    s_add_u32 s3, s3, 1
    s_waitcnt vmcnt(0)
    s_cmp_lt_u32 s3, 0x40000
    s_cbranch_scc1 k3_kernel_tok1
k3_kernel_toke2:
    s_cmp_lg_u32 s13, 0
    s_cbranch_scc1 k3_g_nc
    v_mov_b32 v34, v33
    v_mov_b32 v33, s15
    v_mov_b32 v35, s15
    s_mov_b64 exec, s[44:45]
    buffer_store_dwordx4 v[32:35], v4, s[28:31], s23 offen sc1
    s_branch k3_g_pub
k3_g_nc:
    v_add_f32_dpp v32, v32, v32 quad_perm:[1,0,3,2] row_mask:0xf bank_mask:0xf
    v_add_f32_dpp v33, v33, v33 quad_perm:[1,0,3,2] row_mask:0xf bank_mask:0xf
    s_mov_b32 s3, 0xffff0000
    v_cvt_pk_bf16_f32 v32, v32, v33
    v_lshlrev_b32 v33, 16, v32
    v_and_b32 v34, s3, v32
    v_add_f32 v33, s22, v33
    v_add_f32 v34, s22, v34
    v_cvt_pk_bf16_f32 v32, v33, v34
    v_mov_b32 v33, s15
    buffer_store_dword v32, v5, s[28:31], s24 offen sc1
    s_mov_b64 exec, 15
    s_waitcnt vmcnt(0)
    buffer_store_dword v33, v63, s[28:31], s25 offen sc1
k3_g_pub:
    s_mov_b64 exec, -1
    s_cmp_eq_u32 s13, 1
    s_cbranch_scc1 k3_h_s3
    s_setprio 0
    s_branch k3_mg
k3_g_idle:
    s_cmp_lt_u32 s20, 2
    s_cbranch_scc1 k3_eb1
    s_barrier
k3_eb1:
    s_cmp_lg_u32 s21, 511
    s_cbranch_scc1 k3_g_idle2
    v_lshlrev_b32 v4, 7, v2
    s_mov_b32 s22, 61440
k3_zf:
    buffer_store_dword v62, v4, s[28:31], s22 offen
    s_add_u32 s22, s22, 8192
    s_cmp_lt_u32 s22, 258048
    s_cbranch_scc1 k3_zf
k3_g_idle2:
    s_branch k3_r_nopf
k3_w10:
    s_cmp_lt_u32 s20, 2
    s_cbranch_scc1 k3_eb2
    s_barrier
k3_eb2:
    s_cmp_eq_u32 s18, 11
    s_cbranch_scc1 k3_w11
    s_setprio 2
    v_mov_b32 v4, 8192
    ds_write_b32 v4, v62
    s_cmp_lt_u32 s20, 2
    s_cbranch_scc1 k3_r_idle
    s_lshr_b32 s22, s2, 5
    s_lshl_b32 s22, s22, 1
    s_and_b32 s23, s20, 1
    s_add_u32 s22, s22, s23
    s_cmp_ge_u32 s22, 14
    s_cbranch_scc1 k3_r_idle
    s_and_b32 s21, s2, 7
    s_mul_i32 s21, s21, 14
    s_add_u32 s21, s21, s22
    s_cmp_ge_u32 s21, 108
    s_cbranch_scc1 k3_r_idle
    s_mul_i32 s22, s21, 10923
    s_lshr_b32 s22, s22, 16
    s_mul_i32 s23, s22, 6
    s_sub_u32 s23, s21, s23
    v_and_b32 v5, 19, v6
    v_and_b32 v4, 4, v6
    v_lshl_or_b32 v5, v4, 1, v5
    v_and_b32 v4, 8, v6
    v_lshrrev_b32 v4, 1, v4
    v_or_b32 v5, v5, v4
    s_cmp_ge_u32 s22, 16
    s_cbranch_scc1 k3_r_q2
    v_lshrrev_b32 v4, 4, v5
    v_lshl_add_u32 v4, v4, 1, v5
    s_mul_i32 s24, s22, 36
    v_add_u32 v4, s24, v4
    s_branch k3_r_go
k3_r_q2:
    v_and_b32 v4, 7, v5
    v_lshrrev_b32 v8, 4, v5
    v_lshl_add_u32 v4, v8, 3, v4
    v_and_b32 v8, 8, v5
    v_lshrrev_b32 v9, 1, v4
    v_add_u32 v8, v8, v9
    v_mul_u32_u24 v8, 18, v8
    v_and_b32 v4, 1, v4
    v_add_u32 v4, v4, v8
    s_mul_i32 s24, s22, 288
    s_sub_u32 s24, s24, 4592
    v_add_u32 v4, s24, v4
k3_r_go:
    v_mul_u32_u24 v5, 9216, v7
    v_lshl_add_u32 v5, v4, 1, v5
    s_mul_i32 s24, s23, 110592
    s_mov_b32 s32, s54
    s_mov_b32 s33, s55
    s_mov_b32 s34, 663552
    s_mov_b32 s35, 0x00020000
    buffer_load_ushort v64, v5, s[32:35], s24 offen offset:0
    buffer_load_ushort v65, v5, s[32:35], s24 offen offset:1152
    buffer_load_ushort v66, v5, s[32:35], s24 offen offset:2304
    s_add_u32 s24, s24, 3456
    buffer_load_ushort v67, v5, s[32:35], s24 offen offset:0
    buffer_load_ushort v68, v5, s[32:35], s24 offen offset:1152
    buffer_load_ushort v69, v5, s[32:35], s24 offen offset:2304
    s_add_u32 s24, s24, 3456
    buffer_load_ushort v70, v5, s[32:35], s24 offen offset:0
    buffer_load_ushort v71, v5, s[32:35], s24 offen offset:1152
    s_add_u32 s24, s24, 11520
    buffer_load_ushort v72, v5, s[32:35], s24 offen offset:0
    buffer_load_ushort v73, v5, s[32:35], s24 offen offset:1152
    buffer_load_ushort v74, v5, s[32:35], s24 offen offset:2304
    s_add_u32 s24, s24, 3456
    buffer_load_ushort v75, v5, s[32:35], s24 offen offset:0
    buffer_load_ushort v76, v5, s[32:35], s24 offen offset:1152
    buffer_load_ushort v77, v5, s[32:35], s24 offen offset:2304
    s_add_u32 s24, s24, 3456
    buffer_load_ushort v78, v5, s[32:35], s24 offen offset:0
    buffer_load_ushort v79, v5, s[32:35], s24 offen offset:1152
    s_add_u32 s24, s24, 11520
    buffer_load_ushort v80, v5, s[32:35], s24 offen offset:0
    buffer_load_ushort v81, v5, s[32:35], s24 offen offset:1152
    buffer_load_ushort v82, v5, s[32:35], s24 offen offset:2304
    s_add_u32 s24, s24, 3456
    buffer_load_ushort v83, v5, s[32:35], s24 offen offset:0
    buffer_load_ushort v84, v5, s[32:35], s24 offen offset:1152
    buffer_load_ushort v85, v5, s[32:35], s24 offen offset:2304
    s_add_u32 s24, s24, 3456
    buffer_load_ushort v86, v5, s[32:35], s24 offen offset:0
    buffer_load_ushort v87, v5, s[32:35], s24 offen offset:1152
    s_add_u32 s24, s24, 11520
    buffer_load_ushort v88, v5, s[32:35], s24 offen offset:0
    buffer_load_ushort v89, v5, s[32:35], s24 offen offset:1152
    buffer_load_ushort v90, v5, s[32:35], s24 offen offset:2304
    s_add_u32 s24, s24, 3456
    buffer_load_ushort v91, v5, s[32:35], s24 offen offset:0
    buffer_load_ushort v92, v5, s[32:35], s24 offen offset:1152
    buffer_load_ushort v93, v5, s[32:35], s24 offen offset:2304
    s_add_u32 s24, s24, 3456
    buffer_load_ushort v94, v5, s[32:35], s24 offen offset:0
    buffer_load_ushort v95, v5, s[32:35], s24 offen offset:1152
    s_add_u32 s24, s24, 11520
    buffer_load_ushort v96, v5, s[32:35], s24 offen offset:0
    buffer_load_ushort v97, v5, s[32:35], s24 offen offset:1152
    buffer_load_ushort v98, v5, s[32:35], s24 offen offset:2304
    s_add_u32 s24, s24, 3456
    buffer_load_ushort v99, v5, s[32:35], s24 offen offset:0
    buffer_load_ushort v100, v5, s[32:35], s24 offen offset:1152
    buffer_load_ushort v101, v5, s[32:35], s24 offen offset:2304
    s_add_u32 s24, s24, 3456
    buffer_load_ushort v102, v5, s[32:35], s24 offen offset:0
    buffer_load_ushort v103, v5, s[32:35], s24 offen offset:1152
    s_add_u32 s24, s24, 11520
    buffer_load_ushort v104, v5, s[32:35], s24 offen offset:0
    buffer_load_ushort v105, v5, s[32:35], s24 offen offset:1152
    buffer_load_ushort v106, v5, s[32:35], s24 offen offset:2304
    s_add_u32 s24, s24, 3456
    buffer_load_ushort v107, v5, s[32:35], s24 offen offset:0
    buffer_load_ushort v108, v5, s[32:35], s24 offen offset:1152
    buffer_load_ushort v109, v5, s[32:35], s24 offen offset:2304
    s_add_u32 s24, s24, 3456
    buffer_load_ushort v110, v5, s[32:35], s24 offen offset:0
    buffer_load_ushort v111, v5, s[32:35], s24 offen offset:1152
    s_add_u32 s24, s24, 11520
    s_mul_i32 s24, s21, 6144
    s_add_u32 s24, s24, 1724416
    s_lshl_b32 s25, s21, 7
    s_add_u32 s25, s25, 460800
    s_waitcnt vmcnt(47)
    buffer_load_dword v1, v62, s[40:43], s6 offen sc1
    s_waitcnt vmcnt(41)
    v_lshl_or_b32 v16, v65, 16, v64
    v_lshl_or_b32 v17, v67, 16, v66
    v_lshl_or_b32 v18, v69, 16, v68
    v_lshl_or_b32 v19, v71, 16, v70
    buffer_store_dwordx4 v[16:19], v3, s[28:31], s24 offen offset:0 sc1
    s_waitcnt vmcnt(34)
    v_lshl_or_b32 v20, v73, 16, v72
    v_lshl_or_b32 v21, v75, 16, v74
    v_lshl_or_b32 v22, v77, 16, v76
    v_lshl_or_b32 v23, v79, 16, v78
    buffer_store_dwordx4 v[20:23], v3, s[28:31], s24 offen offset:1024 sc1
    s_waitcnt vmcnt(27)
    v_lshl_or_b32 v24, v81, 16, v80
    v_lshl_or_b32 v25, v83, 16, v82
    v_lshl_or_b32 v26, v85, 16, v84
    v_lshl_or_b32 v27, v87, 16, v86
    buffer_store_dwordx4 v[24:27], v3, s[28:31], s24 offen offset:2048 sc1
    s_waitcnt vmcnt(20)
    v_lshl_or_b32 v28, v89, 16, v88
    v_lshl_or_b32 v29, v91, 16, v90
    v_lshl_or_b32 v30, v93, 16, v92
    v_lshl_or_b32 v31, v95, 16, v94
    buffer_store_dwordx4 v[28:31], v3, s[28:31], s24 offen offset:3072 sc1
    s_add_u32 s24, s24, 4096
    s_waitcnt vmcnt(13)
    v_lshl_or_b32 v32, v97, 16, v96
    v_lshl_or_b32 v33, v99, 16, v98
    v_lshl_or_b32 v34, v101, 16, v100
    v_lshl_or_b32 v35, v103, 16, v102
    buffer_store_dwordx4 v[32:35], v3, s[28:31], s24 offen offset:0 sc1
    s_waitcnt vmcnt(6)
    v_lshl_or_b32 v36, v105, 16, v104
    v_lshl_or_b32 v37, v107, 16, v106
    v_lshl_or_b32 v38, v109, 16, v108
    v_lshl_or_b32 v39, v111, 16, v110
    buffer_store_dwordx4 v[36:39], v3, s[28:31], s24 offen offset:1024 sc1
    s_waitcnt vmcnt(0)
    s_mov_b32 s3, 0
k3_kernel_tok3:
    v_readfirstlane_b32 s15, v1
    s_nop 0
    s_cmp_lg_u32 s15, 0
    s_cbranch_scc1 k3_kernel_toke4
    s_sleep 2
    buffer_load_dword v1, v62, s[40:43], s6 offen sc1
    s_add_u32 s3, s3, 1
    s_waitcnt vmcnt(0)
    s_cmp_lt_u32 s3, 0x40000
    s_cbranch_scc1 k3_kernel_tok3
k3_kernel_toke4:
    v_mov_b32 v4, s15
    s_mov_b64 exec, 15
    buffer_store_dword v4, v63, s[28:31], s25 offen sc1
    s_mov_b64 exec, -1
    s_branch k3_mg
k3_r_idle:
    s_branch k3_r_nopf
k3_w11:
    s_cmp_ge_u32 s2, 16
    s_cbranch_scc1 k3_r_nopf
    s_getpc_b64 s[24:25]
k3_kernel_pc5:
    s_sub_u32 s24, s24, k3_kernel_pc5 - k3_kernel
    s_subb_u32 s25, s25, 0
    v_lshlrev_b32 v8, 7, v2
    v_min_u32 v8, k3_kernel_codeend - k3_kernel - 4, v8
    global_load_dword v9, v8, s[24:25]
    s_getpc_b64 s[24:25]
k3_kernel_pc6:
    s_sub_u32 s24, s24, k3_kernel_pc6 - k3_kernel
    s_subb_u32 s25, s25, 0
    v_lshlrev_b32 v8, 7, v2
    v_add_u32 v8, 8192, v8
    v_min_u32 v8, k3_kernel_codeend - k3_kernel - 4, v8
    global_load_dword v9, v8, s[24:25]
k3_r_nopf:
    s_mov_b32 s32, s52
    s_mov_b32 s33, s53
    s_mov_b32 s34, 2359296
    s_mov_b32 s35, 0x00020000
    s_mul_i32 s24, s19, 36864
    buffer_load_dword v8, v62, s[32:35], s24 offen offset:4000
    s_waitcnt vmcnt(0)
    buffer_load_dword v1, v62, s[40:43], s6 offen sc1
    s_waitcnt vmcnt(0)
    s_mov_b32 s3, 0
k3_kernel_tok7:
    v_readfirstlane_b32 s15, v1
    s_nop 0
    s_cmp_lg_u32 s15, 0
    s_cbranch_scc1 k3_kernel_toke8
    s_sleep 2
    buffer_load_dword v1, v62, s[40:43], s6 offen sc1
    s_add_u32 s3, s3, 1
    s_waitcnt vmcnt(0)
    s_cmp_lt_u32 s3, 0x40000
    s_cbranch_scc1 k3_kernel_tok7
k3_kernel_toke8:
k3_mg:
    s_cmp_eq_u32 s18, 10
    s_cbranch_scc1 k3_mg_done
    s_sub_u32 s23, s18, 8
    s_min_u32 s23, s23, 2
    s_mul_i32 s24, s12, 18432
    s_mul_i32 s25, s23, 6144
    s_add_u32 s24, s24, s25
    s_add_u32 s24, s24, 258048
    s_add_u32 s25, s24, 4096
    s_cmp_ge_u32 s23, 2
    s_cselect_b32 s22, 1.0, 0
    s_cmp_ge_u32 s23, 1
    s_cselect_b32 s21, 1.0, 0
    v_lshrrev_b32 v34, 4, v2
    v_lshlrev_b32 v34, 6, v34
    v_and_b32 v35, 7, v2
    v_lshl_add_u32 v34, v35, 3, v34
    s_mul_i32 s23, s23, 1536
    v_add_u32 v34, s23, v34
    s_mov_b32 s3, 0
k3_m_poll:
    buffer_load_dwordx4 v[8:11], v3, s[28:31], s24 offen sc1
    buffer_load_dwordx4 v[12:15], v3, s[28:31], s24 offen offset:1024 sc1
    buffer_load_dwordx4 v[16:19], v3, s[28:31], s24 offen offset:2048 sc1
    buffer_load_dwordx4 v[20:23], v3, s[28:31], s24 offen offset:3072 sc1
    buffer_load_dwordx4 v[24:27], v3, s[28:31], s25 offen sc1
    buffer_load_dwordx4 v[28:31], v3, s[28:31], s25 offen offset:1024 sc1
    s_add_u32 s3, s3, 1
    s_waitcnt vmcnt(0)
    v_xor_b32 v32, s15, v9
    v_xor_b32 v33, s15, v11
    v_or_b32 v32, v32, v33
    v_xor_b32 v33, s15, v13
    v_or_b32 v32, v32, v33
    v_xor_b32 v33, s15, v15
    v_or_b32 v32, v32, v33
    v_xor_b32 v33, s15, v17
    v_or_b32 v32, v32, v33
    v_xor_b32 v33, s15, v19
    v_or_b32 v32, v32, v33
    v_xor_b32 v33, s15, v21
    v_or_b32 v32, v32, v33
    v_xor_b32 v33, s15, v23
    v_or_b32 v32, v32, v33
    v_xor_b32 v33, s15, v25
    v_or_b32 v32, v32, v33
    v_xor_b32 v33, s15, v27
    v_or_b32 v32, v32, v33
    v_xor_b32 v33, s15, v29
    v_or_b32 v32, v32, v33
    v_xor_b32 v33, s15, v31
    v_or_b32 v32, v32, v33
    v_cmp_eq_u32 vcc, 0, v32
    s_nop 0
    s_cmp_eq_u64 vcc, -1
    s_cbranch_scc1 k3_m_ok
    s_cmp_lt_u32 s20, 2
    s_cbranch_scc1 k3_m_fast
    s_sleep 0
k3_m_fast:
    s_sleep 3
    s_cmp_lt_u32 s3, 0x40000
    s_cbranch_scc1 k3_m_poll
k3_m_ok:
    s_mov_b32 s3, 0xffff0000
    v_add_f32_dpp v8, v8, v8 row_ror:8 row_mask:0xf bank_mask:0xf
    v_add_f32_dpp v10, v10, v10 row_ror:8 row_mask:0xf bank_mask:0xf
    v_add_f32_dpp v12, v12, v12 row_ror:8 row_mask:0xf bank_mask:0xf
    v_add_f32_dpp v14, v14, v14 row_ror:8 row_mask:0xf bank_mask:0xf
    v_add_f32_dpp v16, v16, v16 row_ror:8 row_mask:0xf bank_mask:0xf
    v_add_f32_dpp v18, v18, v18 row_ror:8 row_mask:0xf bank_mask:0xf
    v_add_f32_dpp v20, v20, v20 row_ror:8 row_mask:0xf bank_mask:0xf
    v_add_f32_dpp v22, v22, v22 row_ror:8 row_mask:0xf bank_mask:0xf
    v_add_f32_dpp v24, v24, v24 row_ror:8 row_mask:0xf bank_mask:0xf
    v_add_f32_dpp v26, v26, v26 row_ror:8 row_mask:0xf bank_mask:0xf
    v_add_f32_dpp v28, v28, v28 row_ror:8 row_mask:0xf bank_mask:0xf
    v_add_f32_dpp v30, v30, v30 row_ror:8 row_mask:0xf bank_mask:0xf
    v_cvt_pk_bf16_f32 v8, v8, v10
    v_cvt_pk_bf16_f32 v12, v12, v14
    v_cvt_pk_bf16_f32 v16, v16, v18
    v_cvt_pk_bf16_f32 v20, v20, v22
    v_cvt_pk_bf16_f32 v24, v24, v26
    v_cvt_pk_bf16_f32 v28, v28, v30
    v_and_b32 v9, s3, v8
    v_lshlrev_b32 v8, 16, v8
    v_and_b32 v13, s3, v12
    v_lshlrev_b32 v12, 16, v12
    v_and_b32 v17, s3, v16
    v_lshlrev_b32 v16, 16, v16
    v_and_b32 v21, s3, v20
    v_lshlrev_b32 v20, 16, v20
    v_and_b32 v25, s3, v24
    v_lshlrev_b32 v24, 16, v24
    v_and_b32 v29, s3, v28
    v_lshlrev_b32 v28, 16, v28
    v_add_f32 v8, s22, v8
    v_add_f32 v9, s22, v9
    v_add_f32 v12, s22, v12
    v_add_f32 v13, s22, v13
    v_add_f32 v16, s22, v16
    v_add_f32 v17, s22, v17
    v_add_f32 v20, s21, v20
    v_add_f32 v21, s21, v21
    v_add_f32 v24, s21, v24
    v_add_f32 v25, s21, v25
    v_add_f32 v28, s21, v28
    v_add_f32 v29, s21, v29
    v_cvt_pk_bf16_f32 v8, v8, v9
    v_cvt_pk_bf16_f32 v12, v12, v13
    v_cvt_pk_bf16_f32 v16, v16, v17
    v_cvt_pk_bf16_f32 v20, v20, v21
    v_cvt_pk_bf16_f32 v24, v24, v25
    v_cvt_pk_bf16_f32 v28, v28, v29
    v_and_b32 v9, s3, v8
    v_lshlrev_b32 v8, 16, v8
    ds_write_b64 v34, v[8:9] offset:0
    v_and_b32 v13, s3, v12
    v_lshlrev_b32 v12, 16, v12
    ds_write_b64 v34, v[12:13] offset:256
    v_and_b32 v17, s3, v16
    v_lshlrev_b32 v16, 16, v16
    ds_write_b64 v34, v[16:17] offset:512
    v_and_b32 v21, s3, v20
    v_lshlrev_b32 v20, 16, v20
    ds_write_b64 v34, v[20:21] offset:768
    v_and_b32 v25, s3, v24
    v_lshlrev_b32 v24, 16, v24
    ds_write_b64 v34, v[24:25] offset:1024
    v_and_b32 v29, s3, v28
    v_lshlrev_b32 v28, 16, v28
    ds_write_b64 v34, v[28:29] offset:1280
k3_mg_done:
    s_waitcnt lgkmcnt(0)
    s_barrier
    s_cmp_lt_u32 s18, 10
    s_cbranch_scc1 k3_qw
    s_cmp_eq_u32 s18, 11
    s_cbranch_scc1 k3_kv_pre
k3_w10b:
    s_mov_b32 s26, 0
    s_mul_i32 s24, s12, 88064
    s_add_u32 s24, s24, 460800
    s_add_u32 s25, s24, 8192
    v_lshlrev_b32 v4, 7, v2
    v_min_u32 v5, 5504, v4
    s_mov_b32 s3, 0
k3_q_poll:
    buffer_load_dword v8, v4, s[28:31], s24 offen sc1
    buffer_load_dword v9, v5, s[28:31], s25 offen sc1
    s_add_u32 s3, s3, 1
    s_waitcnt vmcnt(0)
    v_xor_b32 v8, s15, v8
    v_xor_b32 v9, s15, v9
    v_or_b32 v8, v8, v9
    v_cmp_eq_u32 vcc, 0, v8
    s_nop 0
    s_cmp_eq_u64 vcc, -1
    s_cbranch_scc1 k3_q_ok
    s_cmp_lg_u32 s26, 0
    s_cbranch_scc1 k3_q_slp
    s_mov_b32 s26, 1
    s_barrier
k3_q_slp:
    s_sleep 4
    s_cmp_lt_u32 s3, 0x40000
    s_cbranch_scc1 k3_q_poll
k3_q_ok:
    v_mov_b32 v4, 8192
    v_mov_b32 v5, 1
    ds_write_b32 v4, v5
    s_waitcnt lgkmcnt(0)
    s_cmp_lg_u32 s26, 0
    s_cbranch_scc1 k3_kv_b2
    s_barrier
    s_branch k3_kv_b2
k3_kv_pre:
    v_mul_u32_u24 v60, 528, v7
    v_lshl_add_u32 v60, v6, 4, v60
    v_add_u32 v60, 57344, v60
    v_add_u32 v61, 96256, v3
    s_barrier
    s_cmp_ge_u32 s20, 2
    s_cbranch_scc1 k3_kv_b2
    s_setprio 3
    s_cmp_eq_u32 s20, 0
    s_cbranch_scc1 k3_kv_ns
    v_swap_b32 v60, v61
k3_kv_ns:
    ds_read_b128 v[64:67], v61 offset:0
    ds_read_b128 v[8:11], v60 offset:0
    ds_read_b128 v[68:71], v61 offset:1056
    ds_read_b128 v[12:15], v60 offset:1056
    ds_read_b128 v[72:75], v61 offset:2112
    ds_read_b128 v[16:19], v60 offset:2112
    ds_read_b128 v[76:79], v61 offset:3168
    ds_read_b128 v[20:23], v60 offset:3168
    ds_read_b128 v[80:83], v61 offset:4224
    ds_read_b128 v[24:27], v60 offset:4224
    ds_read_b128 v[84:87], v61 offset:5280
    ds_read_b128 v[28:31], v60 offset:5280
    v_mov_b32 v44, 0
    v_mov_b32 v45, 0
    v_mov_b32 v46, 0
    v_mov_b32 v47, 0
    v_mov_b32 v48, 0
    v_mov_b32 v49, 0
    v_mov_b32 v50, 0
    v_mov_b32 v51, 0
    v_mov_b32 v52, 0
    v_mov_b32 v53, 0
    v_mov_b32 v54, 0
    v_mov_b32 v55, 0
    v_mov_b32 v56, 0
    v_mov_b32 v57, 0
    v_mov_b32 v58, 0
    v_mov_b32 v59, 0
    s_mov_b32 s3, 0
k3_kv_loop:
    s_waitcnt lgkmcnt(10)
    v_mfma_f32_32x32x16_bf16 v[44:59], v[64:67], v[8:11], v[44:59]
    ds_read_b128 v[64:67], v61 offset:6336
    ds_read_b128 v[8:11], v60 offset:6336
    s_waitcnt lgkmcnt(10)
    v_mfma_f32_32x32x16_bf16 v[44:59], v[68:71], v[12:15], v[44:59]
    ds_read_b128 v[68:71], v61 offset:7392
    ds_read_b128 v[12:15], v60 offset:7392
    s_waitcnt lgkmcnt(10)
    v_mfma_f32_32x32x16_bf16 v[44:59], v[72:75], v[16:19], v[44:59]
    ds_read_b128 v[72:75], v61 offset:8448
    ds_read_b128 v[16:19], v60 offset:8448
    s_waitcnt lgkmcnt(10)
    v_mfma_f32_32x32x16_bf16 v[44:59], v[76:79], v[20:23], v[44:59]
    ds_read_b128 v[76:79], v61 offset:9504
    ds_read_b128 v[20:23], v60 offset:9504
    s_waitcnt lgkmcnt(10)
    v_mfma_f32_32x32x16_bf16 v[44:59], v[80:83], v[24:27], v[44:59]
    ds_read_b128 v[80:83], v61 offset:10560
    ds_read_b128 v[24:27], v60 offset:10560
    s_waitcnt lgkmcnt(10)
    v_mfma_f32_32x32x16_bf16 v[44:59], v[84:87], v[28:31], v[44:59]
    ds_read_b128 v[84:87], v61 offset:11616
    ds_read_b128 v[28:31], v60 offset:11616
    v_add_u32 v60, 6336, v60
    v_add_u32 v61, 6336, v61
    s_add_u32 s3, s3, 1
    s_cmp_lt_u32 s3, 6
    s_cbranch_scc1 k3_kv_loop
    s_mul_i32 s26, s19, 2432
    s_add_u32 s26, s26, 1306624
    v_lshlrev_b32 v5, 2, v6
    s_waitcnt lgkmcnt(0)
    s_nop 0
    v_cvt_pk_bf16_f32 v8, v44, v45
    v_cvt_pk_bf16_f32 v9, v46, v47
    v_cvt_pk_bf16_f32 v10, v48, v49
    v_cvt_pk_bf16_f32 v11, v50, v51
    v_cvt_pk_bf16_f32 v12, v52, v53
    v_cvt_pk_bf16_f32 v13, v54, v55
    v_cvt_pk_bf16_f32 v14, v56, v57
    v_cvt_pk_bf16_f32 v15, v58, v59
    s_cmp_eq_u32 s20, 1
    s_cbranch_scc1 k3_kv_v
    buffer_store_dwordx4 v[8:11], v3, s[28:31], s26 offen sc1
    buffer_store_dword v12, v5, s[28:31], s26 offen offset:2304 sc1
    s_branch k3_kv_sig
k3_kv_v:
    v_mul_u32_u24 v5, 320, v7
    v_lshl_add_u32 v5, v6, 4, v5
    v_mov_b32 v4, 0x3f803f80
    v_cmp_eq_u32 vcc, 10, v6
    v_subrev_u32 v1, 9, v6
    s_nop 0
    v_cndmask_b32 v4, v4, 0, vcc
    v_cmp_gt_u32 vcc, 2, v1
    s_nop 1
    v_cndmask_b32 v8, v8, v4, vcc
    v_cndmask_b32 v9, v9, v4, vcc
    v_cndmask_b32 v10, v10, v4, vcc
    v_cndmask_b32 v11, v11, v4, vcc
    v_cndmask_b32 v12, v12, v4, vcc
    v_cndmask_b32 v13, v13, v4, vcc
    v_cndmask_b32 v14, v14, v4, vcc
    v_cndmask_b32 v15, v15, v4, vcc
    v_cmp_gt_u32 vcc, 20, v6
    s_nop 0
    s_and_saveexec_b64 s[40:41], vcc
    buffer_store_dwordx4 v[8:11], v5, s[28:31], s26 offen offset:1024 sc1
    buffer_store_dwordx4 v[12:15], v5, s[28:31], s26 offen offset:1664 sc1
    s_mov_b64 exec, s[40:41]
k3_kv_sig:
    s_lshl_b32 s26, s19, 1
    s_add_u32 s26, s26, s20
    s_lshl_b32 s26, s26, 7
    s_add_u32 s26, s26, 477184
    v_mov_b32 v4, s15
    s_waitcnt vmcnt(0)
    s_mov_b64 exec, 15
    buffer_store_dword v4, v63, s[28:31], s26 offen sc1
    s_mov_b64 exec, -1
k3_kv_b2:
    s_add_u32 s32, s16, 1306624
    s_addc_u32 s33, s17, 0
    s_mov_b32 s34, 155648
    s_mov_b32 s35, 0x00020000
    s_barrier
    s_cmp_eq_u32 s18, 10
    s_cbranch_scc1 k3_kv_nb
    v_lshlrev_b32 v5, 7, v2
    s_mul_i32 s26, s12, 88064
    s_add_u32 s26, s26, 477184
    s_add_u32 s25, s26, 8192
    s_mov_b32 s3, 0
k3_kv_poll:
    buffer_load_dword v8, v5, s[28:31], s26 offen sc1
    buffer_load_dword v9, v5, s[28:31], s25 offen sc1
    s_add_u32 s3, s3, 1
    s_waitcnt vmcnt(0)
    v_xor_b32 v8, s15, v8
    v_xor_b32 v9, s15, v9
    v_or_b32 v8, v8, v9
    v_cmp_eq_u32 vcc, 0, v8
    s_nop 0
    s_cmp_eq_u64 vcc, -1
    s_cbranch_scc1 k3_kv_go
    s_sleep 4
    s_cmp_lt_u32 s3, 0x40000
    s_cbranch_scc1 k3_kv_poll
k3_kv_go:
    s_mov_b32 s22, 0
k3_kv_dma:
    s_mov_b32 m0, s22
    s_nop 0
    buffer_load_dwordx4 v3, s[32:35], s22 offen sc1 lds
    buffer_load_dwordx4 v3, s[32:35], s22 offen offset:1024 sc1 lds
    buffer_load_dwordx4 v3, s[32:35], s22 offen offset:2048 sc1 lds
    buffer_load_dwordx4 v3, s[32:35], s22 offen offset:3072 sc1 lds
    s_add_u32 s22, s22, 4096
    s_cmp_lt_u32 s22, 36864
    s_cbranch_scc1 k3_kv_dma
k3_kv_nb:
    s_waitcnt vmcnt(20)
    s_barrier
    s_lshl_b32 s22, s18, 10
k3_helper:
    s_setprio 3
    s_cmp_ge_u32 s18, 10
    s_cbranch_scc1 k3_h_g
    s_sub_u32 s23, s18, 8
    s_mul_i32 s22, s23, 10240
    s_add_u32 s22, s22, 36864
    s_add_u32 s32, s16, 1306624
    s_addc_u32 s33, s17, 0
    s_mov_b32 s34, 155648
    s_mov_b32 s35, 0x00020000
    s_mov_b32 m0, s22
    s_nop 0
    buffer_load_dwordx4 v3, s[32:35], s22 offen offset:0 sc1 lds
    buffer_load_dwordx4 v3, s[32:35], s22 offen offset:1024 sc1 lds
    buffer_load_dwordx4 v3, s[32:35], s22 offen offset:2048 sc1 lds
    buffer_load_dwordx4 v3, s[32:35], s22 offen offset:3072 sc1 lds
    s_add_u32 s22, s22, 4096
    s_mov_b32 m0, s22
    s_nop 0
    buffer_load_dwordx4 v3, s[32:35], s22 offen offset:0 sc1 lds
    buffer_load_dwordx4 v3, s[32:35], s22 offen offset:1024 sc1 lds
    buffer_load_dwordx4 v3, s[32:35], s22 offen offset:2048 sc1 lds
    buffer_load_dwordx4 v3, s[32:35], s22 offen offset:3072 sc1 lds
    s_add_u32 s22, s22, 4096
    s_mov_b32 m0, s22
    s_nop 0
    buffer_load_dwordx4 v3, s[32:35], s22 offen offset:0 sc1 lds
    buffer_load_dwordx4 v3, s[32:35], s22 offen offset:1024 sc1 lds
    s_add_u32 s22, s22, 4096
    s_lshl_b32 s22, s23, 12
    s_add_u32 s22, s22, 57344
    s_waitcnt vmcnt(0)
    s_barrier
k3_h_dma:
    s_mov_b32 m0, s22
    s_nop 0
    buffer_load_dwordx4 v3, s[32:35], s22 offen sc1 lds
    buffer_load_dwordx4 v3, s[32:35], s22 offen offset:1024 sc1 lds
    buffer_load_dwordx4 v3, s[32:35], s22 offen offset:2048 sc1 lds
    buffer_load_dwordx4 v3, s[32:35], s22 offen offset:3072 sc1 lds
    s_add_u32 s22, s22, 8192
    s_cmp_lt_u32 s22, 155648
    s_cbranch_scc1 k3_h_dma
    s_branch k3_h_s3
k3_h_g:
    s_add_u32 s21, s14, 144
    s_add_u32 s22, s2, 400
    s_cmp_eq_u32 s18, 10
    s_cselect_b32 s21, s22, s21
    s_mov_b32 s13, 1
    s_cmp_lt_u32 s21, 432
    s_cbranch_scc1 k3_gemv
    s_barrier
k3_h_s3:
    s_waitcnt vmcnt(0)
    s_barrier
k3_h_work:
    s_cmp_lt_u32 s2, 240
    s_cbranch_scc1 k3_h_nopf
    s_cmp_lg_u32 s18, 11
    s_cbranch_scc1 k3_h_nopf
    s_getpc_b64 s[24:25]
k3_kernel_pc9:
    s_add_u32 s24, s24, k8_kernel - k3_kernel_pc9
    s_addc_u32 s25, s25, 0
    v_lshlrev_b32 v4, 7, v2
    v_min_u32 v4, k8_kernel_codeend - k8_kernel - 4, v4
    global_load_dword v147, v4, s[24:25]
    s_getpc_b64 s[24:25]
k3_kernel_pc10:
    s_add_u32 s24, s24, k8_kernel - k3_kernel_pc10
    s_addc_u32 s25, s25, 0
    v_lshlrev_b32 v4, 7, v2
    v_add_u32 v4, 8192, v4
    v_min_u32 v4, k8_kernel_codeend - k8_kernel - 4, v4
    global_load_dword v147, v4, s[24:25]
    s_getpc_b64 s[24:25]
k3_kernel_pc11:
    s_add_u32 s24, s24, k8_kernel - k3_kernel_pc11
    s_addc_u32 s25, s25, 0
    v_lshlrev_b32 v4, 7, v2
    v_add_u32 v4, 16384, v4
    v_min_u32 v4, k8_kernel_codeend - k8_kernel - 4, v4
    global_load_dword v147, v4, s[24:25]
    s_getpc_b64 s[24:25]
k3_kernel_pc12:
    s_add_u32 s24, s24, k8_kernel - k3_kernel_pc12
    s_addc_u32 s25, s25, 0
    v_lshlrev_b32 v4, 7, v2
    v_add_u32 v4, 24576, v4
    v_min_u32 v4, k8_kernel_codeend - k8_kernel - 4, v4
    global_load_dword v147, v4, s[24:25]
k3_h_nopf:
    s_and_b32 s21, s2, 7
    s_lshl_b32 s21, s21, 5
    s_lshr_b32 s22, s2, 3
    s_add_u32 s21, s21, s22
    s_sub_u32 s22, s18, 8
    s_lshl_b32 s22, s22, 8
    s_add_u32 s21, s21, s22
    s_cmp_ge_u32 s21, 648
    s_cbranch_scc1 k3_end
    s_mov_b32 s47, 0
    s_cmp_ge_u32 s21, 576
    s_cbranch_scc1 k3_h_wo
    v_and_b32 v4, 15, v2
    v_lshrrev_b32 v5, 4, v2
    v_lshrrev_b32 v6, 2, v4
    v_lshlrev_b32 v6, 3, v6
    v_and_b32 v7, 3, v4
    v_add_u32 v6, v6, v7
    s_mov_b32 s45, 3
    s_cmp_ge_u32 s21, 288
    s_cbranch_scc1 k3_h_w2
    v_lshlrev_b32 v9, 7, v2
    v_min_u32 v10, 1920, v9
    s_mul_i32 s22, s12, 88064
    s_add_u32 s22, s22, 433152
    s_add_u32 s23, s22, 8192
    s_add_u32 s24, s22, 16384
    s_mov_b32 s3, 0
k3_d_poll:
    buffer_load_dword v16, v9, s[28:31], s22 offen sc1
    buffer_load_dword v17, v9, s[28:31], s23 offen sc1
    buffer_load_dword v18, v10, s[28:31], s24 offen sc1
    s_add_u32 s3, s3, 1
    s_waitcnt vmcnt(0)
    v_xor_b32 v16, s15, v16
    v_xor_b32 v17, s15, v17
    v_xor_b32 v18, s15, v18
    v_or3_b32 v16, v16, v17, v18
    v_cmp_eq_u32 vcc, 0, v16
    s_nop 0
    s_cmp_eq_u64 vcc, -1
    s_cbranch_scc1 k3_d_ok
    s_sleep 8
    s_cmp_lt_u32 s3, 0x40000
    s_cbranch_scc1 k3_d_poll
k3_d_ok:
    s_mov_b32 s47, 1
    s_mul_i32 s22, s21, 3641
    s_lshr_b32 s22, s22, 16
    s_mul_i32 s23, s22, 18
    s_sub_u32 s23, s21, s23
    s_mov_b32 s24, s8
    s_mov_b32 s25, s9
    s_mov_b32 s26, 5308416
    s_mov_b32 s27, 0x00020000
    s_add_u32 s28, s16, 14659584
    s_addc_u32 s29, s17, 0
    s_mov_b32 s30, 5308416
    s_mov_b32 s31, 0x00020000
    s_add_u32 s32, s16, 16384
    s_addc_u32 s33, s17, 0
    s_mov_b32 s34, 6912
    s_mov_b32 s35, 0x00020000
    s_add_u32 s36, s16, 24576
    s_addc_u32 s37, s17, 0
    s_mov_b32 s38, 36864
    s_mov_b32 s39, 0x00020000
    s_movk_i32 s40, 9216
    s_mov_b32 s41, 221184
    s_mov_b32 s3, 73728
    v_mul_lo_u32 v7, v5, s3
    v_lshl_add_u32 v7, v6, 1, v7
    s_lshr_b32 s42, s21, 1
    s_lshl_b32 s42, s42, 5
    s_and_b32 s3, s21, 1
    s_lshl_b32 s3, s3, 2
    s_add_u32 s48, s42, s3
    s_mov_b32 s44, 3
    s_mov_b32 s43, 0
    s_mov_b32 s49, 0
    s_cmp_ge_u32 s23, 6
    s_cselect_b32 s44, 2, s44
    s_cselect_b32 s43, 102, s43
    s_cselect_b32 s49, 9, s49
    s_cmp_ge_u32 s23, 10
    s_cselect_b32 s44, 2, s44
    s_cselect_b32 s43, 170, s43
    s_cselect_b32 s49, 15, s49
    s_cmp_ge_u32 s23, 14
    s_cselect_b32 s44, 2, s44
    s_cselect_b32 s43, 238, s43
    s_cselect_b32 s49, 21, s49
    s_lshr_b32 s42, s23, 1
    s_add_u32 s49, s49, s42
    s_and_b32 s42, s22, 3
    s_mul_i32 s42, s42, s44
    s_add_u32 s49, s49, s42
    s_lshr_b32 s42, s22, 2
    s_mul_i32 s42, s42, 36
    s_add_u32 s49, s49, s42
    s_lshl_b32 s49, s49, 5
    s_add_u32 s49, s49, s3
    s_lshl_b32 s42, s49, 1
    s_add_u32 s43, s43, s23
    s_mul_i32 s3, s22, 324
    s_add_u32 s43, s43, s3
    s_lshl_b32 s43, s43, 10
    s_lshl_b32 s44, s44, 11
    v_and_b32 v8, 1, v2
    v_mul_u32_u24 v8, 1152, v8
    v_sub_u32 v8, 4608, v8
    v_lshl_add_u32 v8, v5, 4, v8
    s_mov_b32 s46, 0
    v_mov_b32 v112, 0
    v_mov_b32 v113, 0
    v_mov_b32 v114, 0
    v_mov_b32 v115, 0
    s_branch k3_h_loop
k3_h_w2:
    s_sub_u32 s21, s21, 288
    s_mul_i32 s22, s21, 1821
    s_lshr_b32 s22, s22, 16
    s_mul_i32 s23, s22, 36
    s_sub_u32 s23, s21, s23
    s_mul_i32 s46, s23, 7282
    s_lshr_b32 s46, s46, 16
    s_mul_i32 s3, s46, 9
    s_sub_u32 s23, s23, s3
    s_mov_b32 s24, s10
    s_mov_b32 s25, s11
    s_mov_b32 s26, 5308416
    s_mov_b32 s27, 0x00020000
    s_add_u32 s28, s16, 19968000
    s_addc_u32 s29, s17, 0
    s_mov_b32 s30, 5308416
    s_mov_b32 s31, 0x00020000
    s_lshr_b32 s3, s23, 1
    s_lshl_b32 s3, s3, 5
    s_and_b32 s42, s23, 1
    s_lshl_b32 s42, s42, 2
    s_add_u32 s3, s3, s42
    s_cmp_lt_u32 s23, 8
    s_cbranch_scc1 k3_h_w2a
    v_mov_b32 v6, v4
k3_h_w2a:
    s_movk_i32 s40, 1152
    s_movk_i32 s41, 27648
    v_mul_u32_u24 v7, 9216, v5
    v_lshl_add_u32 v7, v6, 1, v7
    s_mul_i32 s42, s46, 144
    s_add_u32 s42, s42, s3
    s_lshl_b32 s42, s42, 1
    s_mul_i32 s43, s22, 663552
    s_add_u32 s42, s42, s43
    s_mul_i32 s43, s46, 144
    s_mul_i32 s44, s22, 18
    s_add_u32 s43, s43, s44
    s_mul_i32 s43, s43, 9
    s_add_u32 s43, s43, s23
    s_lshl_b32 s43, s43, 10
    s_movk_i32 s44, 9216
    s_branch k3_h_loop
k3_h_wo:
    v_and_b32 v4, 15, v2
    v_lshrrev_b32 v5, 4, v2
    v_lshrrev_b32 v6, 2, v4
    v_lshlrev_b32 v6, 3, v6
    v_and_b32 v7, 3, v4
    v_add_u32 v6, v6, v7
    s_sub_u32 s21, s21, 576
    s_cmp_ge_u32 s21, 36
    s_cselect_b32 s22, 1, 0
    s_mul_i32 s23, s22, 36
    s_sub_u32 s23, s21, s23
    s_mul_i32 s46, s23, 86
    s_lshr_b32 s46, s46, 8
    s_mul_i32 s3, s46, 3
    s_sub_u32 s23, s23, s3
    s_mov_b32 s24, s4
    s_mov_b32 s25, s5
    s_mov_b32 s26, 663552
    s_mov_b32 s27, 0x00020000
    s_add_u32 s28, s16, 2461696
    s_addc_u32 s29, s17, 0
    s_mov_b32 s30, 663552
    s_mov_b32 s31, 0x00020000
    s_lshl_b32 s3, s23, 2
    s_cmp_lt_u32 s23, 2
    s_cbranch_scc1 k3_h_woa
    v_mov_b32 v6, v4
    s_mov_b32 s3, 32
k3_h_woa:
    s_mul_i32 s42, s46, 48
    s_add_u32 s42, s42, s3
    s_lshl_b32 s42, s42, 1
    s_mul_i32 s43, s46, 54
    s_movk_i32 s44, 3072
    v_lshrrev_b32 v7, 1, v5
    v_and_b32 v8, 1, v5
    s_cmp_eq_u32 s22, 1
    s_cbranch_scc1 k3_h_wo2
    s_add_u32 s30, s43, 48
    s_lshl_b32 s30, s30, 10
    s_add_u32 s43, s43, s23
    s_lshl_b32 s43, s43, 10
    s_movk_i32 s40, 1152
    s_movk_i32 s41, 32256
    v_mul_u32_u24 v7, 20736, v7
    v_mul_u32_u24 v8, 9216, v8
    v_add_u32 v7, v7, v8
    v_lshl_add_u32 v7, v6, 1, v7
    s_mov_b32 s45, 3
    s_branch k3_h_loop
k3_h_wo2:
    s_add_u32 s30, s43, 54
    s_lshl_b32 s30, s30, 10
    s_add_u32 s43, s43, 48
    s_add_u32 s43, s43, s23
    s_lshl_b32 s43, s43, 10
    s_movk_i32 s40, 20736
    s_mov_b32 s41, 165888
    v_mul_u32_u24 v7, 165888, v7
    v_mul_u32_u24 v8, 1152, v8
    v_add_u32 v7, v7, v8
    v_lshl_add_u32 v7, v6, 1, v7
    s_add_u32 s42, s42, 18432
    s_mov_b32 s45, 1
k3_h_loop:
    buffer_load_ushort v16, v7, s[24:27], s42 offen
    s_add_u32 s42, s42, s40
    buffer_load_ushort v17, v7, s[24:27], s42 offen
    s_add_u32 s42, s42, s40
    buffer_load_ushort v18, v7, s[24:27], s42 offen
    s_add_u32 s42, s42, s40
    buffer_load_ushort v19, v7, s[24:27], s42 offen
    s_add_u32 s42, s42, s40
    buffer_load_ushort v20, v7, s[24:27], s42 offen
    s_add_u32 s42, s42, s40
    buffer_load_ushort v21, v7, s[24:27], s42 offen
    s_add_u32 s42, s42, s40
    buffer_load_ushort v22, v7, s[24:27], s42 offen
    s_add_u32 s42, s42, s40
    buffer_load_ushort v23, v7, s[24:27], s42 offen
    s_add_u32 s42, s42, s40
    s_add_u32 s42, s42, s41
    buffer_load_ushort v24, v7, s[24:27], s42 offen
    s_add_u32 s42, s42, s40
    buffer_load_ushort v25, v7, s[24:27], s42 offen
    s_add_u32 s42, s42, s40
    buffer_load_ushort v26, v7, s[24:27], s42 offen
    s_add_u32 s42, s42, s40
    buffer_load_ushort v27, v7, s[24:27], s42 offen
    s_add_u32 s42, s42, s40
    buffer_load_ushort v28, v7, s[24:27], s42 offen
    s_add_u32 s42, s42, s40
    buffer_load_ushort v29, v7, s[24:27], s42 offen
    s_add_u32 s42, s42, s40
    buffer_load_ushort v30, v7, s[24:27], s42 offen
    s_add_u32 s42, s42, s40
    buffer_load_ushort v31, v7, s[24:27], s42 offen
    s_add_u32 s42, s42, s40
    s_add_u32 s42, s42, s41
    buffer_load_ushort v32, v7, s[24:27], s42 offen
    s_add_u32 s42, s42, s40
    buffer_load_ushort v33, v7, s[24:27], s42 offen
    s_add_u32 s42, s42, s40
    buffer_load_ushort v34, v7, s[24:27], s42 offen
    s_add_u32 s42, s42, s40
    buffer_load_ushort v35, v7, s[24:27], s42 offen
    s_add_u32 s42, s42, s40
    buffer_load_ushort v36, v7, s[24:27], s42 offen
    s_add_u32 s42, s42, s40
    buffer_load_ushort v37, v7, s[24:27], s42 offen
    s_add_u32 s42, s42, s40
    buffer_load_ushort v38, v7, s[24:27], s42 offen
    s_add_u32 s42, s42, s40
    buffer_load_ushort v39, v7, s[24:27], s42 offen
    s_add_u32 s42, s42, s40
    s_add_u32 s42, s42, s41
    buffer_load_ushort v40, v7, s[24:27], s42 offen
    s_add_u32 s42, s42, s40
    buffer_load_ushort v41, v7, s[24:27], s42 offen
    s_add_u32 s42, s42, s40
    buffer_load_ushort v42, v7, s[24:27], s42 offen
    s_add_u32 s42, s42, s40
    buffer_load_ushort v43, v7, s[24:27], s42 offen
    s_add_u32 s42, s42, s40
    buffer_load_ushort v44, v7, s[24:27], s42 offen
    s_add_u32 s42, s42, s40
    buffer_load_ushort v45, v7, s[24:27], s42 offen
    s_add_u32 s42, s42, s40
    buffer_load_ushort v46, v7, s[24:27], s42 offen
    s_add_u32 s42, s42, s40
    buffer_load_ushort v47, v7, s[24:27], s42 offen
    s_add_u32 s42, s42, s40
    s_add_u32 s42, s42, s41
    buffer_load_ushort v48, v7, s[24:27], s42 offen
    s_add_u32 s42, s42, s40
    buffer_load_ushort v49, v7, s[24:27], s42 offen
    s_add_u32 s42, s42, s40
    buffer_load_ushort v50, v7, s[24:27], s42 offen
    s_add_u32 s42, s42, s40
    buffer_load_ushort v51, v7, s[24:27], s42 offen
    s_add_u32 s42, s42, s40
    buffer_load_ushort v52, v7, s[24:27], s42 offen
    s_add_u32 s42, s42, s40
    buffer_load_ushort v53, v7, s[24:27], s42 offen
    s_add_u32 s42, s42, s40
    buffer_load_ushort v54, v7, s[24:27], s42 offen
    s_add_u32 s42, s42, s40
    buffer_load_ushort v55, v7, s[24:27], s42 offen
    s_add_u32 s42, s42, s40
    s_add_u32 s42, s42, s41
    buffer_load_ushort v56, v7, s[24:27], s42 offen
    s_add_u32 s42, s42, s40
    buffer_load_ushort v57, v7, s[24:27], s42 offen
    s_add_u32 s42, s42, s40
    buffer_load_ushort v58, v7, s[24:27], s42 offen
    s_add_u32 s42, s42, s40
    buffer_load_ushort v59, v7, s[24:27], s42 offen
    s_add_u32 s42, s42, s40
    buffer_load_ushort v60, v7, s[24:27], s42 offen
    s_add_u32 s42, s42, s40
    buffer_load_ushort v61, v7, s[24:27], s42 offen
    s_add_u32 s42, s42, s40
    buffer_load_ushort v62, v7, s[24:27], s42 offen
    s_add_u32 s42, s42, s40
    buffer_load_ushort v63, v7, s[24:27], s42 offen
    s_add_u32 s42, s42, s40
    s_add_u32 s42, s42, s41
    s_cmp_eq_u32 s47, 0
    s_cbranch_scc1 k3_h_nob
    buffer_load_dwordx4 v[88:91], v8, s[32:35], s46 offen offset:0 sc1
    buffer_load_dwordx4 v[92:95], v8, s[32:35], s46 offen offset:64 sc1
    buffer_load_dwordx4 v[96:99], v8, s[32:35], s46 offen offset:128 sc1
    buffer_load_dwordx4 v[100:103], v8, s[32:35], s46 offen offset:192 sc1
    buffer_load_dwordx4 v[104:107], v8, s[32:35], s46 offen offset:256 sc1
    buffer_load_dwordx4 v[108:111], v8, s[32:35], s46 offen offset:320 sc1
    s_add_u32 s46, s46, 384
k3_h_nob:
    s_waitcnt vmcnt(0)
    v_lshl_or_b32 v64, v17, 16, v16
    v_lshl_or_b32 v65, v19, 16, v18
    v_lshl_or_b32 v66, v21, 16, v20
    v_lshl_or_b32 v67, v23, 16, v22
    buffer_store_dwordx4 v[64:67], v3, s[28:31], s43 offen sc1
    s_add_u32 s43, s43, s44
    v_lshl_or_b32 v68, v25, 16, v24
    v_lshl_or_b32 v69, v27, 16, v26
    v_lshl_or_b32 v70, v29, 16, v28
    v_lshl_or_b32 v71, v31, 16, v30
    buffer_store_dwordx4 v[68:71], v3, s[28:31], s43 offen sc1
    s_add_u32 s43, s43, s44
    v_lshl_or_b32 v72, v33, 16, v32
    v_lshl_or_b32 v73, v35, 16, v34
    v_lshl_or_b32 v74, v37, 16, v36
    v_lshl_or_b32 v75, v39, 16, v38
    buffer_store_dwordx4 v[72:75], v3, s[28:31], s43 offen sc1
    s_add_u32 s43, s43, s44
    v_lshl_or_b32 v76, v41, 16, v40
    v_lshl_or_b32 v77, v43, 16, v42
    v_lshl_or_b32 v78, v45, 16, v44
    v_lshl_or_b32 v79, v47, 16, v46
    buffer_store_dwordx4 v[76:79], v3, s[28:31], s43 offen sc1
    s_add_u32 s43, s43, s44
    v_lshl_or_b32 v80, v49, 16, v48
    v_lshl_or_b32 v81, v51, 16, v50
    v_lshl_or_b32 v82, v53, 16, v52
    v_lshl_or_b32 v83, v55, 16, v54
    buffer_store_dwordx4 v[80:83], v3, s[28:31], s43 offen sc1
    s_add_u32 s43, s43, s44
    v_lshl_or_b32 v84, v57, 16, v56
    v_lshl_or_b32 v85, v59, 16, v58
    v_lshl_or_b32 v86, v61, 16, v60
    v_lshl_or_b32 v87, v63, 16, v62
    buffer_store_dwordx4 v[84:87], v3, s[28:31], s43 offen sc1
    s_add_u32 s43, s43, s44
    s_cmp_eq_u32 s47, 0
    s_cbranch_scc1 k3_h_nom
    v_mfma_f32_16x16x32_bf16 v[112:115], v[64:67], v[88:91], v[112:115]
    v_mfma_f32_16x16x32_bf16 v[112:115], v[68:71], v[92:95], v[112:115]
    v_mfma_f32_16x16x32_bf16 v[112:115], v[72:75], v[96:99], v[112:115]
    v_mfma_f32_16x16x32_bf16 v[112:115], v[76:79], v[100:103], v[112:115]
    v_mfma_f32_16x16x32_bf16 v[112:115], v[80:83], v[104:107], v[112:115]
    v_mfma_f32_16x16x32_bf16 v[112:115], v[84:87], v[108:111], v[112:115]
k3_h_nom:
    s_sub_u32 s45, s45, 1
    s_cmp_lg_u32 s45, 0
    s_cbranch_scc1 k3_h_loop
    s_cmp_eq_u32 s47, 0
    s_cbranch_scc1 k3_end
    v_mul_u32_u24 v8, 18432, v4
    v_lshl_add_u32 v8, v5, 5, v8
    s_lshl_b32 s3, s48, 2
    v_cmp_gt_u32 vcc, 2, v4
    s_nop 0
    s_and_saveexec_b64 s[40:41], vcc
    buffer_store_dwordx4 v[112:115], v8, s[36:39], s3 offen
    s_endpgm
k3_end:
    s_endpgm
k3_kernel_codeend:
.section .rodata,"a"
.p2align 6
.amdhsa_kernel k3_kernel
  .amdhsa_next_free_vgpr 148
  .amdhsa_next_free_sgpr 102
  .amdhsa_accum_offset 148
  .amdhsa_group_segment_fixed_size 0
  .amdhsa_kernarg_size 104
  .amdhsa_user_sgpr_count 2
  .amdhsa_user_sgpr_kernarg_segment_ptr 1
  .amdhsa_system_sgpr_workgroup_id_x 1
.end_amdhsa_kernel
.text
.globl k8_kernel
.p2align 12
.type k8_kernel,@function
k8_kernel:
    s_cmp_ge_u32 s2, 256
    s_cbranch_scc1 k8_end
    s_load_dwordx2 s[16:17], s[0:1], 96
    s_load_dwordx2 s[4:5], s[0:1], 0
    s_load_dwordx2 s[6:7], s[0:1], 80
    v_lshrrev_b32 v1, 6, v0
    v_and_b32 v2, 63, v0
    v_readfirstlane_b32 s18, v1
    v_lshlrev_b32 v3, 4, v2
    s_and_b32 s19, s2, 7
    s_lshr_b32 s20, s2, 3
    s_lshr_b32 s21, s19, 2
    s_lshl_b32 s21, s21, 3
    s_lshr_b32 s22, s20, 2
    s_add_u32 s21, s21, s22
    s_and_b32 s22, s19, 3
    s_lshl_b32 s22, s22, 2
    s_and_b32 s23, s20, 3
    s_add_u32 s22, s22, s23
    s_lshl_b32 s23, s21, 2
    s_add_u32 s23, s23, s18
    s_lshl_b32 s26, s18, 12
    v_and_b32 v4, 15, v2
    v_lshrrev_b32 v5, 4, v2
    v_add_u32 v6, 0x10000, v3
    v_add_u32 v7, 0x20000, v3
    s_and_b32 s20, s22, 3
    s_lshr_b32 s19, s22, 2
    s_mul_i32 s57, s19, 3
    s_add_u32 s57, s57, s20
    s_mul_i32 s40, s57, 55296
    s_add_u32 s40, s40, s26
    s_add_u32 s40, s40, 2461696
    s_mul_i32 s24, s23, 36864
    s_add_u32 s24, s24, 7581696
    s_add_u32 s25, s24, 18432
    s_mul_i32 s41, s22, 331776
    s_add_u32 s41, s41, s26
    s_add_u32 s41, s41, 14659584
    s_waitcnt lgkmcnt(0)
    s_mov_b32 s28, s16
    s_mov_b32 s29, s17
    s_mov_b32 s30, 53587968
    s_mov_b32 s31, 0x00020000
    s_cmp_eq_u32 s20, 3
    s_cbranch_scc1 k8_idle4
    s_add_u32 m0, s26, 0
    s_add_u32 s27, s40, 0
    buffer_load_dwordx4 v3, s[28:31], s27 offen offset:0 lds
    buffer_load_dwordx4 v3, s[28:31], s27 offen offset:1024 lds
    buffer_load_dwordx4 v3, s[28:31], s27 offen offset:2048 lds
    buffer_load_dwordx4 v3, s[28:31], s27 offen offset:3072 lds
    buffer_load_dwordx4 a[0:3], v3, s[28:31], s24 offen offset:0
    buffer_load_dwordx4 a[4:7], v3, s[28:31], s25 offen offset:0
    buffer_load_dwordx4 a[8:11], v3, s[28:31], s24 offen offset:1024
    buffer_load_dwordx4 a[12:15], v3, s[28:31], s25 offen offset:1024
    buffer_load_dwordx4 a[16:19], v3, s[28:31], s24 offen offset:2048
    buffer_load_dwordx4 a[20:23], v3, s[28:31], s25 offen offset:2048
    buffer_load_dwordx4 a[24:27], v3, s[28:31], s24 offen offset:3072
    buffer_load_dwordx4 a[28:31], v3, s[28:31], s25 offen offset:3072
    s_barrier
    s_add_u32 m0, s26, 16384
    s_add_u32 s27, s40, 16384
    buffer_load_dwordx4 v3, s[28:31], s27 offen offset:0 lds
    buffer_load_dwordx4 v3, s[28:31], s27 offen offset:1024 lds
    buffer_load_dwordx4 v3, s[28:31], s27 offen offset:2048 lds
    buffer_load_dwordx4 v3, s[28:31], s27 offen offset:3072 lds
    s_add_u32 s24, s24, 4096
    buffer_load_dwordx4 a[32:35], v3, s[28:31], s24 offen offset:0
    s_add_u32 s25, s25, 4096
    buffer_load_dwordx4 a[36:39], v3, s[28:31], s25 offen offset:0
    buffer_load_dwordx4 a[40:43], v3, s[28:31], s24 offen offset:1024
    buffer_load_dwordx4 a[44:47], v3, s[28:31], s25 offen offset:1024
    buffer_load_dwordx4 a[48:51], v3, s[28:31], s24 offen offset:2048
    buffer_load_dwordx4 a[52:55], v3, s[28:31], s25 offen offset:2048
    buffer_load_dwordx4 a[56:59], v3, s[28:31], s24 offen offset:3072
    buffer_load_dwordx4 a[60:63], v3, s[28:31], s25 offen offset:3072
    s_add_u32 s24, s24, 4096
    buffer_load_dwordx4 a[64:67], v3, s[28:31], s24 offen offset:0
    s_add_u32 s25, s25, 4096
    buffer_load_dwordx4 a[68:71], v3, s[28:31], s25 offen offset:0
    s_add_u32 m0, s26, 32768
    s_add_u32 s27, s40, 32768
    buffer_load_dwordx4 v3, s[28:31], s27 offen offset:0 lds
    buffer_load_dwordx4 v3, s[28:31], s27 offen offset:1024 lds
    buffer_load_dwordx4 v3, s[28:31], s27 offen offset:2048 lds
    buffer_load_dwordx4 v3, s[28:31], s27 offen offset:3072 lds
    s_add_u32 m0, s26, 49152
    s_add_u32 s27, s40, 49152
    buffer_load_dwordx4 v3, s[28:31], s27 offen offset:0 lds
    buffer_load_dwordx4 v3, s[28:31], s27 offen offset:1024 lds
    buffer_load_dwordx4 v3, s[28:31], s27 offen offset:2048 lds
    buffer_load_dwordx4 v3, s[28:31], s27 offen offset:3072 lds
    v_lshrrev_b32 v245, 1, v5
    v_lshlrev_b32 v245, 8, v245
    v_lshl_add_u32 v245, v4, 4, v245
    v_and_b32 v1, 1, v5
    v_lshl_add_u32 v245, v1, 3, v245
    v_mov_b32 v246, 1
    v_and_b32 v247, 3, v2
    v_lshlrev_b32 v247, 7, v247
    v_min_u32 v92, 11, v4
    v_lshlrev_b32 v92, 7, v92
    s_lshl_b32 s3, s57, 7
    v_add_u32 v93, s3, v3
    s_lshl_b32 s3, s20, 7
    v_add_u32 v94, s3, v3
    s_lshl_b32 s3, s19, 7
    v_add_u32 v95, s3, v3
    v_mov_b32 v244, 1
    s_mul_i32 s43, s21, 12288
    s_add_u32 s43, s43, 61440
    s_lshl_b32 s44, s19, 11
    s_add_u32 s44, s44, s43
    s_add_u32 s44, s44, 2048
    s_lshl_b32 s45, s20, 9
    s_add_u32 s45, s45, s43
    s_add_u32 s45, s45, 10240
    s_mul_i32 s42, s20, 144
    s_mul_i32 s3, s19, 36
    s_add_u32 s42, s42, s3
    s_mul_i32 s42, s42, 9216
    s_add_u32 s42, s42, s26
    s_add_u32 s42, s42, 19968000
    s_mov_b32 s32, s4
    s_mov_b32 s33, s5
    s_mov_b32 s34, 2359296
    s_mov_b32 s35, 0x00020000
    v_mul_u32_u24 v60, 1152, v4
    v_lshl_add_u32 v61, v5, 3, v60
    v_lshl_add_u32 v60, v5, 4, v60
    v_lshlrev_b32 v62, 4, v5
    v_lshlrev_b32 v63, 3, v5
    s_mul_i32 s46, s23, 36864
    s_mul_i32 s47, s57, 96
    s_add_u32 s46, s46, s47
    s_add_u32 s48, s46, 18432
    s_add_u32 s47, s47, 18688
    s_waitcnt vmcnt(30)
    s_barrier
    ds_read_b128 v[8:11], v3 offset:0
    ds_read_b128 v[12:15], v3 offset:1024
    ds_read_b128 v[16:19], v3 offset:2048
    ds_read_b128 v[20:23], v3 offset:3072
    ds_read_b128 v[24:27], v3 offset:4096
    ds_read_b128 v[28:31], v3 offset:5120
    s_waitcnt vmcnt(28) lgkmcnt(4)
    v_mfma_f32_16x16x32_bf16 v[96:99], v[8:11], a[0:3], 0
    ds_read_b128 v[32:35], v3 offset:6144
    buffer_load_dwordx4 a[72:75], v3, s[28:31], s24 offen offset:1024
    v_mfma_f32_16x16x32_bf16 v[100:103], v[8:11], a[4:7], 0
    v_mfma_f32_16x16x32_bf16 v[104:107], v[12:15], a[0:3], 0
    ds_read_b128 v[8:11], v3 offset:7168
    buffer_load_dwordx4 a[76:79], v3, s[28:31], s25 offen offset:1024
    v_mfma_f32_16x16x32_bf16 v[108:111], v[12:15], a[4:7], 0
    s_waitcnt lgkmcnt(4)
    v_mfma_f32_16x16x32_bf16 v[112:115], v[16:19], a[0:3], 0
    ds_read_b128 v[12:15], v3 offset:8192
    buffer_load_dwordx4 a[80:83], v3, s[28:31], s24 offen offset:2048
    v_mfma_f32_16x16x32_bf16 v[116:119], v[16:19], a[4:7], 0
    s_waitcnt vmcnt(29)
    v_mfma_f32_16x16x32_bf16 v[96:99], v[20:23], a[8:11], v[96:99]
    ds_read_b128 v[16:19], v3 offset:9216
    buffer_load_dwordx4 a[84:87], v3, s[28:31], s25 offen offset:2048
    v_mfma_f32_16x16x32_bf16 v[100:103], v[20:23], a[12:15], v[100:103]
    s_waitcnt lgkmcnt(4)
    v_mfma_f32_16x16x32_bf16 v[104:107], v[24:27], a[8:11], v[104:107]
    ds_read_b128 v[20:23], v3 offset:10240
    buffer_load_dwordx4 a[88:91], v3, s[28:31], s24 offen offset:3072
    v_mfma_f32_16x16x32_bf16 v[108:111], v[24:27], a[12:15], v[108:111]
    v_mfma_f32_16x16x32_bf16 v[112:115], v[28:31], a[8:11], v[112:115]
    ds_read_b128 v[24:27], v3 offset:11264
    buffer_load_dwordx4 a[92:95], v3, s[28:31], s25 offen offset:3072
    v_mfma_f32_16x16x32_bf16 v[116:119], v[28:31], a[12:15], v[116:119]
    s_waitcnt vmcnt(30) lgkmcnt(4)
    v_mfma_f32_16x16x32_bf16 v[96:99], v[32:35], a[16:19], v[96:99]
    ds_read_b128 v[28:31], v3 offset:12288
    s_add_u32 s24, s24, 4096
    v_mfma_f32_16x16x32_bf16 v[100:103], v[32:35], a[20:23], v[100:103]
    buffer_load_dwordx4 a[96:99], v3, s[28:31], s24 offen offset:0
    v_mfma_f32_16x16x32_bf16 v[104:107], v[8:11], a[16:19], v[104:107]
    ds_read_b128 v[32:35], v3 offset:13312
    s_add_u32 s25, s25, 4096
    v_mfma_f32_16x16x32_bf16 v[108:111], v[8:11], a[20:23], v[108:111]
    buffer_load_dwordx4 a[100:103], v3, s[28:31], s25 offen offset:0
    s_waitcnt lgkmcnt(4)
    v_mfma_f32_16x16x32_bf16 v[112:115], v[12:15], a[16:19], v[112:115]
    ds_read_b128 v[8:11], v3 offset:14336
    buffer_load_dwordx4 a[104:107], v3, s[28:31], s24 offen offset:1024
    v_mfma_f32_16x16x32_bf16 v[116:119], v[12:15], a[20:23], v[116:119]
    s_waitcnt vmcnt(31)
    v_mfma_f32_16x16x32_bf16 v[96:99], v[16:19], a[24:27], v[96:99]
    ds_read_b128 v[12:15], v3 offset:15360
    buffer_load_dwordx4 a[108:111], v3, s[28:31], s25 offen offset:1024
    v_mfma_f32_16x16x32_bf16 v[100:103], v[16:19], a[28:31], v[100:103]
    s_waitcnt vmcnt(28)
    s_barrier
    s_waitcnt lgkmcnt(4)
    v_mfma_f32_16x16x32_bf16 v[104:107], v[20:23], a[24:27], v[104:107]
    ds_read_b128 v[16:19], v3 offset:16384
    buffer_load_dwordx4 a[112:115], v3, s[28:31], s24 offen offset:2048
    v_mfma_f32_16x16x32_bf16 v[108:111], v[20:23], a[28:31], v[108:111]
    v_mfma_f32_16x16x32_bf16 v[112:115], v[24:27], a[24:27], v[112:115]
    ds_read_b128 v[20:23], v3 offset:17408
    buffer_load_dwordx4 a[116:119], v3, s[28:31], s25 offen offset:2048
    v_mfma_f32_16x16x32_bf16 v[116:119], v[24:27], a[28:31], v[116:119]
    s_waitcnt vmcnt(28) lgkmcnt(4)
    v_mfma_f32_16x16x32_bf16 v[96:99], v[28:31], a[32:35], v[96:99]
    ds_read_b128 v[24:27], v3 offset:18432
    buffer_load_dwordx4 a[120:123], v3, s[28:31], s24 offen offset:3072
    v_mfma_f32_16x16x32_bf16 v[100:103], v[28:31], a[36:39], v[100:103]
    v_mfma_f32_16x16x32_bf16 v[104:107], v[32:35], a[32:35], v[104:107]
    ds_read_b128 v[28:31], v3 offset:19456
    buffer_load_dwordx4 a[124:127], v3, s[28:31], s25 offen offset:3072
    v_mfma_f32_16x16x32_bf16 v[108:111], v[32:35], a[36:39], v[108:111]
    s_waitcnt lgkmcnt(4)
    v_mfma_f32_16x16x32_bf16 v[112:115], v[8:11], a[32:35], v[112:115]
    ds_read_b128 v[32:35], v3 offset:20480
    s_add_u32 s24, s24, 4096
    v_mfma_f32_16x16x32_bf16 v[116:119], v[8:11], a[36:39], v[116:119]
    buffer_load_dwordx4 a[128:131], v3, s[28:31], s24 offen offset:0
    s_waitcnt vmcnt(29)
    v_mfma_f32_16x16x32_bf16 v[96:99], v[12:15], a[40:43], v[96:99]
    ds_read_b128 v[8:11], v3 offset:21504
    s_add_u32 s25, s25, 4096
    v_mfma_f32_16x16x32_bf16 v[100:103], v[12:15], a[44:47], v[100:103]
    buffer_load_dwordx4 a[132:135], v3, s[28:31], s25 offen offset:0
    s_waitcnt lgkmcnt(4)
    v_mfma_f32_16x16x32_bf16 v[104:107], v[16:19], a[40:43], v[104:107]
    ds_read_b128 v[12:15], v3 offset:22528
    buffer_load_dwordx4 a[136:139], v3, s[28:31], s24 offen offset:1024
    v_mfma_f32_16x16x32_bf16 v[108:111], v[16:19], a[44:47], v[108:111]
    v_mfma_f32_16x16x32_bf16 v[112:115], v[20:23], a[40:43], v[112:115]
    ds_read_b128 v[16:19], v3 offset:23552
    buffer_load_dwordx4 a[140:143], v3, s[28:31], s25 offen offset:1024
    v_mfma_f32_16x16x32_bf16 v[116:119], v[20:23], a[44:47], v[116:119]
    s_waitcnt vmcnt(30) lgkmcnt(4)
    v_mfma_f32_16x16x32_bf16 v[96:99], v[24:27], a[48:51], v[96:99]
    ds_read_b128 v[20:23], v3 offset:24576
    buffer_load_dwordx4 v[36:39], v60, s[32:35], s46 offen
    v_mfma_f32_16x16x32_bf16 v[100:103], v[24:27], a[52:55], v[100:103]
    v_mfma_f32_16x16x32_bf16 v[104:107], v[28:31], a[48:51], v[104:107]
    ds_read_b128 v[24:27], v3 offset:25600
    buffer_load_dwordx2 v[40:41], v61, s[32:35], s46 offen offset:64
    v_mfma_f32_16x16x32_bf16 v[108:111], v[28:31], a[52:55], v[108:111]
    s_waitcnt lgkmcnt(4)
    v_mfma_f32_16x16x32_bf16 v[112:115], v[32:35], a[48:51], v[112:115]
    ds_read_b128 v[28:31], v3 offset:26624
    buffer_load_dwordx4 v[42:45], v60, s[32:35], s48 offen
    v_mfma_f32_16x16x32_bf16 v[116:119], v[32:35], a[52:55], v[116:119]
    s_waitcnt vmcnt(31)
    v_mfma_f32_16x16x32_bf16 v[96:99], v[8:11], a[56:59], v[96:99]
    ds_read_b128 v[32:35], v3 offset:27648
    buffer_load_dwordx2 v[46:47], v61, s[32:35], s48 offen offset:64
    v_mfma_f32_16x16x32_bf16 v[100:103], v[8:11], a[60:63], v[100:103]
    s_waitcnt lgkmcnt(4)
    v_mfma_f32_16x16x32_bf16 v[104:107], v[12:15], a[56:59], v[104:107]
    ds_read_b128 v[8:11], v3 offset:28672
    buffer_load_dwordx4 v[48:51], v62, s[28:31], s47 offen
    v_mfma_f32_16x16x32_bf16 v[108:111], v[12:15], a[60:63], v[108:111]
    v_mfma_f32_16x16x32_bf16 v[112:115], v[16:19], a[56:59], v[112:115]
    ds_read_b128 v[12:15], v3 offset:29696
    buffer_load_dwordx2 v[52:53], v63, s[28:31], s47 offen offset:64
    v_mfma_f32_16x16x32_bf16 v[116:119], v[16:19], a[60:63], v[116:119]
    s_waitcnt vmcnt(32) lgkmcnt(4)
    v_mfma_f32_16x16x32_bf16 v[96:99], v[20:23], a[64:67], v[96:99]
    ds_read_b128 v[16:19], v3 offset:30720
    buffer_load_dwordx4 v[54:57], v62, s[28:31], s47 offen offset:2304
    v_mfma_f32_16x16x32_bf16 v[100:103], v[20:23], a[68:71], v[100:103]
    v_mfma_f32_16x16x32_bf16 v[104:107], v[24:27], a[64:67], v[104:107]
    ds_read_b128 v[20:23], v3 offset:31744
    buffer_load_dwordx2 v[58:59], v63, s[28:31], s47 offen offset:2368
    v_mfma_f32_16x16x32_bf16 v[108:111], v[24:27], a[68:71], v[108:111]
    s_waitcnt vmcnt(26)
    s_barrier
    s_waitcnt lgkmcnt(4)
    v_mfma_f32_16x16x32_bf16 v[112:115], v[28:31], a[64:67], v[112:115]
    ds_read_b128 v[24:27], v3 offset:32768
    v_mfma_f32_16x16x32_bf16 v[116:119], v[28:31], a[68:71], v[116:119]
    s_waitcnt vmcnt(24)
    v_mfma_f32_16x16x32_bf16 v[96:99], v[32:35], a[72:75], v[96:99]
    ds_read_b128 v[28:31], v3 offset:33792
    v_mfma_f32_16x16x32_bf16 v[100:103], v[32:35], a[76:79], v[100:103]
    s_waitcnt lgkmcnt(4)
    v_mfma_f32_16x16x32_bf16 v[104:107], v[8:11], a[72:75], v[104:107]
    ds_read_b128 v[32:35], v3 offset:34816
    v_mfma_f32_16x16x32_bf16 v[108:111], v[8:11], a[76:79], v[108:111]
    v_mfma_f32_16x16x32_bf16 v[112:115], v[12:15], a[72:75], v[112:115]
    ds_read_b128 v[8:11], v3 offset:35840
    v_mfma_f32_16x16x32_bf16 v[116:119], v[12:15], a[76:79], v[116:119]
    s_waitcnt vmcnt(22) lgkmcnt(4)
    v_mfma_f32_16x16x32_bf16 v[96:99], v[16:19], a[80:83], v[96:99]
    ds_read_b128 v[12:15], v3 offset:36864
    v_mfma_f32_16x16x32_bf16 v[100:103], v[16:19], a[84:87], v[100:103]
    v_mfma_f32_16x16x32_bf16 v[104:107], v[20:23], a[80:83], v[104:107]
    ds_read_b128 v[16:19], v3 offset:37888
    v_mfma_f32_16x16x32_bf16 v[108:111], v[20:23], a[84:87], v[108:111]
    s_waitcnt lgkmcnt(4)
    v_mfma_f32_16x16x32_bf16 v[112:115], v[24:27], a[80:83], v[112:115]
    ds_read_b128 v[20:23], v3 offset:38912
    v_mfma_f32_16x16x32_bf16 v[116:119], v[24:27], a[84:87], v[116:119]
    s_waitcnt vmcnt(20)
    v_mfma_f32_16x16x32_bf16 v[96:99], v[28:31], a[88:91], v[96:99]
    ds_read_b128 v[24:27], v3 offset:39936
    v_mfma_f32_16x16x32_bf16 v[100:103], v[28:31], a[92:95], v[100:103]
    s_waitcnt lgkmcnt(4)
    v_mfma_f32_16x16x32_bf16 v[104:107], v[32:35], a[88:91], v[104:107]
    ds_read_b128 v[28:31], v3 offset:40960
    v_mfma_f32_16x16x32_bf16 v[108:111], v[32:35], a[92:95], v[108:111]
    v_mfma_f32_16x16x32_bf16 v[112:115], v[8:11], a[88:91], v[112:115]
    ds_read_b128 v[32:35], v3 offset:41984
    v_mfma_f32_16x16x32_bf16 v[116:119], v[8:11], a[92:95], v[116:119]
    s_waitcnt vmcnt(18) lgkmcnt(4)
    v_mfma_f32_16x16x32_bf16 v[96:99], v[12:15], a[96:99], v[96:99]
    ds_read_b128 v[8:11], v3 offset:43008
    v_mfma_f32_16x16x32_bf16 v[100:103], v[12:15], a[100:103], v[100:103]
    v_mfma_f32_16x16x32_bf16 v[104:107], v[16:19], a[96:99], v[104:107]
    ds_read_b128 v[12:15], v3 offset:44032
    v_mfma_f32_16x16x32_bf16 v[108:111], v[16:19], a[100:103], v[108:111]
    s_waitcnt lgkmcnt(4)
    v_mfma_f32_16x16x32_bf16 v[112:115], v[20:23], a[96:99], v[112:115]
    ds_read_b128 v[16:19], v3 offset:45056
    v_mfma_f32_16x16x32_bf16 v[116:119], v[20:23], a[100:103], v[116:119]
    s_waitcnt vmcnt(16)
    v_mfma_f32_16x16x32_bf16 v[96:99], v[24:27], a[104:107], v[96:99]
    ds_read_b128 v[20:23], v3 offset:46080
    v_mfma_f32_16x16x32_bf16 v[100:103], v[24:27], a[108:111], v[100:103]
    s_waitcnt lgkmcnt(4)
    v_mfma_f32_16x16x32_bf16 v[104:107], v[28:31], a[104:107], v[104:107]
    ds_read_b128 v[24:27], v3 offset:47104
    v_mfma_f32_16x16x32_bf16 v[108:111], v[28:31], a[108:111], v[108:111]
    v_mfma_f32_16x16x32_bf16 v[112:115], v[32:35], a[104:107], v[112:115]
    ds_read_b128 v[28:31], v3 offset:48128
    v_mfma_f32_16x16x32_bf16 v[116:119], v[32:35], a[108:111], v[116:119]
    s_waitcnt vmcnt(14) lgkmcnt(4)
    v_mfma_f32_16x16x32_bf16 v[96:99], v[8:11], a[112:115], v[96:99]
    ds_read_b128 v[32:35], v3 offset:49152
    v_mfma_f32_16x16x32_bf16 v[100:103], v[8:11], a[116:119], v[100:103]
    v_mfma_f32_16x16x32_bf16 v[104:107], v[12:15], a[112:115], v[104:107]
    ds_read_b128 v[8:11], v3 offset:50176
    v_mfma_f32_16x16x32_bf16 v[108:111], v[12:15], a[116:119], v[108:111]
    s_waitcnt lgkmcnt(4)
    v_mfma_f32_16x16x32_bf16 v[112:115], v[16:19], a[112:115], v[112:115]
    ds_read_b128 v[12:15], v3 offset:51200
    v_mfma_f32_16x16x32_bf16 v[116:119], v[16:19], a[116:119], v[116:119]
    s_waitcnt vmcnt(12)
    v_mfma_f32_16x16x32_bf16 v[96:99], v[20:23], a[120:123], v[96:99]
    ds_read_b128 v[16:19], v3 offset:52224
    v_mfma_f32_16x16x32_bf16 v[100:103], v[20:23], a[124:127], v[100:103]
    s_waitcnt lgkmcnt(4)
    v_mfma_f32_16x16x32_bf16 v[104:107], v[24:27], a[120:123], v[104:107]
    ds_read_b128 v[20:23], v3 offset:53248
    v_mfma_f32_16x16x32_bf16 v[108:111], v[24:27], a[124:127], v[108:111]
    v_mfma_f32_16x16x32_bf16 v[112:115], v[28:31], a[120:123], v[112:115]
    ds_read_b128 v[24:27], v3 offset:54272
    v_mfma_f32_16x16x32_bf16 v[116:119], v[28:31], a[124:127], v[116:119]
    s_waitcnt vmcnt(10) lgkmcnt(4)
    v_mfma_f32_16x16x32_bf16 v[96:99], v[32:35], a[128:131], v[96:99]
    v_mfma_f32_16x16x32_bf16 v[100:103], v[32:35], a[132:135], v[100:103]
    v_mfma_f32_16x16x32_bf16 v[104:107], v[8:11], a[128:131], v[104:107]
    v_mfma_f32_16x16x32_bf16 v[108:111], v[8:11], a[132:135], v[108:111]
    s_waitcnt lgkmcnt(2)
    v_mfma_f32_16x16x32_bf16 v[112:115], v[12:15], a[128:131], v[112:115]
    v_mfma_f32_16x16x32_bf16 v[116:119], v[12:15], a[132:135], v[116:119]
    s_waitcnt vmcnt(8)
    v_mfma_f32_16x16x32_bf16 v[96:99], v[16:19], a[136:139], v[96:99]
    v_mfma_f32_16x16x32_bf16 v[100:103], v[16:19], a[140:143], v[100:103]
    s_waitcnt lgkmcnt(0)
    v_mfma_f32_16x16x32_bf16 v[104:107], v[20:23], a[136:139], v[104:107]
    v_mfma_f32_16x16x32_bf16 v[108:111], v[20:23], a[140:143], v[108:111]
    v_mfma_f32_16x16x32_bf16 v[112:115], v[24:27], a[136:139], v[112:115]
    v_mfma_f32_16x16x32_bf16 v[116:119], v[24:27], a[140:143], v[116:119]
    s_mov_b32 s3, 0xffff0000
    v_lshlrev_b32 v61, 3, v4
    s_mul_i32 s46, s23, 36864
    s_mul_i32 s47, s57, 1536
    s_add_u32 s46, s46, s47
    s_add_u32 s46, s46, 12300288
    s_add_u32 s47, s46, 18432
    s_add_u32 s50, s46, -2359296
    s_add_u32 s51, s47, -2359296
    s_lshl_b32 s48, s57, 14
    s_lshl_b32 s49, s23, 8
    s_add_u32 s48, s48, s49
    s_add_u32 s48, s48, 1110016
    s_waitcnt vmcnt(0)
    v_lshlrev_b32 v8, 16, v48
    v_and_b32 v9, s3, v48
    v_lshlrev_b32 v20, 16, v54
    v_and_b32 v21, s3, v54
    v_lshlrev_b32 v10, 16, v49
    v_and_b32 v11, s3, v49
    v_lshlrev_b32 v22, 16, v55
    v_and_b32 v23, s3, v55
    v_lshlrev_b32 v12, 16, v50
    v_and_b32 v13, s3, v50
    v_lshlrev_b32 v24, 16, v56
    v_and_b32 v25, s3, v56
    v_lshlrev_b32 v14, 16, v51
    v_and_b32 v15, s3, v51
    v_lshlrev_b32 v26, 16, v57
    v_and_b32 v27, s3, v57
    v_lshlrev_b32 v16, 16, v52
    v_and_b32 v17, s3, v52
    v_lshlrev_b32 v28, 16, v58
    v_and_b32 v29, s3, v58
    v_lshlrev_b32 v18, 16, v53
    v_and_b32 v19, s3, v53
    v_lshlrev_b32 v30, 16, v59
    v_and_b32 v31, s3, v59
    v_lshlrev_b32 v64, 16, v36
    v_and_b32 v65, s3, v36
    v_lshlrev_b32 v66, 16, v37
    v_and_b32 v67, s3, v37
    v_lshlrev_b32 v68, 16, v38
    v_and_b32 v69, s3, v38
    v_lshlrev_b32 v70, 16, v39
    v_and_b32 v71, s3, v39
    v_lshlrev_b32 v72, 16, v40
    v_and_b32 v73, s3, v40
    v_lshlrev_b32 v74, 16, v41
    v_and_b32 v75, s3, v41
    v_fmac_f32 v64, v96, v8
    v_fmac_f32 v65, v97, v9
    v_fmac_f32 v66, v98, v10
    v_fmac_f32 v67, v99, v11
    v_fmac_f32 v68, v104, v12
    v_fmac_f32 v69, v105, v13
    v_fmac_f32 v70, v106, v14
    v_fmac_f32 v71, v107, v15
    v_fmac_f32 v72, v112, v16
    v_fmac_f32 v73, v113, v17
    v_fmac_f32 v74, v114, v18
    v_fmac_f32 v75, v115, v19
    v_cvt_pk_bf16_f32 v120, v64, v65
    v_cvt_pk_bf16_f32 v121, v66, v67
    v_cvt_pk_bf16_f32 v122, v68, v69
    v_cvt_pk_bf16_f32 v123, v70, v71
    v_cvt_pk_bf16_f32 v124, v72, v73
    v_cvt_pk_bf16_f32 v125, v74, v75
    v_lshlrev_b32 v64, 16, v120
    v_and_b32 v65, s3, v120
    v_lshlrev_b32 v66, 16, v121
    v_and_b32 v67, s3, v121
    v_lshlrev_b32 v68, 16, v122
    v_and_b32 v69, s3, v122
    v_lshlrev_b32 v70, 16, v123
    v_and_b32 v71, s3, v123
    v_lshlrev_b32 v72, 16, v124
    v_and_b32 v73, s3, v124
    v_lshlrev_b32 v74, 16, v125
    v_and_b32 v75, s3, v125
    v_mul_f32 v96, v64, v20
    v_mul_f32 v97, v65, v21
    v_mul_f32 v98, v66, v22
    v_mul_f32 v99, v67, v23
    v_mul_f32 v104, v68, v24
    v_mul_f32 v105, v69, v25
    v_mul_f32 v106, v70, v26
    v_mul_f32 v107, v71, v27
    v_mul_f32 v112, v72, v28
    v_mul_f32 v113, v73, v29
    v_mul_f32 v114, v74, v30
    v_mul_f32 v115, v75, v31
    v_cvt_pk_bf16_f32 v128, v96, v97
    v_cvt_pk_bf16_f32 v129, v98, v99
    v_cvt_pk_bf16_f32 v130, v104, v105
    v_cvt_pk_bf16_f32 v131, v106, v107
    v_cvt_pk_bf16_f32 v132, v112, v113
    v_cvt_pk_bf16_f32 v133, v114, v115
    buffer_store_dwordx4 v[128:131], v3, s[28:31], s46 offen sc1
    buffer_store_dwordx2 v[132:133], v245, s[28:31], s46 offen offset:1024 sc1
    v_lshlrev_b32 v80, 16, v42
    v_and_b32 v81, s3, v42
    v_lshlrev_b32 v82, 16, v43
    v_and_b32 v83, s3, v43
    v_lshlrev_b32 v84, 16, v44
    v_and_b32 v85, s3, v44
    v_lshlrev_b32 v86, 16, v45
    v_and_b32 v87, s3, v45
    v_lshlrev_b32 v88, 16, v46
    v_and_b32 v89, s3, v46
    v_lshlrev_b32 v90, 16, v47
    v_and_b32 v91, s3, v47
    v_fmac_f32 v80, v100, v8
    v_fmac_f32 v81, v101, v9
    v_fmac_f32 v82, v102, v10
    v_fmac_f32 v83, v103, v11
    v_fmac_f32 v84, v108, v12
    v_fmac_f32 v85, v109, v13
    v_fmac_f32 v86, v110, v14
    v_fmac_f32 v87, v111, v15
    v_fmac_f32 v88, v116, v16
    v_fmac_f32 v89, v117, v17
    v_fmac_f32 v90, v118, v18
    v_fmac_f32 v91, v119, v19
    v_cvt_pk_bf16_f32 v136, v80, v81
    v_cvt_pk_bf16_f32 v137, v82, v83
    v_cvt_pk_bf16_f32 v138, v84, v85
    v_cvt_pk_bf16_f32 v139, v86, v87
    v_cvt_pk_bf16_f32 v140, v88, v89
    v_cvt_pk_bf16_f32 v141, v90, v91
    v_lshlrev_b32 v80, 16, v136
    v_and_b32 v81, s3, v136
    v_lshlrev_b32 v82, 16, v137
    v_and_b32 v83, s3, v137
    v_lshlrev_b32 v84, 16, v138
    v_and_b32 v85, s3, v138
    v_lshlrev_b32 v86, 16, v139
    v_and_b32 v87, s3, v139
    v_lshlrev_b32 v88, 16, v140
    v_and_b32 v89, s3, v140
    v_lshlrev_b32 v90, 16, v141
    v_and_b32 v91, s3, v141
    v_mul_f32 v100, v80, v20
    v_mul_f32 v101, v81, v21
    v_mul_f32 v102, v82, v22
    v_mul_f32 v103, v83, v23
    v_mul_f32 v108, v84, v24
    v_mul_f32 v109, v85, v25
    v_mul_f32 v110, v86, v26
    v_mul_f32 v111, v87, v27
    v_mul_f32 v116, v88, v28
    v_mul_f32 v117, v89, v29
    v_mul_f32 v118, v90, v30
    v_mul_f32 v119, v91, v31
    v_cvt_pk_bf16_f32 v144, v100, v101
    v_cvt_pk_bf16_f32 v145, v102, v103
    v_cvt_pk_bf16_f32 v146, v108, v109
    v_cvt_pk_bf16_f32 v147, v110, v111
    v_cvt_pk_bf16_f32 v148, v116, v117
    v_cvt_pk_bf16_f32 v149, v118, v119
    buffer_store_dwordx4 v[144:147], v3, s[28:31], s47 offen sc1
    buffer_store_dwordx2 v[148:149], v245, s[28:31], s47 offen offset:1024 sc1
    v_add_f32 v32, v64, v65
    v_add_f32 v36, v80, v81
    v_add_f32 v32, v32, v66
    v_add_f32 v36, v36, v82
    v_add_f32 v32, v32, v67
    v_add_f32 v36, v36, v83
    v_add_f32 v32, v32, v68
    v_add_f32 v36, v36, v84
    v_add_f32 v32, v32, v69
    v_add_f32 v36, v36, v85
    v_add_f32 v32, v32, v70
    v_add_f32 v36, v36, v86
    v_add_f32 v32, v32, v71
    v_add_f32 v36, v36, v87
    v_add_f32 v32, v32, v72
    v_add_f32 v36, v36, v88
    v_add_f32 v32, v32, v73
    v_add_f32 v36, v36, v89
    v_add_f32 v32, v32, v74
    v_add_f32 v36, v36, v90
    v_add_f32 v32, v32, v75
    v_add_f32 v36, v36, v91
    v_mov_b32 v34, v32
    v_mov_b32 v38, v36
    s_nop 0
    v_permlane32_swap_b32 v32, v34
    v_permlane32_swap_b32 v36, v38
    v_add_f32 v32, v32, v34
    v_add_f32 v36, v36, v38
    v_mov_b32 v34, v32
    v_mov_b32 v38, v36
    s_nop 0
    v_permlane16_swap_b32 v32, v34
    v_permlane16_swap_b32 v36, v38
    v_add_f32 v32, v32, v34
    v_add_f32 v36, v36, v38
    v_mul_f32 v34, 0x3caaaaab, v32
    v_mul_f32 v38, 0x3caaaaab, v36
    v_sub_f32 v64, v64, v34
    v_sub_f32 v80, v80, v38
    v_sub_f32 v65, v65, v34
    v_sub_f32 v81, v81, v38
    v_sub_f32 v66, v66, v34
    v_sub_f32 v82, v82, v38
    v_sub_f32 v67, v67, v34
    v_sub_f32 v83, v83, v38
    v_sub_f32 v68, v68, v34
    v_sub_f32 v84, v84, v38
    v_sub_f32 v69, v69, v34
    v_sub_f32 v85, v85, v38
    v_sub_f32 v70, v70, v34
    v_sub_f32 v86, v86, v38
    v_sub_f32 v71, v71, v34
    v_sub_f32 v87, v87, v38
    v_sub_f32 v72, v72, v34
    v_sub_f32 v88, v88, v38
    v_sub_f32 v73, v73, v34
    v_sub_f32 v89, v89, v38
    v_sub_f32 v74, v74, v34
    v_sub_f32 v90, v90, v38
    v_sub_f32 v75, v75, v34
    v_sub_f32 v91, v91, v38
    v_mul_f32 v33, v64, v64
    v_mul_f32 v37, v80, v80
    v_fmac_f32 v33, v65, v65
    v_fmac_f32 v37, v81, v81
    v_fmac_f32 v33, v66, v66
    v_fmac_f32 v37, v82, v82
    v_fmac_f32 v33, v67, v67
    v_fmac_f32 v37, v83, v83
    v_fmac_f32 v33, v68, v68
    v_fmac_f32 v37, v84, v84
    v_fmac_f32 v33, v69, v69
    v_fmac_f32 v37, v85, v85
    v_fmac_f32 v33, v70, v70
    v_fmac_f32 v37, v86, v86
    v_fmac_f32 v33, v71, v71
    v_fmac_f32 v37, v87, v87
    v_fmac_f32 v33, v72, v72
    v_fmac_f32 v37, v88, v88
    v_fmac_f32 v33, v73, v73
    v_fmac_f32 v37, v89, v89
    v_fmac_f32 v33, v74, v74
    v_fmac_f32 v37, v90, v90
    v_fmac_f32 v33, v75, v75
    v_fmac_f32 v37, v91, v91
    v_mov_b32 v34, v33
    v_mov_b32 v38, v37
    s_nop 0
    v_permlane32_swap_b32 v33, v34
    v_permlane32_swap_b32 v37, v38
    v_add_f32 v33, v33, v34
    v_add_f32 v37, v37, v38
    v_mov_b32 v34, v33
    v_mov_b32 v38, v37
    s_nop 0
    v_permlane16_swap_b32 v33, v34
    v_permlane16_swap_b32 v37, v38
    v_add_f32 v33, v33, v34
    v_add_f32 v37, v37, v38
    buffer_store_dwordx2 v[32:33], v61, s[28:31], s48 offen offset:0 sc1
    buffer_store_dwordx4 v[120:123], v3, s[28:31], s50 offen sc1
    buffer_store_dwordx2 v[124:125], v245, s[28:31], s50 offen offset:1024 sc1
    buffer_store_dwordx2 v[36:37], v61, s[28:31], s48 offen offset:128 sc1
    buffer_store_dwordx4 v[136:139], v3, s[28:31], s51 offen sc1
    buffer_store_dwordx2 v[140:141], v245, s[28:31], s51 offen offset:1024 sc1
    s_add_u32 m0, s26, 65536
    s_add_u32 s27, s41, 0
    buffer_load_dwordx4 v3, s[28:31], s27 offen offset:0 lds
    buffer_load_dwordx4 v3, s[28:31], s27 offen offset:1024 lds
    buffer_load_dwordx4 v3, s[28:31], s27 offen offset:2048 lds
    buffer_load_dwordx4 v3, s[28:31], s27 offen offset:3072 lds
    s_add_u32 m0, s26, 81920
    s_add_u32 s27, s41, 16384
    buffer_load_dwordx4 v3, s[28:31], s27 offen offset:0 lds
    buffer_load_dwordx4 v3, s[28:31], s27 offen offset:1024 lds
    buffer_load_dwordx4 v3, s[28:31], s27 offen offset:2048 lds
    buffer_load_dwordx4 v3, s[28:31], s27 offen offset:3072 lds
    s_add_u32 m0, s26, 98304
    s_add_u32 s27, s41, 32768
    buffer_load_dwordx4 v3, s[28:31], s27 offen offset:0 lds
    buffer_load_dwordx4 v3, s[28:31], s27 offen offset:1024 lds
    buffer_load_dwordx4 v3, s[28:31], s27 offen offset:2048 lds
    buffer_load_dwordx4 v3, s[28:31], s27 offen offset:3072 lds
    s_add_u32 m0, s26, 114688
    s_add_u32 s27, s41, 49152
    buffer_load_dwordx4 v3, s[28:31], s27 offen offset:0 lds
    buffer_load_dwordx4 v3, s[28:31], s27 offen offset:1024 lds
    buffer_load_dwordx4 v3, s[28:31], s27 offen offset:2048 lds
    buffer_load_dwordx4 v3, s[28:31], s27 offen offset:3072 lds
    s_waitcnt vmcnt(16)
    s_barrier
    s_cmp_lg_u32 s18, 0
    s_cbranch_scc1 k8_kernel_sig1
    s_mov_b64 exec, 0xff
    buffer_store_dwordx4 v[244:247], v93, s[28:31], s43 offen offset:0 sc1
    s_mov_b64 exec, -1
k8_kernel_sig1:
    s_branch k8_p5
k8_idle4:
    v_lshrrev_b32 v245, 1, v5
    v_lshlrev_b32 v245, 8, v245
    v_lshl_add_u32 v245, v4, 4, v245
    v_and_b32 v1, 1, v5
    v_lshl_add_u32 v245, v1, 3, v245
    v_mov_b32 v246, 1
    v_and_b32 v247, 3, v2
    v_lshlrev_b32 v247, 7, v247
    v_min_u32 v92, 11, v4
    v_lshlrev_b32 v92, 7, v92
    s_lshl_b32 s3, s57, 7
    v_add_u32 v93, s3, v3
    s_lshl_b32 s3, s20, 7
    v_add_u32 v94, s3, v3
    s_lshl_b32 s3, s19, 7
    v_add_u32 v95, s3, v3
    v_mov_b32 v244, 1
    s_mul_i32 s43, s21, 12288
    s_add_u32 s43, s43, 61440
    s_lshl_b32 s44, s19, 11
    s_add_u32 s44, s44, s43
    s_add_u32 s44, s44, 2048
    s_lshl_b32 s45, s20, 9
    s_add_u32 s45, s45, s43
    s_add_u32 s45, s45, 10240
    s_mul_i32 s42, s20, 144
    s_mul_i32 s3, s19, 36
    s_add_u32 s42, s42, s3
    s_mul_i32 s42, s42, 9216
    s_add_u32 s42, s42, s26
    s_add_u32 s42, s42, 19968000
    v_lshlrev_b32 v8, 7, v2
    s_and_b32 s46, s21, 7
    s_lshl_b32 s46, s46, 2
    s_add_u32 s46, s46, s18
    s_lshl_b32 s46, s46, 13
    s_mul_i32 s47, s19, 1327104
    s_add_u32 s47, s47, 14659584
    s_add_u32 s47, s47, s46
    s_cmp_ge_u32 s46, 0
    s_cbranch_scc1 k8_nowarm
    buffer_load_dword v9, v8, s[28:31], s47 offen
    s_add_u32 s47, s47, 331776
    buffer_load_dword v9, v8, s[28:31], s47 offen
    s_add_u32 s47, s47, 331776
    buffer_load_dword v9, v8, s[28:31], s47 offen
k8_nowarm:
    s_getpc_b64 s[48:49]
k8_kernel_pc2:
    s_sub_u32 s48, s48, k8_kernel_pc2 - k8_kernel
    s_subb_u32 s49, s49, 0
    v_lshlrev_b32 v8, 7, v2
    v_add_u32 v8, 8192, v8
    v_min_u32 v8, k8_kernel_codeend - k8_kernel - 4, v8
    global_load_dword v9, v8, s[48:49]
    s_getpc_b64 s[48:49]
k8_kernel_pc3:
    s_sub_u32 s48, s48, k8_kernel_pc3 - k8_kernel
    s_subb_u32 s49, s49, 0
    v_lshlrev_b32 v8, 7, v2
    v_add_u32 v8, 16384, v8
    v_min_u32 v8, k8_kernel_codeend - k8_kernel - 4, v8
    global_load_dword v9, v8, s[48:49]
    s_getpc_b64 s[48:49]
k8_kernel_pc4:
    s_sub_u32 s48, s48, k8_kernel_pc4 - k8_kernel
    s_subb_u32 s49, s49, 0
    v_lshlrev_b32 v8, 7, v2
    v_add_u32 v8, 24576, v8
    v_min_u32 v8, k8_kernel_codeend - k8_kernel - 4, v8
    global_load_dword v9, v8, s[48:49]
    s_add_u32 m0, s26, 65536
    s_add_u32 s27, s41, 0
    buffer_load_dwordx4 v3, s[28:31], s27 offen offset:0 lds
    buffer_load_dwordx4 v3, s[28:31], s27 offen offset:1024 lds
    buffer_load_dwordx4 v3, s[28:31], s27 offen offset:2048 lds
    buffer_load_dwordx4 v3, s[28:31], s27 offen offset:3072 lds
    s_add_u32 m0, s26, 81920
    s_add_u32 s27, s41, 16384
    buffer_load_dwordx4 v3, s[28:31], s27 offen offset:0 lds
    buffer_load_dwordx4 v3, s[28:31], s27 offen offset:1024 lds
    buffer_load_dwordx4 v3, s[28:31], s27 offen offset:2048 lds
    buffer_load_dwordx4 v3, s[28:31], s27 offen offset:3072 lds
    s_add_u32 m0, s26, 98304
    s_add_u32 s27, s41, 32768
    buffer_load_dwordx4 v3, s[28:31], s27 offen offset:0 lds
    buffer_load_dwordx4 v3, s[28:31], s27 offen offset:1024 lds
    buffer_load_dwordx4 v3, s[28:31], s27 offen offset:2048 lds
    buffer_load_dwordx4 v3, s[28:31], s27 offen offset:3072 lds
    s_add_u32 m0, s26, 114688
    s_add_u32 s27, s41, 49152
    buffer_load_dwordx4 v3, s[28:31], s27 offen offset:0 lds
    buffer_load_dwordx4 v3, s[28:31], s27 offen offset:1024 lds
    buffer_load_dwordx4 v3, s[28:31], s27 offen offset:2048 lds
    buffer_load_dwordx4 v3, s[28:31], s27 offen offset:3072 lds
    s_waitcnt vmcnt(16)
k8_p5:
    s_mul_i32 s24, s23, 36864
    s_add_u32 s24, s24, 12300288
    s_add_u32 s25, s24, 18432
    v_cmp_le_u32 vcc, 72, v0
    v_mov_b32 v1, 17280
    s_nop 0
    v_cndmask_b32 v1, 0, v1, vcc
    v_lshl_add_u32 v242, v0, 4, v1
    s_mul_i32 s49, s22, 1152
    s_add_u32 s49, s49, 24576
    v_lshlrev_b32 v1, 3, v4
    s_mov_b32 s48, 49152
    v_mad_u32_u24 v240, v5, s48, v1
    s_lshl_b32 s48, s23, 8
    s_add_u32 s48, s48, 1110016
    v_lshlrev_b32 v244, 5, v5
    v_add_u32 v244, 147456, v244
    s_mul_i32 s52, s23, 294912
    s_mul_i32 s53, s19, 36864
    s_add_u32 s52, s52, s53
    s_add_u32 s52, s52, 25276416
    s_add_u32 s53, s52, 147456
    s_waitcnt vmcnt(12)
    s_cmp_lg_u32 s18, 1
    s_cbranch_scc1 k8_kernel_pend5
    s_mov_b32 s3, 0
    buffer_load_dword v84, v92, s[28:31], s43 offen sc1
    s_sleep 3
    buffer_load_dword v85, v92, s[28:31], s43 offen sc1
    s_sleep 3
    buffer_load_dword v86, v92, s[28:31], s43 offen sc1
    s_sleep 3
k8_kernel_pp6:
    buffer_load_dword v87, v92, s[28:31], s43 offen sc1
    s_waitcnt vmcnt(3)
    v_cmp_ne_u32 vcc, 0, v84
    s_nop 0
    s_cmp_eq_u64 vcc, -1
    s_cbranch_scc1 k8_kernel_pend5
    s_sleep 3
    buffer_load_dword v84, v92, s[28:31], s43 offen sc1
    s_waitcnt vmcnt(3)
    v_cmp_ne_u32 vcc, 0, v85
    s_nop 0
    s_cmp_eq_u64 vcc, -1
    s_cbranch_scc1 k8_kernel_pend5
    s_sleep 3
    buffer_load_dword v85, v92, s[28:31], s43 offen sc1
    s_waitcnt vmcnt(3)
    v_cmp_ne_u32 vcc, 0, v86
    s_nop 0
    s_cmp_eq_u64 vcc, -1
    s_cbranch_scc1 k8_kernel_pend5
    s_sleep 3
    buffer_load_dword v86, v92, s[28:31], s43 offen sc1
    s_waitcnt vmcnt(3)
    v_cmp_ne_u32 vcc, 0, v87
    s_nop 0
    s_cmp_eq_u64 vcc, -1
    s_cbranch_scc1 k8_kernel_pend5
    s_sleep 3
    s_add_u32 s3, s3, 1
    s_cmp_lt_u32 s3, 0x20000
    s_cbranch_scc1 k8_kernel_pp6
k8_kernel_pend5:
    s_add_u32 m0, s26, 131072
    s_add_u32 s27, s41, 65536
    buffer_load_dwordx4 v3, s[28:31], s27 offen offset:0 lds
    buffer_load_dwordx4 v3, s[28:31], s27 offen offset:1024 lds
    buffer_load_dwordx4 v3, s[28:31], s27 offen offset:2048 lds
    buffer_load_dwordx4 v3, s[28:31], s27 offen offset:3072 lds
    s_add_u32 m0, s26, 0
    s_add_u32 s27, s41, 81920
    buffer_load_dwordx4 v3, s[28:31], s27 offen offset:0 lds
    buffer_load_dwordx4 v3, s[28:31], s27 offen offset:1024 lds
    buffer_load_dwordx4 v3, s[28:31], s27 offen offset:2048 lds
    buffer_load_dwordx4 v3, s[28:31], s27 offen offset:3072 lds
    s_add_u32 m0, s26, 16384
    s_add_u32 s27, s41, 98304
    buffer_load_dwordx4 v3, s[28:31], s27 offen offset:0 lds
    buffer_load_dwordx4 v3, s[28:31], s27 offen offset:1024 lds
    buffer_load_dwordx4 v3, s[28:31], s27 offen offset:2048 lds
    buffer_load_dwordx4 v3, s[28:31], s27 offen offset:3072 lds
    s_add_u32 m0, s26, 32768
    s_add_u32 s27, s41, 114688
    buffer_load_dwordx4 v3, s[28:31], s27 offen offset:0 lds
    buffer_load_dwordx4 v3, s[28:31], s27 offen offset:1024 lds
    buffer_load_dwordx4 v3, s[28:31], s27 offen offset:2048 lds
    buffer_load_dwordx4 v3, s[28:31], s27 offen offset:3072 lds
    s_add_u32 m0, s26, 49152
    s_add_u32 s27, s41, 131072
    buffer_load_dwordx4 v3, s[28:31], s27 offen offset:0 lds
    buffer_load_dwordx4 v3, s[28:31], s27 offen offset:1024 lds
    buffer_load_dwordx4 v3, s[28:31], s27 offen offset:2048 lds
    buffer_load_dwordx4 v3, s[28:31], s27 offen offset:3072 lds
    s_barrier
    buffer_load_dwordx4 a[0:3], v3, s[28:31], s24 offen offset:0 sc1
    buffer_load_dwordx4 a[4:7], v3, s[28:31], s25 offen offset:0 sc1
    buffer_load_dwordx4 a[8:11], v3, s[28:31], s24 offen offset:1024 sc1
    buffer_load_dwordx4 a[12:15], v3, s[28:31], s25 offen offset:1024 sc1
    buffer_load_dwordx4 a[16:19], v3, s[28:31], s24 offen offset:2048 sc1
    buffer_load_dwordx4 a[20:23], v3, s[28:31], s25 offen offset:2048 sc1
    buffer_load_dwordx4 a[24:27], v3, s[28:31], s24 offen offset:3072 sc1
    buffer_load_dwordx4 a[28:31], v3, s[28:31], s25 offen offset:3072 sc1
    s_add_u32 s24, s24, 4096
    buffer_load_dwordx4 a[32:35], v3, s[28:31], s24 offen offset:0 sc1
    s_add_u32 s25, s25, 4096
    buffer_load_dwordx4 a[36:39], v3, s[28:31], s25 offen offset:0 sc1
    buffer_load_dwordx4 a[40:43], v3, s[28:31], s24 offen offset:1024 sc1
    buffer_load_dwordx4 a[44:47], v3, s[28:31], s25 offen offset:1024 sc1
    buffer_load_dwordx4 a[48:51], v3, s[28:31], s24 offen offset:2048 sc1
    buffer_load_dwordx4 a[52:55], v3, s[28:31], s25 offen offset:2048 sc1
    s_mov_b32 s60, s52
    s_mov_b32 s61, s53
    ds_read_b128 v[12:15], v6 offset:0
    ds_read_b128 v[16:19], v6 offset:1024
    ds_read_b128 v[20:23], v6 offset:2048
    ds_read_b128 v[24:27], v6 offset:3072
    ds_read_b128 v[28:31], v6 offset:4096
    ds_read_b128 v[32:35], v6 offset:5120
    s_waitcnt vmcnt(12) lgkmcnt(4)
    v_mfma_f32_16x16x32_bf16 v[96:99], v[12:15], a[0:3], 0
    ds_read_b128 v[8:11], v6 offset:6144
    buffer_load_dwordx4 a[56:59], v3, s[28:31], s24 offen offset:3072 sc1
    v_mfma_f32_16x16x32_bf16 v[100:103], v[12:15], a[4:7], 0
    v_mfma_f32_16x16x32_bf16 v[104:107], v[16:19], a[0:3], 0
    ds_read_b128 v[12:15], v6 offset:7168
    buffer_load_dwordx4 a[60:63], v3, s[28:31], s25 offen offset:3072 sc1
    v_mfma_f32_16x16x32_bf16 v[108:111], v[16:19], a[4:7], 0
    s_waitcnt lgkmcnt(4)
    v_mfma_f32_16x16x32_bf16 v[112:115], v[20:23], a[0:3], 0
    ds_read_b128 v[16:19], v6 offset:8192
    v_mfma_f32_16x16x32_bf16 v[116:119], v[20:23], a[4:7], 0
    v_mfma_f32_16x16x32_bf16 v[120:123], v[24:27], a[0:3], 0
    ds_read_b128 v[20:23], v6 offset:9216
    s_add_u32 s24, s24, 4096
    v_mfma_f32_16x16x32_bf16 v[124:127], v[24:27], a[4:7], 0
    buffer_load_dwordx4 a[64:67], v3, s[28:31], s24 offen offset:0 sc1
    s_waitcnt lgkmcnt(4)
    v_mfma_f32_16x16x32_bf16 v[128:131], v[28:31], a[0:3], 0
    ds_read_b128 v[24:27], v6 offset:10240
    s_add_u32 s25, s25, 4096
    v_mfma_f32_16x16x32_bf16 v[132:135], v[28:31], a[4:7], 0
    buffer_load_dwordx4 a[68:71], v3, s[28:31], s25 offen offset:0 sc1
    v_mfma_f32_16x16x32_bf16 v[136:139], v[32:35], a[0:3], 0
    ds_read_b128 v[28:31], v6 offset:11264
    v_mfma_f32_16x16x32_bf16 v[140:143], v[32:35], a[4:7], 0
    s_waitcnt vmcnt(14) lgkmcnt(4)
    v_mfma_f32_16x16x32_bf16 v[96:99], v[8:11], a[8:11], v[96:99]
    ds_read_b128 v[32:35], v6 offset:12288
    buffer_load_dwordx4 a[72:75], v3, s[28:31], s24 offen offset:1024 sc1
    v_mfma_f32_16x16x32_bf16 v[100:103], v[8:11], a[12:15], v[100:103]
    v_mfma_f32_16x16x32_bf16 v[104:107], v[12:15], a[8:11], v[104:107]
    ds_read_b128 v[8:11], v6 offset:13312
    buffer_load_dwordx4 a[76:79], v3, s[28:31], s25 offen offset:1024 sc1
    v_mfma_f32_16x16x32_bf16 v[108:111], v[12:15], a[12:15], v[108:111]
    s_waitcnt lgkmcnt(4)
    v_mfma_f32_16x16x32_bf16 v[112:115], v[16:19], a[8:11], v[112:115]
    ds_read_b128 v[12:15], v6 offset:14336
    v_mfma_f32_16x16x32_bf16 v[116:119], v[16:19], a[12:15], v[116:119]
    v_mfma_f32_16x16x32_bf16 v[120:123], v[20:23], a[8:11], v[120:123]
    ds_read_b128 v[16:19], v6 offset:15360
    buffer_load_dwordx4 a[80:83], v3, s[28:31], s24 offen offset:2048 sc1
    v_mfma_f32_16x16x32_bf16 v[124:127], v[20:23], a[12:15], v[124:127]
    s_barrier
    s_waitcnt lgkmcnt(4)
    v_mfma_f32_16x16x32_bf16 v[128:131], v[24:27], a[8:11], v[128:131]
    ds_read_b128 v[20:23], v6 offset:16384
    v_mfma_f32_16x16x32_bf16 v[132:135], v[24:27], a[12:15], v[132:135]
    v_mfma_f32_16x16x32_bf16 v[136:139], v[28:31], a[8:11], v[136:139]
    ds_read_b128 v[24:27], v6 offset:17408
    buffer_load_dwordx4 a[84:87], v3, s[28:31], s25 offen offset:2048 sc1
    v_mfma_f32_16x16x32_bf16 v[140:143], v[28:31], a[12:15], v[140:143]
    s_waitcnt vmcnt(16) lgkmcnt(4)
    v_mfma_f32_16x16x32_bf16 v[96:99], v[32:35], a[16:19], v[96:99]
    ds_read_b128 v[28:31], v6 offset:18432
    buffer_load_dwordx4 v[72:75], v242, s[28:31], s49 offen
    v_mfma_f32_16x16x32_bf16 v[100:103], v[32:35], a[20:23], v[100:103]
    v_mfma_f32_16x16x32_bf16 v[104:107], v[8:11], a[16:19], v[104:107]
    ds_read_b128 v[32:35], v6 offset:19456
    v_mfma_f32_16x16x32_bf16 v[108:111], v[8:11], a[20:23], v[108:111]
    s_waitcnt lgkmcnt(4)
    v_mfma_f32_16x16x32_bf16 v[112:115], v[12:15], a[16:19], v[112:115]
    ds_read_b128 v[8:11], v6 offset:20480
    buffer_load_dwordx4 a[88:91], v3, s[28:31], s24 offen offset:3072 sc1
    v_mfma_f32_16x16x32_bf16 v[116:119], v[12:15], a[20:23], v[116:119]
    v_mfma_f32_16x16x32_bf16 v[120:123], v[16:19], a[16:19], v[120:123]
    ds_read_b128 v[12:15], v6 offset:21504
    buffer_load_dwordx4 a[92:95], v3, s[28:31], s25 offen offset:3072 sc1
    v_mfma_f32_16x16x32_bf16 v[124:127], v[16:19], a[20:23], v[124:127]
    s_waitcnt lgkmcnt(4)
    v_mfma_f32_16x16x32_bf16 v[128:131], v[20:23], a[16:19], v[128:131]
    ds_read_b128 v[16:19], v6 offset:22528
    v_mfma_f32_16x16x32_bf16 v[132:135], v[20:23], a[20:23], v[132:135]
    v_mfma_f32_16x16x32_bf16 v[136:139], v[24:27], a[16:19], v[136:139]
    ds_read_b128 v[20:23], v6 offset:23552
    s_add_u32 s24, s24, 4096
    v_mfma_f32_16x16x32_bf16 v[140:143], v[24:27], a[20:23], v[140:143]
    buffer_load_dwordx4 a[96:99], v3, s[28:31], s24 offen offset:0 sc1
    s_waitcnt vmcnt(18) lgkmcnt(4)
    v_mfma_f32_16x16x32_bf16 v[96:99], v[28:31], a[24:27], v[96:99]
    ds_read_b128 v[24:27], v6 offset:24576
    v_mfma_f32_16x16x32_bf16 v[100:103], v[28:31], a[28:31], v[100:103]
    v_mfma_f32_16x16x32_bf16 v[104:107], v[32:35], a[24:27], v[104:107]
    ds_read_b128 v[28:31], v6 offset:25600
    s_add_u32 s25, s25, 4096
    v_mfma_f32_16x16x32_bf16 v[108:111], v[32:35], a[28:31], v[108:111]
    buffer_load_dwordx4 a[100:103], v3, s[28:31], s25 offen offset:0 sc1
    s_waitcnt lgkmcnt(4)
    v_mfma_f32_16x16x32_bf16 v[112:115], v[8:11], a[24:27], v[112:115]
    ds_read_b128 v[32:35], v6 offset:26624
    buffer_load_dwordx2 v[36:37], v240, s[28:31], s48 offen sc1
    v_mfma_f32_16x16x32_bf16 v[116:119], v[8:11], a[28:31], v[116:119]
    buffer_load_dwordx2 v[42:43], v240, s[28:31], s48 offen offset:128 sc1
    s_add_u32 s48, s48, 16384
    v_mfma_f32_16x16x32_bf16 v[120:123], v[12:15], a[24:27], v[120:123]
    ds_read_b128 v[8:11], v6 offset:27648
    v_mfma_f32_16x16x32_bf16 v[124:127], v[12:15], a[28:31], v[124:127]
    s_waitcnt lgkmcnt(4)
    v_mfma_f32_16x16x32_bf16 v[128:131], v[16:19], a[24:27], v[128:131]
    ds_read_b128 v[12:15], v6 offset:28672
    buffer_load_dwordx2 v[38:39], v240, s[28:31], s48 offen sc1
    v_mfma_f32_16x16x32_bf16 v[132:135], v[16:19], a[28:31], v[132:135]
    buffer_load_dwordx2 v[44:45], v240, s[28:31], s48 offen offset:128 sc1
    s_add_u32 s48, s48, 16384
    v_mfma_f32_16x16x32_bf16 v[136:139], v[20:23], a[24:27], v[136:139]
    ds_read_b128 v[16:19], v6 offset:29696
    buffer_load_dwordx2 v[40:41], v240, s[28:31], s48 offen sc1
    v_mfma_f32_16x16x32_bf16 v[140:143], v[20:23], a[28:31], v[140:143]
    buffer_load_dwordx2 v[46:47], v240, s[28:31], s48 offen offset:128 sc1
    s_add_u32 s48, s48, 16384
    s_waitcnt vmcnt(23) lgkmcnt(4)
    v_mfma_f32_16x16x32_bf16 v[96:99], v[24:27], a[32:35], v[96:99]
    ds_read_b128 v[20:23], v6 offset:30720
    v_mfma_f32_16x16x32_bf16 v[100:103], v[24:27], a[36:39], v[100:103]
    v_mfma_f32_16x16x32_bf16 v[104:107], v[28:31], a[32:35], v[104:107]
    ds_read_b128 v[24:27], v6 offset:31744
    buffer_load_dwordx4 a[104:107], v3, s[28:31], s24 offen offset:1024 sc1
    v_mfma_f32_16x16x32_bf16 v[108:111], v[28:31], a[36:39], v[108:111]
    s_barrier
    s_waitcnt lgkmcnt(4)
    v_mfma_f32_16x16x32_bf16 v[112:115], v[32:35], a[32:35], v[112:115]
    ds_read_b128 v[28:31], v6 offset:32768
    v_mfma_f32_16x16x32_bf16 v[116:119], v[32:35], a[36:39], v[116:119]
    v_mfma_f32_16x16x32_bf16 v[120:123], v[8:11], a[32:35], v[120:123]
    ds_read_b128 v[32:35], v6 offset:33792
    buffer_load_dwordx4 a[108:111], v3, s[28:31], s25 offen offset:1024 sc1
    v_mfma_f32_16x16x32_bf16 v[124:127], v[8:11], a[36:39], v[124:127]
    s_waitcnt lgkmcnt(4)
    v_mfma_f32_16x16x32_bf16 v[128:131], v[12:15], a[32:35], v[128:131]
    ds_read_b128 v[8:11], v6 offset:34816
    buffer_load_dwordx4 a[112:115], v3, s[28:31], s24 offen offset:2048 sc1
    v_mfma_f32_16x16x32_bf16 v[132:135], v[12:15], a[36:39], v[132:135]
    v_mfma_f32_16x16x32_bf16 v[136:139], v[16:19], a[32:35], v[136:139]
    ds_read_b128 v[12:15], v6 offset:35840
    v_mfma_f32_16x16x32_bf16 v[140:143], v[16:19], a[36:39], v[140:143]
    s_waitcnt vmcnt(24) lgkmcnt(4)
    v_mfma_f32_16x16x32_bf16 v[96:99], v[20:23], a[40:43], v[96:99]
    ds_read_b128 v[16:19], v6 offset:36864
    buffer_load_dwordx4 a[116:119], v3, s[28:31], s25 offen offset:2048 sc1
    v_mfma_f32_16x16x32_bf16 v[100:103], v[20:23], a[44:47], v[100:103]
    v_mfma_f32_16x16x32_bf16 v[104:107], v[24:27], a[40:43], v[104:107]
    ds_read_b128 v[20:23], v6 offset:37888
    buffer_load_dwordx4 a[120:123], v3, s[28:31], s24 offen offset:3072 sc1
    v_mfma_f32_16x16x32_bf16 v[108:111], v[24:27], a[44:47], v[108:111]
    s_waitcnt lgkmcnt(4)
    v_mfma_f32_16x16x32_bf16 v[112:115], v[28:31], a[40:43], v[112:115]
    ds_read_b128 v[24:27], v6 offset:38912
    v_mfma_f32_16x16x32_bf16 v[116:119], v[28:31], a[44:47], v[116:119]
    v_mfma_f32_16x16x32_bf16 v[120:123], v[32:35], a[40:43], v[120:123]
    ds_read_b128 v[28:31], v6 offset:39936
    buffer_load_dwordx4 a[124:127], v3, s[28:31], s25 offen offset:3072 sc1
    v_mfma_f32_16x16x32_bf16 v[124:127], v[32:35], a[44:47], v[124:127]
    s_waitcnt lgkmcnt(4)
    v_mfma_f32_16x16x32_bf16 v[128:131], v[8:11], a[40:43], v[128:131]
    ds_read_b128 v[32:35], v6 offset:40960
    v_mfma_f32_16x16x32_bf16 v[132:135], v[8:11], a[44:47], v[132:135]
    v_mfma_f32_16x16x32_bf16 v[136:139], v[12:15], a[40:43], v[136:139]
    ds_read_b128 v[8:11], v6 offset:41984
    s_add_u32 s24, s24, 4096
    v_mfma_f32_16x16x32_bf16 v[140:143], v[12:15], a[44:47], v[140:143]
    buffer_load_dwordx4 a[128:131], v3, s[28:31], s24 offen offset:0 sc1
    s_waitcnt vmcnt(26) lgkmcnt(4)
    v_mfma_f32_16x16x32_bf16 v[96:99], v[16:19], a[48:51], v[96:99]
    ds_read_b128 v[12:15], v6 offset:43008
    s_add_u32 s25, s25, 4096
    v_mfma_f32_16x16x32_bf16 v[100:103], v[16:19], a[52:55], v[100:103]
    buffer_load_dwordx4 a[132:135], v3, s[28:31], s25 offen offset:0 sc1
    v_mfma_f32_16x16x32_bf16 v[104:107], v[20:23], a[48:51], v[104:107]
    ds_read_b128 v[16:19], v6 offset:44032
    v_mfma_f32_16x16x32_bf16 v[108:111], v[20:23], a[52:55], v[108:111]
    s_waitcnt lgkmcnt(4)
    v_mfma_f32_16x16x32_bf16 v[112:115], v[24:27], a[48:51], v[112:115]
    ds_read_b128 v[20:23], v6 offset:45056
    buffer_load_dwordx4 a[136:139], v3, s[28:31], s24 offen offset:1024 sc1
    v_mfma_f32_16x16x32_bf16 v[116:119], v[24:27], a[52:55], v[116:119]
    v_mfma_f32_16x16x32_bf16 v[120:123], v[28:31], a[48:51], v[120:123]
    ds_read_b128 v[24:27], v6 offset:46080
    buffer_load_dwordx4 a[140:143], v3, s[28:31], s25 offen offset:1024 sc1
    v_mfma_f32_16x16x32_bf16 v[124:127], v[28:31], a[52:55], v[124:127]
    s_waitcnt lgkmcnt(4)
    v_mfma_f32_16x16x32_bf16 v[128:131], v[32:35], a[48:51], v[128:131]
    ds_read_b128 v[28:31], v6 offset:47104
    v_mfma_f32_16x16x32_bf16 v[132:135], v[32:35], a[52:55], v[132:135]
    v_mfma_f32_16x16x32_bf16 v[136:139], v[8:11], a[48:51], v[136:139]
    ds_read_b128 v[32:35], v6 offset:48128
    s_add_u32 m0, s26, 65536
    v_mfma_f32_16x16x32_bf16 v[140:143], v[8:11], a[52:55], v[140:143]
    s_add_u32 s27, s41, 147456
    buffer_load_dwordx4 v3, s[28:31], s27 offen offset:0 lds
    s_waitcnt vmcnt(28) lgkmcnt(4)
    v_mfma_f32_16x16x32_bf16 v[96:99], v[12:15], a[56:59], v[96:99]
    ds_read_b128 v[8:11], v6 offset:49152
    v_mfma_f32_16x16x32_bf16 v[100:103], v[12:15], a[60:63], v[100:103]
    v_mfma_f32_16x16x32_bf16 v[104:107], v[16:19], a[56:59], v[104:107]
    ds_read_b128 v[12:15], v6 offset:50176
    buffer_load_dwordx4 v3, s[28:31], s27 offen offset:1024 lds
    v_mfma_f32_16x16x32_bf16 v[108:111], v[16:19], a[60:63], v[108:111]
    s_waitcnt lgkmcnt(4)
    v_mfma_f32_16x16x32_bf16 v[112:115], v[20:23], a[56:59], v[112:115]
    ds_read_b128 v[16:19], v6 offset:51200
    buffer_load_dwordx4 v3, s[28:31], s27 offen offset:2048 lds
    v_mfma_f32_16x16x32_bf16 v[116:119], v[20:23], a[60:63], v[116:119]
    v_mfma_f32_16x16x32_bf16 v[120:123], v[24:27], a[56:59], v[120:123]
    ds_read_b128 v[20:23], v6 offset:52224
    v_mfma_f32_16x16x32_bf16 v[124:127], v[24:27], a[60:63], v[124:127]
    s_waitcnt lgkmcnt(4)
    v_mfma_f32_16x16x32_bf16 v[128:131], v[28:31], a[56:59], v[128:131]
    ds_read_b128 v[24:27], v6 offset:53248
    buffer_load_dwordx4 v3, s[28:31], s27 offen offset:3072 lds
    v_mfma_f32_16x16x32_bf16 v[132:135], v[28:31], a[60:63], v[132:135]
    v_mfma_f32_16x16x32_bf16 v[136:139], v[32:35], a[56:59], v[136:139]
    ds_read_b128 v[28:31], v6 offset:54272
    v_mfma_f32_16x16x32_bf16 v[140:143], v[32:35], a[60:63], v[140:143]
    s_waitcnt vmcnt(29) lgkmcnt(4)
    v_mfma_f32_16x16x32_bf16 v[96:99], v[8:11], a[64:67], v[96:99]
    ds_read_b128 v[32:35], v6 offset:55296
    v_mfma_f32_16x16x32_bf16 v[100:103], v[8:11], a[68:71], v[100:103]
    v_mfma_f32_16x16x32_bf16 v[104:107], v[12:15], a[64:67], v[104:107]
    ds_read_b128 v[8:11], v6 offset:56320
    v_mfma_f32_16x16x32_bf16 v[108:111], v[12:15], a[68:71], v[108:111]
    s_waitcnt lgkmcnt(4)
    v_mfma_f32_16x16x32_bf16 v[112:115], v[16:19], a[64:67], v[112:115]
    ds_read_b128 v[12:15], v6 offset:57344
    v_mfma_f32_16x16x32_bf16 v[116:119], v[16:19], a[68:71], v[116:119]
    v_mfma_f32_16x16x32_bf16 v[120:123], v[20:23], a[64:67], v[120:123]
    ds_read_b128 v[16:19], v6 offset:58368
    v_mfma_f32_16x16x32_bf16 v[124:127], v[20:23], a[68:71], v[124:127]
    s_waitcnt lgkmcnt(4)
    v_mfma_f32_16x16x32_bf16 v[128:131], v[24:27], a[64:67], v[128:131]
    ds_read_b128 v[20:23], v6 offset:59392
    v_mfma_f32_16x16x32_bf16 v[132:135], v[24:27], a[68:71], v[132:135]
    v_mfma_f32_16x16x32_bf16 v[136:139], v[28:31], a[64:67], v[136:139]
    ds_read_b128 v[24:27], v6 offset:60416
    v_mfma_f32_16x16x32_bf16 v[140:143], v[28:31], a[68:71], v[140:143]
    s_waitcnt vmcnt(27) lgkmcnt(4)
    v_mfma_f32_16x16x32_bf16 v[96:99], v[32:35], a[72:75], v[96:99]
    ds_read_b128 v[28:31], v6 offset:61440
    v_mfma_f32_16x16x32_bf16 v[100:103], v[32:35], a[76:79], v[100:103]
    v_mfma_f32_16x16x32_bf16 v[104:107], v[8:11], a[72:75], v[104:107]
    ds_read_b128 v[32:35], v6 offset:62464
    v_mfma_f32_16x16x32_bf16 v[108:111], v[8:11], a[76:79], v[108:111]
    s_waitcnt lgkmcnt(4)
    v_mfma_f32_16x16x32_bf16 v[112:115], v[12:15], a[72:75], v[112:115]
    ds_read_b128 v[8:11], v6 offset:63488
    v_mfma_f32_16x16x32_bf16 v[116:119], v[12:15], a[76:79], v[116:119]
    v_mfma_f32_16x16x32_bf16 v[120:123], v[16:19], a[72:75], v[120:123]
    ds_read_b128 v[12:15], v6 offset:64512
    v_mfma_f32_16x16x32_bf16 v[124:127], v[16:19], a[76:79], v[124:127]
    s_barrier
    s_waitcnt lgkmcnt(4)
    v_mfma_f32_16x16x32_bf16 v[128:131], v[20:23], a[72:75], v[128:131]
    ds_read_b128 v[16:19], v7 offset:0
    s_add_u32 m0, s26, 81920
    v_mfma_f32_16x16x32_bf16 v[132:135], v[20:23], a[76:79], v[132:135]
    s_add_u32 s27, s41, 163840
    buffer_load_dwordx4 v3, s[28:31], s27 offen offset:0 lds
    v_mfma_f32_16x16x32_bf16 v[136:139], v[24:27], a[72:75], v[136:139]
    ds_read_b128 v[20:23], v7 offset:1024
    buffer_load_dwordx4 v3, s[28:31], s27 offen offset:1024 lds
    v_mfma_f32_16x16x32_bf16 v[140:143], v[24:27], a[76:79], v[140:143]
    s_waitcnt vmcnt(27) lgkmcnt(4)
    v_mfma_f32_16x16x32_bf16 v[96:99], v[28:31], a[80:83], v[96:99]
    ds_read_b128 v[24:27], v7 offset:2048
    buffer_load_dwordx4 v3, s[28:31], s27 offen offset:2048 lds
    v_mfma_f32_16x16x32_bf16 v[100:103], v[28:31], a[84:87], v[100:103]
    v_mfma_f32_16x16x32_bf16 v[104:107], v[32:35], a[80:83], v[104:107]
    ds_read_b128 v[28:31], v7 offset:3072
    buffer_load_dwordx4 v3, s[28:31], s27 offen offset:3072 lds
    v_mfma_f32_16x16x32_bf16 v[108:111], v[32:35], a[84:87], v[108:111]
    s_waitcnt lgkmcnt(4)
    v_mfma_f32_16x16x32_bf16 v[112:115], v[8:11], a[80:83], v[112:115]
    ds_read_b128 v[32:35], v7 offset:4096
    v_mfma_f32_16x16x32_bf16 v[116:119], v[8:11], a[84:87], v[116:119]
    v_mfma_f32_16x16x32_bf16 v[120:123], v[12:15], a[80:83], v[120:123]
    ds_read_b128 v[8:11], v7 offset:5120
    s_add_u32 m0, s26, 98304
    v_mfma_f32_16x16x32_bf16 v[124:127], v[12:15], a[84:87], v[124:127]
    s_add_u32 s27, s41, 180224
    s_waitcnt lgkmcnt(4)
    v_mfma_f32_16x16x32_bf16 v[128:131], v[16:19], a[80:83], v[128:131]
    ds_read_b128 v[12:15], v7 offset:6144
    buffer_load_dwordx4 v3, s[28:31], s27 offen offset:0 lds
    v_mfma_f32_16x16x32_bf16 v[132:135], v[16:19], a[84:87], v[132:135]
    v_mfma_f32_16x16x32_bf16 v[136:139], v[20:23], a[80:83], v[136:139]
    ds_read_b128 v[16:19], v7 offset:7168
    buffer_load_dwordx4 v3, s[28:31], s27 offen offset:1024 lds
    v_mfma_f32_16x16x32_bf16 v[140:143], v[20:23], a[84:87], v[140:143]
    s_waitcnt vmcnt(28) lgkmcnt(4)
    v_mfma_f32_16x16x32_bf16 v[96:99], v[24:27], a[88:91], v[96:99]
    ds_read_b128 v[20:23], v7 offset:8192
    buffer_load_dwordx4 v3, s[28:31], s27 offen offset:2048 lds
    v_mfma_f32_16x16x32_bf16 v[100:103], v[24:27], a[92:95], v[100:103]
    v_mfma_f32_16x16x32_bf16 v[104:107], v[28:31], a[88:91], v[104:107]
    ds_read_b128 v[24:27], v7 offset:9216
    v_mfma_f32_16x16x32_bf16 v[108:111], v[28:31], a[92:95], v[108:111]
    s_waitcnt lgkmcnt(4)
    v_mfma_f32_16x16x32_bf16 v[112:115], v[32:35], a[88:91], v[112:115]
    ds_read_b128 v[28:31], v7 offset:10240
    buffer_load_dwordx4 v3, s[28:31], s27 offen offset:3072 lds
    v_mfma_f32_16x16x32_bf16 v[116:119], v[32:35], a[92:95], v[116:119]
    v_mfma_f32_16x16x32_bf16 v[120:123], v[8:11], a[88:91], v[120:123]
    ds_read_b128 v[32:35], v7 offset:11264
    v_mfma_f32_16x16x32_bf16 v[124:127], v[8:11], a[92:95], v[124:127]
    s_waitcnt lgkmcnt(4)
    v_mfma_f32_16x16x32_bf16 v[128:131], v[12:15], a[88:91], v[128:131]
    ds_read_b128 v[8:11], v7 offset:12288
    v_mfma_f32_16x16x32_bf16 v[132:135], v[12:15], a[92:95], v[132:135]
    v_mfma_f32_16x16x32_bf16 v[136:139], v[16:19], a[88:91], v[136:139]
    ds_read_b128 v[12:15], v7 offset:13312
    v_mfma_f32_16x16x32_bf16 v[140:143], v[16:19], a[92:95], v[140:143]
    s_waitcnt vmcnt(28) lgkmcnt(4)
    v_mfma_f32_16x16x32_bf16 v[96:99], v[20:23], a[96:99], v[96:99]
    ds_read_b128 v[16:19], v7 offset:14336
    v_mfma_f32_16x16x32_bf16 v[100:103], v[20:23], a[100:103], v[100:103]
    v_mfma_f32_16x16x32_bf16 v[104:107], v[24:27], a[96:99], v[104:107]
    ds_read_b128 v[20:23], v7 offset:15360
    v_mfma_f32_16x16x32_bf16 v[108:111], v[24:27], a[100:103], v[108:111]
    s_waitcnt lgkmcnt(4)
    v_mfma_f32_16x16x32_bf16 v[112:115], v[28:31], a[96:99], v[112:115]
    ds_read_b128 v[24:27], v3 offset:0
    s_waitcnt vmcnt(22)
    v_mfma_f32_16x16x32_bf16 v[116:119], v[28:31], a[100:103], v[116:119]
    v_lshlrev_b32 v1, 4, v0
    v_add_u32 v1, 147456, v1
    v_cmp_gt_u32 vcc, 144, v0
    s_nop 0
    s_and_saveexec_b64 s[58:59], vcc
    ds_write_b128 v1, v[72:75]
    s_mov_b64 exec, s[58:59]
    v_mfma_f32_16x16x32_bf16 v[120:123], v[32:35], a[96:99], v[120:123]
    ds_read_b128 v[28:31], v3 offset:1024
    v_add_f32 v76, v36, v38
    v_mfma_f32_16x16x32_bf16 v[124:127], v[32:35], a[100:103], v[124:127]
    v_add_f32 v80, v42, v44
    s_waitcnt lgkmcnt(5)
    v_mfma_f32_16x16x32_bf16 v[128:131], v[8:11], a[96:99], v[128:131]
    ds_read_b128 v[32:35], v3 offset:2048
    v_add_f32 v76, v76, v40
    v_mfma_f32_16x16x32_bf16 v[132:135], v[8:11], a[100:103], v[132:135]
    v_add_f32 v80, v80, v46
    v_mfma_f32_16x16x32_bf16 v[136:139], v[12:15], a[96:99], v[136:139]
    ds_read_b128 v[8:11], v3 offset:3072
    v_mov_b32 v77, v76
    v_mfma_f32_16x16x32_bf16 v[140:143], v[12:15], a[100:103], v[140:143]
    v_mov_b32 v81, v80
    s_waitcnt vmcnt(20) lgkmcnt(5)
    v_mfma_f32_16x16x32_bf16 v[96:99], v[16:19], a[104:107], v[96:99]
    ds_read_b128 v[12:15], v3 offset:4096
    v_permlane32_swap_b32 v76, v77
    v_mfma_f32_16x16x32_bf16 v[100:103], v[16:19], a[108:111], v[100:103]
    v_permlane32_swap_b32 v80, v81
    v_mfma_f32_16x16x32_bf16 v[104:107], v[20:23], a[104:107], v[104:107]
    ds_read_b128 v[16:19], v3 offset:5120
    v_add_f32 v76, v76, v77
    v_mfma_f32_16x16x32_bf16 v[108:111], v[20:23], a[108:111], v[108:111]
    v_add_f32 v80, v80, v81
    s_waitcnt lgkmcnt(4)
    v_mfma_f32_16x16x32_bf16 v[112:115], v[24:27], a[104:107], v[112:115]
    ds_read_b128 v[20:23], v3 offset:6144
    v_mov_b32 v77, v76
    v_mfma_f32_16x16x32_bf16 v[116:119], v[24:27], a[108:111], v[116:119]
    v_mov_b32 v81, v80
    v_mfma_f32_16x16x32_bf16 v[120:123], v[28:31], a[104:107], v[120:123]
    ds_read_b128 v[24:27], v3 offset:7168
    v_permlane16_swap_b32 v76, v77
    v_mfma_f32_16x16x32_bf16 v[124:127], v[28:31], a[108:111], v[124:127]
    v_permlane16_swap_b32 v80, v81
    s_waitcnt lgkmcnt(4)
    v_mfma_f32_16x16x32_bf16 v[128:131], v[32:35], a[104:107], v[128:131]
    ds_read_b128 v[28:31], v3 offset:8192
    v_add_f32 v76, v76, v77
    v_mfma_f32_16x16x32_bf16 v[132:135], v[32:35], a[108:111], v[132:135]
    v_add_f32 v80, v80, v81
    v_mfma_f32_16x16x32_bf16 v[136:139], v[8:11], a[104:107], v[136:139]
    ds_read_b128 v[32:35], v3 offset:9216
    v_mul_f32 v76, 0x3ae38e39, v76
    v_mfma_f32_16x16x32_bf16 v[140:143], v[8:11], a[108:111], v[140:143]
    v_mul_f32 v80, 0x3ae38e39, v80
    s_waitcnt vmcnt(18) lgkmcnt(4)
    v_mfma_f32_16x16x32_bf16 v[96:99], v[12:15], a[112:115], v[96:99]
    ds_read_b128 v[8:11], v3 offset:10240
    v_mul_f32 v77, 0x42400000, v76
    v_mfma_f32_16x16x32_bf16 v[100:103], v[12:15], a[116:119], v[100:103]
    v_mul_f32 v81, 0x42400000, v80
    v_mfma_f32_16x16x32_bf16 v[104:107], v[16:19], a[112:115], v[104:107]
    ds_read_b128 v[12:15], v3 offset:11264
    v_mov_b32 v78, 0
    v_mfma_f32_16x16x32_bf16 v[108:111], v[16:19], a[116:119], v[108:111]
    v_mov_b32 v82, 0
    s_waitcnt lgkmcnt(4)
    v_mfma_f32_16x16x32_bf16 v[112:115], v[20:23], a[112:115], v[112:115]
    ds_read_b128 v[16:19], v3 offset:12288
    v_mov_b32 v79, 0
    v_mfma_f32_16x16x32_bf16 v[116:119], v[20:23], a[116:119], v[116:119]
    v_mov_b32 v83, 0
    v_mfma_f32_16x16x32_bf16 v[120:123], v[24:27], a[112:115], v[120:123]
    ds_read_b128 v[20:23], v3 offset:13312
    v_sub_f32 v36, v36, v77
    v_mfma_f32_16x16x32_bf16 v[124:127], v[24:27], a[116:119], v[124:127]
    v_sub_f32 v42, v42, v81
    s_waitcnt lgkmcnt(4)
    v_mfma_f32_16x16x32_bf16 v[128:131], v[28:31], a[112:115], v[128:131]
    ds_read_b128 v[24:27], v3 offset:14336
    v_add_f32 v78, v78, v37
    v_mfma_f32_16x16x32_bf16 v[132:135], v[28:31], a[116:119], v[132:135]
    v_add_f32 v82, v82, v43
    v_mfma_f32_16x16x32_bf16 v[136:139], v[32:35], a[112:115], v[136:139]
    ds_read_b128 v[28:31], v3 offset:15360
    v_fmac_f32 v79, v36, v36
    v_mfma_f32_16x16x32_bf16 v[140:143], v[32:35], a[116:119], v[140:143]
    v_fmac_f32 v83, v42, v42
    s_barrier
    s_waitcnt vmcnt(16) lgkmcnt(4)
    v_mfma_f32_16x16x32_bf16 v[96:99], v[8:11], a[120:123], v[96:99]
    ds_read_b128 v[32:35], v3 offset:16384
    s_add_u32 m0, s26, 114688
    v_mfma_f32_16x16x32_bf16 v[100:103], v[8:11], a[124:127], v[100:103]
    s_add_u32 s27, s41, 196608
    buffer_load_dwordx4 v3, s[28:31], s27 offen offset:0 lds
    v_mfma_f32_16x16x32_bf16 v[104:107], v[12:15], a[120:123], v[104:107]
    ds_read_b128 v[8:11], v3 offset:17408
    v_sub_f32 v38, v38, v77
    v_mfma_f32_16x16x32_bf16 v[108:111], v[12:15], a[124:127], v[108:111]
    v_sub_f32 v44, v44, v81
    s_waitcnt lgkmcnt(4)
    v_mfma_f32_16x16x32_bf16 v[112:115], v[16:19], a[120:123], v[112:115]
    ds_read_b128 v[12:15], v3 offset:18432
    buffer_load_dwordx4 v3, s[28:31], s27 offen offset:1024 lds
    v_mfma_f32_16x16x32_bf16 v[116:119], v[16:19], a[124:127], v[116:119]
    v_add_f32 v78, v78, v39
    v_add_f32 v82, v82, v45
    v_mfma_f32_16x16x32_bf16 v[120:123], v[20:23], a[120:123], v[120:123]
    ds_read_b128 v[16:19], v3 offset:19456
    buffer_load_dwordx4 v3, s[28:31], s27 offen offset:2048 lds
    v_mfma_f32_16x16x32_bf16 v[124:127], v[20:23], a[124:127], v[124:127]
    v_fmac_f32 v79, v38, v38
    v_fmac_f32 v83, v44, v44
    s_waitcnt lgkmcnt(4)
    v_mfma_f32_16x16x32_bf16 v[128:131], v[24:27], a[120:123], v[128:131]
    ds_read_b128 v[20:23], v3 offset:20480
    buffer_load_dwordx4 v3, s[28:31], s27 offen offset:3072 lds
    v_mfma_f32_16x16x32_bf16 v[132:135], v[24:27], a[124:127], v[132:135]
    v_sub_f32 v40, v40, v77
    v_sub_f32 v46, v46, v81
    v_mfma_f32_16x16x32_bf16 v[136:139], v[28:31], a[120:123], v[136:139]
    ds_read_b128 v[24:27], v3 offset:21504
    v_add_f32 v78, v78, v41
    v_mfma_f32_16x16x32_bf16 v[140:143], v[28:31], a[124:127], v[140:143]
    v_add_f32 v82, v82, v47
    s_add_u32 m0, s26, 131072
    s_add_u32 s27, s41, 212992
    buffer_load_dwordx4 v3, s[28:31], s27 offen offset:0 lds
    v_fmac_f32 v79, v40, v40
    v_fmac_f32 v83, v46, v46
    s_waitcnt vmcnt(19) lgkmcnt(4)
    v_mfma_f32_16x16x32_bf16 v[96:99], v[32:35], a[128:131], v[96:99]
    ds_read_b128 v[28:31], v3 offset:22528
    v_fmac_f32 v78, 0x3caaaaab, v79
    v_mfma_f32_16x16x32_bf16 v[100:103], v[32:35], a[132:135], v[100:103]
    v_fmac_f32 v82, 0x3caaaaab, v83
    v_mfma_f32_16x16x32_bf16 v[104:107], v[8:11], a[128:131], v[104:107]
    ds_read_b128 v[32:35], v3 offset:23552
    buffer_load_dwordx4 v3, s[28:31], s27 offen offset:1024 lds
    v_mfma_f32_16x16x32_bf16 v[108:111], v[8:11], a[132:135], v[108:111]
    v_mov_b32 v79, v78
    s_waitcnt lgkmcnt(4)
    v_mfma_f32_16x16x32_bf16 v[112:115], v[12:15], a[128:131], v[112:115]
    ds_read_b128 v[8:11], v3 offset:24576
    v_mov_b32 v83, v82
    v_mfma_f32_16x16x32_bf16 v[116:119], v[12:15], a[132:135], v[116:119]
    buffer_load_dwordx4 v3, s[28:31], s27 offen offset:2048 lds
    v_permlane32_swap_b32 v78, v79
    v_mfma_f32_16x16x32_bf16 v[120:123], v[16:19], a[128:131], v[120:123]
    ds_read_b128 v[12:15], v3 offset:25600
    v_permlane32_swap_b32 v82, v83
    v_mfma_f32_16x16x32_bf16 v[124:127], v[16:19], a[132:135], v[124:127]
    v_add_f32 v78, v78, v79
    s_waitcnt lgkmcnt(4)
    v_mfma_f32_16x16x32_bf16 v[128:131], v[20:23], a[128:131], v[128:131]
    ds_read_b128 v[16:19], v3 offset:26624
    v_add_f32 v82, v82, v83
    v_mfma_f32_16x16x32_bf16 v[132:135], v[20:23], a[132:135], v[132:135]
    buffer_load_dwordx4 v3, s[28:31], s27 offen offset:3072 lds
    v_mov_b32 v79, v78
    v_mfma_f32_16x16x32_bf16 v[136:139], v[24:27], a[128:131], v[136:139]
    ds_read_b128 v[20:23], v3 offset:27648
    v_mov_b32 v83, v82
    v_mfma_f32_16x16x32_bf16 v[140:143], v[24:27], a[132:135], v[140:143]
    v_permlane16_swap_b32 v78, v79
    v_permlane16_swap_b32 v82, v83
    s_waitcnt vmcnt(20) lgkmcnt(4)
    v_mfma_f32_16x16x32_bf16 v[96:99], v[28:31], a[136:139], v[96:99]
    ds_read_b128 v[24:27], v3 offset:28672
    v_add_f32 v78, v78, v79
    v_mfma_f32_16x16x32_bf16 v[100:103], v[28:31], a[140:143], v[100:103]
    v_add_f32 v82, v82, v83
    v_mfma_f32_16x16x32_bf16 v[104:107], v[32:35], a[136:139], v[104:107]
    ds_read_b128 v[28:31], v3 offset:29696
    v_mov_b32 v79, 0x3727c5ac
    v_mfma_f32_16x16x32_bf16 v[108:111], v[32:35], a[140:143], v[108:111]
    v_mov_b32 v83, 0x3727c5ac
    s_waitcnt lgkmcnt(4)
    v_mfma_f32_16x16x32_bf16 v[112:115], v[8:11], a[136:139], v[112:115]
    ds_read_b128 v[32:35], v3 offset:30720
    v_fmac_f32 v79, 0x3ae38e39, v78
    v_mfma_f32_16x16x32_bf16 v[116:119], v[8:11], a[140:143], v[116:119]
    v_fmac_f32 v83, 0x3ae38e39, v82
    v_mfma_f32_16x16x32_bf16 v[120:123], v[12:15], a[136:139], v[120:123]
    ds_read_b128 v[8:11], v3 offset:31744
    v_rsq_f32 v240, v79
    v_mfma_f32_16x16x32_bf16 v[124:127], v[12:15], a[140:143], v[124:127]
    v_rsq_f32 v241, v83
    s_waitcnt lgkmcnt(4)
    v_mfma_f32_16x16x32_bf16 v[128:131], v[16:19], a[136:139], v[128:131]
    ds_read_b128 v[12:15], v3 offset:32768
    v_mul_f32 v76, v76, v240
    v_mfma_f32_16x16x32_bf16 v[132:135], v[16:19], a[140:143], v[132:135]
    v_mul_f32 v80, v80, v241
    v_mfma_f32_16x16x32_bf16 v[136:139], v[20:23], a[136:139], v[136:139]
    ds_read_b128 v[16:19], v3 offset:33792
    v_sub_f32 v242, 0, v76
    v_mfma_f32_16x16x32_bf16 v[140:143], v[20:23], a[140:143], v[140:143]
    v_sub_f32 v243, 0, v80
    s_waitcnt lgkmcnt(4)
    v_mfma_f32_16x16x32_bf16 v[144:147], v[24:27], a[0:3], 0
    ds_read_b128 v[20:23], v3 offset:34816
    v_mfma_f32_16x16x32_bf16 v[148:151], v[24:27], a[4:7], 0
    v_mfma_f32_16x16x32_bf16 v[152:155], v[28:31], a[0:3], 0
    ds_read_b128 v[24:27], v3 offset:35840
    v_mfma_f32_16x16x32_bf16 v[156:159], v[28:31], a[4:7], 0
    s_waitcnt lgkmcnt(4)
    v_mfma_f32_16x16x32_bf16 v[160:163], v[32:35], a[0:3], 0
    ds_read_b128 v[28:31], v3 offset:36864
    ds_read_b128 v[36:39], v244 offset:0
    v_mfma_f32_16x16x32_bf16 v[164:167], v[32:35], a[4:7], 0
    ds_read_b128 v[40:43], v244 offset:16
    v_mfma_f32_16x16x32_bf16 v[168:171], v[8:11], a[0:3], 0
    ds_read_b128 v[32:35], v3 offset:37888
    ds_read_b128 v[44:47], v244 offset:1152
    v_mfma_f32_16x16x32_bf16 v[172:175], v[8:11], a[4:7], 0
    ds_read_b128 v[48:51], v244 offset:1168
    s_waitcnt lgkmcnt(8)
    v_mfma_f32_16x16x32_bf16 v[144:147], v[12:15], a[8:11], v[144:147]
    ds_read_b128 v[8:11], v3 offset:38912
    s_waitcnt lgkmcnt(1)
    v_mfma_f32_16x16x32_bf16 v[148:151], v[12:15], a[12:15], v[148:151]
    s_mul_i32 s50, s20, 3072
    ds_read_b128 v[52:55], v244 offset:128
    v_mfma_f32_16x16x32_bf16 v[152:155], v[16:19], a[8:11], v[152:155]
    ds_read_b128 v[12:15], v3 offset:39936
    s_add_u32 s50, s50, 0
    v_mfma_f32_16x16x32_bf16 v[156:159], v[16:19], a[12:15], v[156:159]
    s_add_u32 s51, s50, s61
    v_mfma_f32_16x16x32_bf16 v[160:163], v[20:23], a[8:11], v[160:163]
    ds_read_b128 v[16:19], v3 offset:40960
    s_add_u32 s50, s50, s60
    v_mfma_f32_16x16x32_bf16 v[164:167], v[20:23], a[12:15], v[164:167]
    v_fma_f32 v68, v36, v242, v44
    v_fma_f32 v69, v37, v242, v45
    v_mfma_f32_16x16x32_bf16 v[168:171], v[24:27], a[8:11], v[168:171]
    ds_read_b128 v[20:23], v3 offset:41984
    ds_read_b128 v[56:59], v244 offset:144
    v_mfma_f32_16x16x32_bf16 v[172:175], v[24:27], a[12:15], v[172:175]
    v_fma_f32 v70, v38, v242, v46
    v_mfma_f32_16x16x32_bf16 v[144:147], v[28:31], a[16:19], v[144:147]
    ds_read_b128 v[24:27], v3 offset:43008
    v_fma_f32 v71, v39, v242, v47
    v_mfma_f32_16x16x32_bf16 v[148:151], v[28:31], a[20:23], v[148:151]
    v_fma_f32 v72, v40, v242, v48
    v_fma_f32 v73, v41, v242, v49
    v_mfma_f32_16x16x32_bf16 v[152:155], v[32:35], a[16:19], v[152:155]
    ds_read_b128 v[28:31], v3 offset:44032
    v_fma_f32 v74, v42, v242, v50
    v_mfma_f32_16x16x32_bf16 v[156:159], v[32:35], a[20:23], v[156:159]
    ds_read_b128 v[60:63], v244 offset:1280
    v_fma_f32 v75, v43, v242, v51
    s_waitcnt lgkmcnt(6)
    v_mfma_f32_16x16x32_bf16 v[160:163], v[8:11], a[16:19], v[160:163]
    ds_read_b128 v[32:35], v3 offset:45056
    v_fmac_f32 v68, v96, v240
    v_mfma_f32_16x16x32_bf16 v[164:167], v[8:11], a[20:23], v[164:167]
    v_fmac_f32 v69, v97, v240
    v_fmac_f32 v70, v98, v240
    v_mfma_f32_16x16x32_bf16 v[168:171], v[12:15], a[16:19], v[168:171]
    ds_read_b128 v[8:11], v3 offset:46080
    v_fmac_f32 v71, v99, v240
    v_mfma_f32_16x16x32_bf16 v[172:175], v[12:15], a[20:23], v[172:175]
    ds_read_b128 v[64:67], v244 offset:1296
    s_waitcnt lgkmcnt(7)
    v_mfma_f32_16x16x32_bf16 v[144:147], v[16:19], a[24:27], v[144:147]
    ds_read_b128 v[12:15], v3 offset:47104
    v_fmac_f32 v72, v104, v240
    v_mfma_f32_16x16x32_bf16 v[148:151], v[16:19], a[28:31], v[148:151]
    v_fmac_f32 v73, v105, v240
    v_fmac_f32 v74, v106, v240
    v_mfma_f32_16x16x32_bf16 v[152:155], v[20:23], a[24:27], v[152:155]
    ds_read_b128 v[16:19], v3 offset:48128
    v_fmac_f32 v75, v107, v240
    v_mfma_f32_16x16x32_bf16 v[156:159], v[20:23], a[28:31], v[156:159]
    v_cvt_pk_bf16_f32 v96, v68, v69
    v_cvt_pk_bf16_f32 v97, v70, v71
    v_cvt_pk_bf16_f32 v98, v72, v73
    v_cvt_pk_bf16_f32 v99, v74, v75
    v_pk_max_i16 v96, v96, 0
    s_waitcnt vmcnt(16)
    s_barrier
    s_waitcnt lgkmcnt(6)
    v_mfma_f32_16x16x32_bf16 v[160:163], v[24:27], a[24:27], v[160:163]
    ds_read_b128 v[20:23], v3 offset:49152
    s_add_u32 m0, s26, 0
    v_mfma_f32_16x16x32_bf16 v[164:167], v[24:27], a[28:31], v[164:167]
    s_add_u32 s27, s41, 229376
    buffer_load_dwordx4 v3, s[28:31], s27 offen offset:0 lds
    v_mfma_f32_16x16x32_bf16 v[168:171], v[28:31], a[24:27], v[168:171]
    ds_read_b128 v[24:27], v3 offset:50176
    v_pk_max_i16 v97, v97, 0
    v_mfma_f32_16x16x32_bf16 v[172:175], v[28:31], a[28:31], v[172:175]
    v_pk_max_i16 v98, v98, 0
    v_pk_max_i16 v99, v99, 0
    buffer_load_dwordx4 v3, s[28:31], s27 offen offset:1024 lds
    s_waitcnt lgkmcnt(5)
    v_mfma_f32_16x16x32_bf16 v[144:147], v[32:35], a[32:35], v[144:147]
    ds_read_b128 v[28:31], v3 offset:51200
    buffer_store_dwordx4 v[96:99], v3, s[28:31], s50 offen offset:0 sc1
    v_mfma_f32_16x16x32_bf16 v[148:151], v[32:35], a[36:39], v[148:151]
    v_fma_f32 v76, v36, v243, v44
    v_fma_f32 v77, v37, v243, v45
    v_mfma_f32_16x16x32_bf16 v[152:155], v[8:11], a[32:35], v[152:155]
    ds_read_b128 v[32:35], v3 offset:52224
    v_fma_f32 v78, v38, v243, v46
    v_mfma_f32_16x16x32_bf16 v[156:159], v[8:11], a[36:39], v[156:159]
    v_fma_f32 v79, v39, v243, v47
    v_fma_f32 v80, v40, v243, v48
    buffer_load_dwordx4 v3, s[28:31], s27 offen offset:2048 lds
    s_waitcnt lgkmcnt(4)
    v_mfma_f32_16x16x32_bf16 v[160:163], v[12:15], a[32:35], v[160:163]
    ds_read_b128 v[8:11], v3 offset:53248
    v_fma_f32 v81, v41, v243, v49
    v_mfma_f32_16x16x32_bf16 v[164:167], v[12:15], a[36:39], v[164:167]
    v_fma_f32 v82, v42, v243, v50
    v_fma_f32 v83, v43, v243, v51
    v_mfma_f32_16x16x32_bf16 v[168:171], v[16:19], a[32:35], v[168:171]
    ds_read_b128 v[12:15], v3 offset:54272
    v_fmac_f32 v76, v100, v241
    v_mfma_f32_16x16x32_bf16 v[172:175], v[16:19], a[36:39], v[172:175]
    v_fmac_f32 v77, v101, v241
    v_fmac_f32 v78, v102, v241
    buffer_load_dwordx4 v3, s[28:31], s27 offen offset:3072 lds
    s_waitcnt lgkmcnt(4)
    v_mfma_f32_16x16x32_bf16 v[144:147], v[20:23], a[40:43], v[144:147]
    ds_read_b128 v[16:19], v3 offset:55296
    v_fmac_f32 v79, v103, v241
    v_mfma_f32_16x16x32_bf16 v[148:151], v[20:23], a[44:47], v[148:151]
    v_fmac_f32 v80, v108, v241
    v_fmac_f32 v81, v109, v241
    v_mfma_f32_16x16x32_bf16 v[152:155], v[24:27], a[40:43], v[152:155]
    ds_read_b128 v[20:23], v3 offset:56320
    v_fmac_f32 v82, v110, v241
    v_mfma_f32_16x16x32_bf16 v[156:159], v[24:27], a[44:47], v[156:159]
    v_fmac_f32 v83, v111, v241
    s_add_u32 m0, s26, 16384
    s_add_u32 s27, s41, 245760
    buffer_load_dwordx4 v3, s[28:31], s27 offen offset:0 lds
    s_waitcnt lgkmcnt(4)
    v_mfma_f32_16x16x32_bf16 v[160:163], v[28:31], a[40:43], v[160:163]
    ds_read_b128 v[24:27], v3 offset:57344
    v_cvt_pk_bf16_f32 v100, v76, v77
    v_mfma_f32_16x16x32_bf16 v[164:167], v[28:31], a[44:47], v[164:167]
    v_cvt_pk_bf16_f32 v101, v78, v79
    v_cvt_pk_bf16_f32 v102, v80, v81
    v_mfma_f32_16x16x32_bf16 v[168:171], v[32:35], a[40:43], v[168:171]
    ds_read_b128 v[28:31], v3 offset:58368
    v_cvt_pk_bf16_f32 v103, v82, v83
    v_mfma_f32_16x16x32_bf16 v[172:175], v[32:35], a[44:47], v[172:175]
    v_pk_max_i16 v100, v100, 0
    v_pk_max_i16 v101, v101, 0
    buffer_load_dwordx4 v3, s[28:31], s27 offen offset:1024 lds
    s_waitcnt lgkmcnt(4)
    v_mfma_f32_16x16x32_bf16 v[144:147], v[8:11], a[48:51], v[144:147]
    ds_read_b128 v[32:35], v3 offset:59392
    v_pk_max_i16 v102, v102, 0
    v_mfma_f32_16x16x32_bf16 v[148:151], v[8:11], a[52:55], v[148:151]
    v_pk_max_i16 v103, v103, 0
    buffer_store_dwordx4 v[100:103], v3, s[28:31], s51 offen offset:0 sc1
    v_mfma_f32_16x16x32_bf16 v[152:155], v[12:15], a[48:51], v[152:155]
    ds_read_b128 v[8:11], v3 offset:60416
    v_mfma_f32_16x16x32_bf16 v[156:159], v[12:15], a[52:55], v[156:159]
    v_fma_f32 v68, v52, v242, v60
    ds_read_b128 v[36:39], v244 offset:256
    s_waitcnt lgkmcnt(5)
    v_mfma_f32_16x16x32_bf16 v[160:163], v[16:19], a[48:51], v[160:163]
    ds_read_b128 v[12:15], v3 offset:61440
    v_fma_f32 v69, v53, v242, v61
    v_mfma_f32_16x16x32_bf16 v[164:167], v[16:19], a[52:55], v[164:167]
    v_fma_f32 v70, v54, v242, v62
    v_fma_f32 v71, v55, v242, v63
    buffer_load_dwordx4 v3, s[28:31], s27 offen offset:2048 lds
    v_mfma_f32_16x16x32_bf16 v[168:171], v[20:23], a[48:51], v[168:171]
    ds_read_b128 v[16:19], v3 offset:62464
    v_fma_f32 v72, v56, v242, v64
    v_mfma_f32_16x16x32_bf16 v[172:175], v[20:23], a[52:55], v[172:175]
    v_fma_f32 v73, v57, v242, v65
    ds_read_b128 v[40:43], v244 offset:272
    s_waitcnt lgkmcnt(6)
    v_mfma_f32_16x16x32_bf16 v[144:147], v[24:27], a[56:59], v[144:147]
    ds_read_b128 v[20:23], v3 offset:63488
    v_fma_f32 v74, v58, v242, v66
    v_mfma_f32_16x16x32_bf16 v[148:151], v[24:27], a[60:63], v[148:151]
    v_fma_f32 v75, v59, v242, v67
    v_fmac_f32 v68, v112, v240
    buffer_load_dwordx4 v3, s[28:31], s27 offen offset:3072 lds
    v_mfma_f32_16x16x32_bf16 v[152:155], v[28:31], a[56:59], v[152:155]
    ds_read_b128 v[24:27], v3 offset:64512
    v_fmac_f32 v69, v113, v240
    v_mfma_f32_16x16x32_bf16 v[156:159], v[28:31], a[60:63], v[156:159]
    v_fmac_f32 v70, v114, v240
    ds_read_b128 v[44:47], v244 offset:1408
    s_waitcnt lgkmcnt(7)
    v_mfma_f32_16x16x32_bf16 v[160:163], v[32:35], a[56:59], v[160:163]
    ds_read_b128 v[28:31], v6 offset:0
    v_fmac_f32 v71, v115, v240
    v_mfma_f32_16x16x32_bf16 v[164:167], v[32:35], a[60:63], v[164:167]
    v_fmac_f32 v72, v120, v240
    v_fmac_f32 v73, v121, v240
    v_mfma_f32_16x16x32_bf16 v[168:171], v[8:11], a[56:59], v[168:171]
    ds_read_b128 v[32:35], v6 offset:1024
    v_fmac_f32 v74, v122, v240
    v_mfma_f32_16x16x32_bf16 v[172:175], v[8:11], a[60:63], v[172:175]
    v_fmac_f32 v75, v123, v240
    s_waitcnt lgkmcnt(6)
    v_mfma_f32_16x16x32_bf16 v[144:147], v[12:15], a[64:67], v[144:147]
    ds_read_b128 v[8:11], v6 offset:2048
    ds_read_b128 v[48:51], v244 offset:1424
    v_mfma_f32_16x16x32_bf16 v[148:151], v[12:15], a[68:71], v[148:151]
    v_cvt_pk_bf16_f32 v112, v68, v69
    v_cvt_pk_bf16_f32 v113, v70, v71
    v_mfma_f32_16x16x32_bf16 v[152:155], v[16:19], a[64:67], v[152:155]
    ds_read_b128 v[12:15], v6 offset:3072
    v_cvt_pk_bf16_f32 v114, v72, v73
    v_mfma_f32_16x16x32_bf16 v[156:159], v[16:19], a[68:71], v[156:159]
    v_cvt_pk_bf16_f32 v115, v74, v75
    v_pk_max_i16 v112, v112, 0
    s_waitcnt lgkmcnt(6)
    v_mfma_f32_16x16x32_bf16 v[160:163], v[20:23], a[64:67], v[160:163]
    ds_read_b128 v[16:19], v6 offset:4096
    v_pk_max_i16 v113, v113, 0
    v_mfma_f32_16x16x32_bf16 v[164:167], v[20:23], a[68:71], v[164:167]
    v_pk_max_i16 v114, v114, 0
    v_pk_max_i16 v115, v115, 0
    v_mfma_f32_16x16x32_bf16 v[168:171], v[24:27], a[64:67], v[168:171]
    ds_read_b128 v[20:23], v6 offset:5120
    buffer_store_dwordx4 v[112:115], v3, s[28:31], s50 offen offset:1024 sc1
    v_mfma_f32_16x16x32_bf16 v[172:175], v[24:27], a[68:71], v[172:175]
    v_fma_f32 v76, v52, v243, v60
    v_fma_f32 v77, v53, v243, v61
    s_waitcnt lgkmcnt(5)
    v_mfma_f32_16x16x32_bf16 v[144:147], v[28:31], a[72:75], v[144:147]
    ds_read_b128 v[24:27], v6 offset:6144
    v_fma_f32 v78, v54, v243, v62
    v_mfma_f32_16x16x32_bf16 v[148:151], v[28:31], a[76:79], v[148:151]
    v_fma_f32 v79, v55, v243, v63
    v_fma_f32 v80, v56, v243, v64
    v_mfma_f32_16x16x32_bf16 v[152:155], v[32:35], a[72:75], v[152:155]
    ds_read_b128 v[28:31], v6 offset:7168
    v_fma_f32 v81, v57, v243, v65
    v_mfma_f32_16x16x32_bf16 v[156:159], v[32:35], a[76:79], v[156:159]
    v_fma_f32 v82, v58, v243, v66
    v_fma_f32 v83, v59, v243, v67
    s_waitcnt lgkmcnt(4)
    v_mfma_f32_16x16x32_bf16 v[160:163], v[8:11], a[72:75], v[160:163]
    ds_read_b128 v[32:35], v6 offset:8192
    v_fmac_f32 v76, v116, v241
    v_mfma_f32_16x16x32_bf16 v[164:167], v[8:11], a[76:79], v[164:167]
    v_fmac_f32 v77, v117, v241
    v_fmac_f32 v78, v118, v241
    v_mfma_f32_16x16x32_bf16 v[168:171], v[12:15], a[72:75], v[168:171]
    ds_read_b128 v[8:11], v6 offset:9216
    v_fmac_f32 v79, v119, v241
    v_mfma_f32_16x16x32_bf16 v[172:175], v[12:15], a[76:79], v[172:175]
    v_fmac_f32 v80, v124, v241
    s_waitcnt lgkmcnt(4)
    v_mfma_f32_16x16x32_bf16 v[144:147], v[16:19], a[80:83], v[144:147]
    ds_read_b128 v[12:15], v6 offset:10240
    v_fmac_f32 v81, v125, v241
    v_mfma_f32_16x16x32_bf16 v[148:151], v[16:19], a[84:87], v[148:151]
    v_fmac_f32 v82, v126, v241
    v_fmac_f32 v83, v127, v241
    v_mfma_f32_16x16x32_bf16 v[152:155], v[20:23], a[80:83], v[152:155]
    ds_read_b128 v[16:19], v6 offset:11264
    v_cvt_pk_bf16_f32 v116, v76, v77
    v_mfma_f32_16x16x32_bf16 v[156:159], v[20:23], a[84:87], v[156:159]
    v_cvt_pk_bf16_f32 v117, v78, v79
    v_cvt_pk_bf16_f32 v118, v80, v81
    s_waitcnt lgkmcnt(4)
    v_mfma_f32_16x16x32_bf16 v[160:163], v[24:27], a[80:83], v[160:163]
    ds_read_b128 v[20:23], v6 offset:12288
    v_cvt_pk_bf16_f32 v119, v82, v83
    v_mfma_f32_16x16x32_bf16 v[164:167], v[24:27], a[84:87], v[164:167]
    v_pk_max_i16 v116, v116, 0
    v_pk_max_i16 v117, v117, 0
    v_mfma_f32_16x16x32_bf16 v[168:171], v[28:31], a[80:83], v[168:171]
    ds_read_b128 v[24:27], v6 offset:13312
    v_pk_max_i16 v118, v118, 0
    v_mfma_f32_16x16x32_bf16 v[172:175], v[28:31], a[84:87], v[172:175]
    v_pk_max_i16 v119, v119, 0
    buffer_store_dwordx4 v[116:119], v3, s[28:31], s51 offen offset:1024 sc1
    s_waitcnt lgkmcnt(4)
    v_mfma_f32_16x16x32_bf16 v[144:147], v[32:35], a[88:91], v[144:147]
    ds_read_b128 v[28:31], v6 offset:14336
    v_mfma_f32_16x16x32_bf16 v[148:151], v[32:35], a[92:95], v[148:151]
    v_fma_f32 v68, v36, v242, v44
    ds_read_b128 v[52:55], v244 offset:384
    v_mfma_f32_16x16x32_bf16 v[152:155], v[8:11], a[88:91], v[152:155]
    ds_read_b128 v[32:35], v6 offset:15360
    v_fma_f32 v69, v37, v242, v45
    v_mfma_f32_16x16x32_bf16 v[156:159], v[8:11], a[92:95], v[156:159]
    v_fma_f32 v70, v38, v242, v46
    v_fma_f32 v71, v39, v242, v47
    v_fma_f32 v72, v40, v242, v48
    v_fma_f32 v73, v41, v242, v49
    ds_read_b128 v[56:59], v244 offset:400
    s_waitcnt vmcnt(20)
    s_barrier
    s_waitcnt lgkmcnt(6)
    v_mfma_f32_16x16x32_bf16 v[160:163], v[12:15], a[88:91], v[160:163]
    ds_read_b128 v[8:11], v6 offset:16384
    s_add_u32 m0, s26, 32768
    v_mfma_f32_16x16x32_bf16 v[164:167], v[12:15], a[92:95], v[164:167]
    s_add_u32 s27, s41, 262144
    buffer_load_dwordx4 v3, s[28:31], s27 offen offset:0 lds
    v_mfma_f32_16x16x32_bf16 v[168:171], v[16:19], a[88:91], v[168:171]
    ds_read_b128 v[12:15], v6 offset:17408
    v_fma_f32 v74, v42, v242, v50
    v_mfma_f32_16x16x32_bf16 v[172:175], v[16:19], a[92:95], v[172:175]
    v_fma_f32 v75, v43, v242, v51
    v_fmac_f32 v68, v128, v240
    buffer_load_dwordx4 v3, s[28:31], s27 offen offset:1024 lds
    s_waitcnt lgkmcnt(6)
    v_mfma_f32_16x16x32_bf16 v[144:147], v[20:23], a[96:99], v[144:147]
    ds_read_b128 v[16:19], v6 offset:18432
    v_fmac_f32 v69, v129, v240
    v_mfma_f32_16x16x32_bf16 v[148:151], v[20:23], a[100:103], v[148:151]
    v_fmac_f32 v70, v130, v240
    ds_read_b128 v[60:63], v244 offset:1536
    v_mfma_f32_16x16x32_bf16 v[152:155], v[24:27], a[96:99], v[152:155]
    ds_read_b128 v[20:23], v6 offset:19456
    v_fmac_f32 v71, v131, v240
    v_mfma_f32_16x16x32_bf16 v[156:159], v[24:27], a[100:103], v[156:159]
    v_fmac_f32 v72, v136, v240
    buffer_load_dwordx4 v3, s[28:31], s27 offen offset:2048 lds
    s_waitcnt lgkmcnt(6)
    v_mfma_f32_16x16x32_bf16 v[160:163], v[28:31], a[96:99], v[160:163]
    ds_read_b128 v[24:27], v6 offset:20480
    v_fmac_f32 v73, v137, v240
    v_mfma_f32_16x16x32_bf16 v[164:167], v[28:31], a[100:103], v[164:167]
    v_fmac_f32 v74, v138, v240
    v_fmac_f32 v75, v139, v240
    v_mfma_f32_16x16x32_bf16 v[168:171], v[32:35], a[96:99], v[168:171]
    ds_read_b128 v[28:31], v6 offset:21504
    ds_read_b128 v[64:67], v244 offset:1552
    v_mfma_f32_16x16x32_bf16 v[172:175], v[32:35], a[100:103], v[172:175]
    v_cvt_pk_bf16_f32 v128, v68, v69
    v_cvt_pk_bf16_f32 v129, v70, v71
    buffer_load_dwordx4 v3, s[28:31], s27 offen offset:3072 lds
    s_waitcnt lgkmcnt(6)
    v_mfma_f32_16x16x32_bf16 v[144:147], v[8:11], a[104:107], v[144:147]
    ds_read_b128 v[32:35], v6 offset:22528
    v_cvt_pk_bf16_f32 v130, v72, v73
    v_mfma_f32_16x16x32_bf16 v[148:151], v[8:11], a[108:111], v[148:151]
    v_cvt_pk_bf16_f32 v131, v74, v75
    v_pk_max_i16 v128, v128, 0
    v_mfma_f32_16x16x32_bf16 v[152:155], v[12:15], a[104:107], v[152:155]
    ds_read_b128 v[8:11], v6 offset:23552
    v_pk_max_i16 v129, v129, 0
    v_mfma_f32_16x16x32_bf16 v[156:159], v[12:15], a[108:111], v[156:159]
    v_pk_max_i16 v130, v130, 0
    v_pk_max_i16 v131, v131, 0
    s_add_u32 m0, s26, 49152
    s_add_u32 s27, s41, 278528
    buffer_load_dwordx4 v3, s[28:31], s27 offen offset:0 lds
    s_waitcnt lgkmcnt(5)
    v_mfma_f32_16x16x32_bf16 v[160:163], v[16:19], a[104:107], v[160:163]
    ds_read_b128 v[12:15], v6 offset:24576
    buffer_store_dwordx4 v[128:131], v3, s[28:31], s50 offen offset:2048 sc1
    v_mfma_f32_16x16x32_bf16 v[164:167], v[16:19], a[108:111], v[164:167]
    v_fma_f32 v76, v36, v243, v44
    v_fma_f32 v77, v37, v243, v45
    v_mfma_f32_16x16x32_bf16 v[168:171], v[20:23], a[104:107], v[168:171]
    ds_read_b128 v[16:19], v6 offset:25600
    v_fma_f32 v78, v38, v243, v46
    v_mfma_f32_16x16x32_bf16 v[172:175], v[20:23], a[108:111], v[172:175]
    v_fma_f32 v79, v39, v243, v47
    v_fma_f32 v80, v40, v243, v48
    buffer_load_dwordx4 v3, s[28:31], s27 offen offset:1024 lds
    s_waitcnt lgkmcnt(5)
    v_mfma_f32_16x16x32_bf16 v[144:147], v[24:27], a[112:115], v[144:147]
    ds_read_b128 v[20:23], v6 offset:26624
    v_fma_f32 v81, v41, v243, v49
    v_mfma_f32_16x16x32_bf16 v[148:151], v[24:27], a[116:119], v[148:151]
    v_fma_f32 v82, v42, v243, v50
    v_fma_f32 v83, v43, v243, v51
    v_mfma_f32_16x16x32_bf16 v[152:155], v[28:31], a[112:115], v[152:155]
    ds_read_b128 v[24:27], v6 offset:27648
    v_fmac_f32 v76, v132, v241
    v_mfma_f32_16x16x32_bf16 v[156:159], v[28:31], a[116:119], v[156:159]
    v_fmac_f32 v77, v133, v241
    v_fmac_f32 v78, v134, v241
    s_waitcnt lgkmcnt(4)
    v_mfma_f32_16x16x32_bf16 v[160:163], v[32:35], a[112:115], v[160:163]
    ds_read_b128 v[28:31], v6 offset:28672
    v_fmac_f32 v79, v135, v241
    v_mfma_f32_16x16x32_bf16 v[164:167], v[32:35], a[116:119], v[164:167]
    v_fmac_f32 v80, v140, v241
    v_fmac_f32 v81, v141, v241
    v_mfma_f32_16x16x32_bf16 v[168:171], v[8:11], a[112:115], v[168:171]
    ds_read_b128 v[32:35], v6 offset:29696
    buffer_load_dwordx4 v3, s[28:31], s27 offen offset:2048 lds
    v_mfma_f32_16x16x32_bf16 v[172:175], v[8:11], a[116:119], v[172:175]
    v_fmac_f32 v82, v142, v241
    v_fmac_f32 v83, v143, v241
    s_waitcnt lgkmcnt(4)
    v_mfma_f32_16x16x32_bf16 v[144:147], v[12:15], a[120:123], v[144:147]
    ds_read_b128 v[8:11], v6 offset:30720
    v_cvt_pk_bf16_f32 v132, v76, v77
    v_mfma_f32_16x16x32_bf16 v[148:151], v[12:15], a[124:127], v[148:151]
    v_cvt_pk_bf16_f32 v133, v78, v79
    v_cvt_pk_bf16_f32 v134, v80, v81
    buffer_load_dwordx4 v3, s[28:31], s27 offen offset:3072 lds
    v_mfma_f32_16x16x32_bf16 v[152:155], v[16:19], a[120:123], v[152:155]
    ds_read_b128 v[12:15], v6 offset:31744
    v_cvt_pk_bf16_f32 v135, v82, v83
    v_mfma_f32_16x16x32_bf16 v[156:159], v[16:19], a[124:127], v[156:159]
    v_pk_max_i16 v132, v132, 0
    v_pk_max_i16 v133, v133, 0
    s_waitcnt lgkmcnt(4)
    v_mfma_f32_16x16x32_bf16 v[160:163], v[20:23], a[120:123], v[160:163]
    ds_read_b128 v[16:19], v6 offset:32768
    v_pk_max_i16 v134, v134, 0
    v_mfma_f32_16x16x32_bf16 v[164:167], v[20:23], a[124:127], v[164:167]
    v_pk_max_i16 v135, v135, 0
    buffer_store_dwordx4 v[132:135], v3, s[28:31], s51 offen offset:2048 sc1
    v_mfma_f32_16x16x32_bf16 v[168:171], v[24:27], a[120:123], v[168:171]
    ds_read_b128 v[20:23], v6 offset:33792
    v_mfma_f32_16x16x32_bf16 v[172:175], v[24:27], a[124:127], v[172:175]
    s_waitcnt lgkmcnt(4)
    v_mfma_f32_16x16x32_bf16 v[144:147], v[28:31], a[128:131], v[144:147]
    ds_read_b128 v[24:27], v6 offset:34816
    v_mfma_f32_16x16x32_bf16 v[148:151], v[28:31], a[132:135], v[148:151]
    v_mfma_f32_16x16x32_bf16 v[152:155], v[32:35], a[128:131], v[152:155]
    ds_read_b128 v[28:31], v6 offset:35840
    v_mfma_f32_16x16x32_bf16 v[156:159], v[32:35], a[132:135], v[156:159]
    s_waitcnt lgkmcnt(4)
    v_mfma_f32_16x16x32_bf16 v[160:163], v[8:11], a[128:131], v[160:163]
    ds_read_b128 v[32:35], v6 offset:36864
    v_mfma_f32_16x16x32_bf16 v[164:167], v[8:11], a[132:135], v[164:167]
    v_mfma_f32_16x16x32_bf16 v[168:171], v[12:15], a[128:131], v[168:171]
    ds_read_b128 v[8:11], v6 offset:37888
    v_mfma_f32_16x16x32_bf16 v[172:175], v[12:15], a[132:135], v[172:175]
    s_waitcnt lgkmcnt(4)
    v_mfma_f32_16x16x32_bf16 v[144:147], v[16:19], a[136:139], v[144:147]
    ds_read_b128 v[12:15], v6 offset:38912
    v_mfma_f32_16x16x32_bf16 v[148:151], v[16:19], a[140:143], v[148:151]
    v_mfma_f32_16x16x32_bf16 v[152:155], v[20:23], a[136:139], v[152:155]
    ds_read_b128 v[16:19], v6 offset:39936
    v_mfma_f32_16x16x32_bf16 v[156:159], v[20:23], a[140:143], v[156:159]
    s_waitcnt lgkmcnt(4)
    v_mfma_f32_16x16x32_bf16 v[160:163], v[24:27], a[136:139], v[160:163]
    ds_read_b128 v[20:23], v6 offset:40960
    v_mfma_f32_16x16x32_bf16 v[164:167], v[24:27], a[140:143], v[164:167]
    v_mfma_f32_16x16x32_bf16 v[168:171], v[28:31], a[136:139], v[168:171]
    ds_read_b128 v[24:27], v6 offset:41984
    v_mfma_f32_16x16x32_bf16 v[172:175], v[28:31], a[140:143], v[172:175]
    s_waitcnt lgkmcnt(4)
    v_mfma_f32_16x16x32_bf16 v[176:179], v[32:35], a[0:3], 0
    ds_read_b128 v[28:31], v6 offset:43008
    v_mfma_f32_16x16x32_bf16 v[180:183], v[32:35], a[4:7], 0
    v_mfma_f32_16x16x32_bf16 v[184:187], v[8:11], a[0:3], 0
    ds_read_b128 v[32:35], v6 offset:44032
    v_mfma_f32_16x16x32_bf16 v[188:191], v[8:11], a[4:7], 0
    s_waitcnt lgkmcnt(4)
    v_mfma_f32_16x16x32_bf16 v[192:195], v[12:15], a[0:3], 0
    ds_read_b128 v[8:11], v6 offset:45056
    v_mfma_f32_16x16x32_bf16 v[196:199], v[12:15], a[4:7], 0
    s_mul_i32 s50, s20, 2048
    v_mfma_f32_16x16x32_bf16 v[200:203], v[16:19], a[0:3], 0
    ds_read_b128 v[12:15], v6 offset:46080
    ds_read_b128 v[36:39], v244 offset:512
    v_mfma_f32_16x16x32_bf16 v[204:207], v[16:19], a[4:7], 0
    s_add_u32 s50, s50, 12288
    s_waitcnt lgkmcnt(5)
    v_mfma_f32_16x16x32_bf16 v[176:179], v[20:23], a[8:11], v[176:179]
    ds_read_b128 v[16:19], v6 offset:47104
    s_add_u32 s51, s50, s61
    v_mfma_f32_16x16x32_bf16 v[180:183], v[20:23], a[12:15], v[180:183]
    s_add_u32 s50, s50, s60
    v_mfma_f32_16x16x32_bf16 v[184:187], v[24:27], a[8:11], v[184:187]
    ds_read_b128 v[20:23], v6 offset:48128
    v_fma_f32 v68, v52, v242, v60
    v_mfma_f32_16x16x32_bf16 v[188:191], v[24:27], a[12:15], v[188:191]
    v_fma_f32 v69, v53, v242, v61
    s_waitcnt vmcnt(22)
    s_barrier
    s_waitcnt lgkmcnt(5)
    v_mfma_f32_16x16x32_bf16 v[192:195], v[28:31], a[8:11], v[192:195]
    ds_read_b128 v[24:27], v6 offset:49152
    s_add_u32 m0, s26, 65536
    v_mfma_f32_16x16x32_bf16 v[196:199], v[28:31], a[12:15], v[196:199]
    s_add_u32 s27, s41, 294912
    buffer_load_dwordx4 v3, s[28:31], s27 offen offset:0 lds
    v_mfma_f32_16x16x32_bf16 v[200:203], v[32:35], a[8:11], v[200:203]
    ds_read_b128 v[28:31], v6 offset:50176
    ds_read_b128 v[40:43], v244 offset:528
    v_mfma_f32_16x16x32_bf16 v[204:207], v[32:35], a[12:15], v[204:207]
    v_fma_f32 v70, v54, v242, v62
    s_waitcnt lgkmcnt(6)
    v_mfma_f32_16x16x32_bf16 v[176:179], v[8:11], a[16:19], v[176:179]
    ds_read_b128 v[32:35], v6 offset:51200
    buffer_load_dwordx4 v3, s[28:31], s27 offen offset:1024 lds
    v_mfma_f32_16x16x32_bf16 v[180:183], v[8:11], a[20:23], v[180:183]
    v_fma_f32 v71, v55, v242, v63
    v_fma_f32 v72, v56, v242, v64
    v_mfma_f32_16x16x32_bf16 v[184:187], v[12:15], a[16:19], v[184:187]
    ds_read_b128 v[8:11], v6 offset:52224
    v_fma_f32 v73, v57, v242, v65
    v_mfma_f32_16x16x32_bf16 v[188:191], v[12:15], a[20:23], v[188:191]
    buffer_load_dwordx4 v3, s[28:31], s27 offen offset:2048 lds
    s_waitcnt lgkmcnt(5)
    v_mfma_f32_16x16x32_bf16 v[192:195], v[16:19], a[16:19], v[192:195]
    ds_read_b128 v[12:15], v6 offset:53248
    v_fma_f32 v74, v58, v242, v66
    v_mfma_f32_16x16x32_bf16 v[196:199], v[16:19], a[20:23], v[196:199]
    ds_read_b128 v[44:47], v244 offset:1664
    v_fma_f32 v75, v59, v242, v67
    v_mfma_f32_16x16x32_bf16 v[200:203], v[20:23], a[16:19], v[200:203]
    ds_read_b128 v[16:19], v6 offset:54272
    v_fmac_f32 v68, v144, v240
    v_mfma_f32_16x16x32_bf16 v[204:207], v[20:23], a[20:23], v[204:207]
    buffer_load_dwordx4 v3, s[28:31], s27 offen offset:3072 lds
    s_waitcnt lgkmcnt(6)
    v_mfma_f32_16x16x32_bf16 v[176:179], v[24:27], a[24:27], v[176:179]
    ds_read_b128 v[20:23], v6 offset:55296
    v_fmac_f32 v69, v145, v240
    v_mfma_f32_16x16x32_bf16 v[180:183], v[24:27], a[28:31], v[180:183]
    v_fmac_f32 v70, v146, v240
    v_fmac_f32 v71, v147, v240
    v_mfma_f32_16x16x32_bf16 v[184:187], v[28:31], a[24:27], v[184:187]
    ds_read_b128 v[24:27], v6 offset:56320
    ds_read_b128 v[48:51], v244 offset:1680
    v_mfma_f32_16x16x32_bf16 v[188:191], v[28:31], a[28:31], v[188:191]
    s_add_u32 m0, s26, 81920
    s_add_u32 s27, s41, 311296
    s_waitcnt lgkmcnt(6)
    v_mfma_f32_16x16x32_bf16 v[192:195], v[32:35], a[24:27], v[192:195]
    ds_read_b128 v[28:31], v6 offset:57344
    buffer_load_dwordx4 v3, s[28:31], s27 offen offset:0 lds
    v_mfma_f32_16x16x32_bf16 v[196:199], v[32:35], a[28:31], v[196:199]
    v_fmac_f32 v72, v152, v240
    v_fmac_f32 v73, v153, v240
    v_mfma_f32_16x16x32_bf16 v[200:203], v[8:11], a[24:27], v[200:203]
    ds_read_b128 v[32:35], v6 offset:58368
    v_fmac_f32 v74, v154, v240
    v_mfma_f32_16x16x32_bf16 v[204:207], v[8:11], a[28:31], v[204:207]
    v_fmac_f32 v75, v155, v240
    s_waitcnt lgkmcnt(5)
    v_mfma_f32_16x16x32_bf16 v[176:179], v[12:15], a[32:35], v[176:179]
    ds_read_b128 v[8:11], v6 offset:59392
    buffer_load_dwordx4 v3, s[28:31], s27 offen offset:1024 lds
    v_mfma_f32_16x16x32_bf16 v[180:183], v[12:15], a[36:39], v[180:183]
    v_cvt_pk_bf16_f32 v144, v68, v69
    v_cvt_pk_bf16_f32 v145, v70, v71
    v_mfma_f32_16x16x32_bf16 v[184:187], v[16:19], a[32:35], v[184:187]
    ds_read_b128 v[12:15], v6 offset:60416
    v_cvt_pk_bf16_f32 v146, v72, v73
    v_mfma_f32_16x16x32_bf16 v[188:191], v[16:19], a[36:39], v[188:191]
    v_cvt_pk_bf16_f32 v147, v74, v75
    s_waitcnt lgkmcnt(5)
    v_mfma_f32_16x16x32_bf16 v[192:195], v[20:23], a[32:35], v[192:195]
    ds_read_b128 v[16:19], v6 offset:61440
    v_pk_max_i16 v144, v144, 0
    v_mfma_f32_16x16x32_bf16 v[196:199], v[20:23], a[36:39], v[196:199]
    v_pk_max_i16 v145, v145, 0
    buffer_load_dwordx4 v3, s[28:31], s27 offen offset:2048 lds
    v_mfma_f32_16x16x32_bf16 v[200:203], v[24:27], a[32:35], v[200:203]
    ds_read_b128 v[20:23], v6 offset:62464
    v_pk_max_i16 v146, v146, 0
    v_mfma_f32_16x16x32_bf16 v[204:207], v[24:27], a[36:39], v[204:207]
    v_pk_max_i16 v147, v147, 0
    s_waitcnt lgkmcnt(4)
    v_mfma_f32_16x16x32_bf16 v[176:179], v[28:31], a[40:43], v[176:179]
    ds_read_b128 v[24:27], v6 offset:63488
    buffer_store_dwordx4 v[144:147], v3, s[28:31], s50 offen offset:0 sc1
    v_mfma_f32_16x16x32_bf16 v[180:183], v[28:31], a[44:47], v[180:183]
    buffer_load_dwordx4 v3, s[28:31], s27 offen offset:3072 lds
    v_fma_f32 v76, v52, v243, v60
    v_mfma_f32_16x16x32_bf16 v[184:187], v[32:35], a[40:43], v[184:187]
    ds_read_b128 v[28:31], v6 offset:64512
    v_fma_f32 v77, v53, v243, v61
    v_mfma_f32_16x16x32_bf16 v[188:191], v[32:35], a[44:47], v[188:191]
    v_fma_f32 v78, v54, v243, v62
    s_waitcnt lgkmcnt(4)
    v_mfma_f32_16x16x32_bf16 v[192:195], v[8:11], a[40:43], v[192:195]
    ds_read_b128 v[32:35], v7 offset:0
    v_fma_f32 v79, v55, v243, v63
    v_mfma_f32_16x16x32_bf16 v[196:199], v[8:11], a[44:47], v[196:199]
    v_fma_f32 v80, v56, v243, v64
    v_fma_f32 v81, v57, v243, v65
    v_mfma_f32_16x16x32_bf16 v[200:203], v[12:15], a[40:43], v[200:203]
    ds_read_b128 v[8:11], v7 offset:1024
    v_fma_f32 v82, v58, v243, v66
    v_mfma_f32_16x16x32_bf16 v[204:207], v[12:15], a[44:47], v[204:207]
    v_fma_f32 v83, v59, v243, v67
    s_waitcnt lgkmcnt(4)
    v_mfma_f32_16x16x32_bf16 v[176:179], v[16:19], a[48:51], v[176:179]
    ds_read_b128 v[12:15], v7 offset:2048
    v_fmac_f32 v76, v148, v241
    v_mfma_f32_16x16x32_bf16 v[180:183], v[16:19], a[52:55], v[180:183]
    v_fmac_f32 v77, v149, v241
    v_mfma_f32_16x16x32_bf16 v[184:187], v[20:23], a[48:51], v[184:187]
    ds_read_b128 v[16:19], v7 offset:3072
    v_fmac_f32 v78, v150, v241
    v_mfma_f32_16x16x32_bf16 v[188:191], v[20:23], a[52:55], v[188:191]
    v_fmac_f32 v79, v151, v241
    s_waitcnt lgkmcnt(4)
    v_mfma_f32_16x16x32_bf16 v[192:195], v[24:27], a[48:51], v[192:195]
    ds_read_b128 v[20:23], v7 offset:4096
    v_fmac_f32 v80, v156, v241
    v_mfma_f32_16x16x32_bf16 v[196:199], v[24:27], a[52:55], v[196:199]
    v_fmac_f32 v81, v157, v241
    v_mfma_f32_16x16x32_bf16 v[200:203], v[28:31], a[48:51], v[200:203]
    ds_read_b128 v[24:27], v7 offset:5120
    v_fmac_f32 v82, v158, v241
    v_mfma_f32_16x16x32_bf16 v[204:207], v[28:31], a[52:55], v[204:207]
    v_fmac_f32 v83, v159, v241
    s_waitcnt lgkmcnt(4)
    v_mfma_f32_16x16x32_bf16 v[176:179], v[32:35], a[56:59], v[176:179]
    ds_read_b128 v[28:31], v7 offset:6144
    v_cvt_pk_bf16_f32 v148, v76, v77
    v_mfma_f32_16x16x32_bf16 v[180:183], v[32:35], a[60:63], v[180:183]
    v_cvt_pk_bf16_f32 v149, v78, v79
    v_mfma_f32_16x16x32_bf16 v[184:187], v[8:11], a[56:59], v[184:187]
    ds_read_b128 v[32:35], v7 offset:7168
    v_cvt_pk_bf16_f32 v150, v80, v81
    v_mfma_f32_16x16x32_bf16 v[188:191], v[8:11], a[60:63], v[188:191]
    v_cvt_pk_bf16_f32 v151, v82, v83
    s_waitcnt lgkmcnt(4)
    v_mfma_f32_16x16x32_bf16 v[192:195], v[12:15], a[56:59], v[192:195]
    ds_read_b128 v[8:11], v7 offset:8192
    v_pk_max_i16 v148, v148, 0
    v_mfma_f32_16x16x32_bf16 v[196:199], v[12:15], a[60:63], v[196:199]
    v_mfma_f32_16x16x32_bf16 v[200:203], v[16:19], a[56:59], v[200:203]
    ds_read_b128 v[12:15], v7 offset:9216
    v_pk_max_i16 v149, v149, 0
    v_mfma_f32_16x16x32_bf16 v[204:207], v[16:19], a[60:63], v[204:207]
    v_pk_max_i16 v150, v150, 0
    s_waitcnt lgkmcnt(4)
    v_mfma_f32_16x16x32_bf16 v[176:179], v[20:23], a[64:67], v[176:179]
    ds_read_b128 v[16:19], v7 offset:10240
    v_pk_max_i16 v151, v151, 0
    v_mfma_f32_16x16x32_bf16 v[180:183], v[20:23], a[68:71], v[180:183]
    buffer_store_dwordx4 v[148:151], v3, s[28:31], s51 offen offset:0 sc1
    v_mfma_f32_16x16x32_bf16 v[184:187], v[24:27], a[64:67], v[184:187]
    ds_read_b128 v[20:23], v7 offset:11264
    v_mfma_f32_16x16x32_bf16 v[188:191], v[24:27], a[68:71], v[188:191]
    v_fma_f32 v68, v36, v242, v44
    s_waitcnt lgkmcnt(4)
    v_mfma_f32_16x16x32_bf16 v[192:195], v[28:31], a[64:67], v[192:195]
    ds_read_b128 v[24:27], v7 offset:12288
    ds_read_b128 v[52:55], v244 offset:640
    v_mfma_f32_16x16x32_bf16 v[196:199], v[28:31], a[68:71], v[196:199]
    v_fma_f32 v69, v37, v242, v45
    v_mfma_f32_16x16x32_bf16 v[200:203], v[32:35], a[64:67], v[200:203]
    ds_read_b128 v[28:31], v7 offset:13312
    v_fma_f32 v70, v38, v242, v46
    v_mfma_f32_16x16x32_bf16 v[204:207], v[32:35], a[68:71], v[204:207]
    v_fma_f32 v71, v39, v242, v47
    s_waitcnt lgkmcnt(5)
    v_mfma_f32_16x16x32_bf16 v[176:179], v[8:11], a[72:75], v[176:179]
    ds_read_b128 v[32:35], v7 offset:14336
    v_fma_f32 v72, v40, v242, v48
    v_mfma_f32_16x16x32_bf16 v[180:183], v[8:11], a[76:79], v[180:183]
    v_fma_f32 v73, v41, v242, v49
    v_mfma_f32_16x16x32_bf16 v[184:187], v[12:15], a[72:75], v[184:187]
    ds_read_b128 v[8:11], v7 offset:15360
    ds_read_b128 v[56:59], v244 offset:656
    v_mfma_f32_16x16x32_bf16 v[188:191], v[12:15], a[76:79], v[188:191]
    v_fma_f32 v74, v42, v242, v50
    s_waitcnt vmcnt(10)
    s_barrier
    s_cmp_lg_u32 s18, 0
    s_cbranch_scc1 k8_kernel_sig7
    s_mov_b64 exec, 0xff
    buffer_store_dwordx4 v[244:247], v94, s[28:31], s44 offen offset:0 sc1
    s_mov_b64 exec, -1
k8_kernel_sig7:
    s_waitcnt lgkmcnt(6)
    v_mfma_f32_16x16x32_bf16 v[192:195], v[16:19], a[72:75], v[192:195]
    ds_read_b128 v[12:15], v3 offset:0
    s_add_u32 m0, s26, 98304
    v_mfma_f32_16x16x32_bf16 v[196:199], v[16:19], a[76:79], v[196:199]
    s_add_u32 s27, s41, 327680
    buffer_load_dwordx4 v3, s[28:31], s27 offen offset:0 lds
    v_mfma_f32_16x16x32_bf16 v[200:203], v[20:23], a[72:75], v[200:203]
    ds_read_b128 v[16:19], v3 offset:1024
    v_fma_f32 v75, v43, v242, v51
    v_mfma_f32_16x16x32_bf16 v[204:207], v[20:23], a[76:79], v[204:207]
    v_fmac_f32 v68, v160, v240
    s_waitcnt lgkmcnt(5)
    v_mfma_f32_16x16x32_bf16 v[176:179], v[24:27], a[80:83], v[176:179]
    ds_read_b128 v[20:23], v3 offset:2048
    buffer_load_dwordx4 v3, s[28:31], s27 offen offset:1024 lds
    v_mfma_f32_16x16x32_bf16 v[180:183], v[24:27], a[84:87], v[180:183]
    v_fmac_f32 v69, v161, v240
    v_fmac_f32 v70, v162, v240
    v_mfma_f32_16x16x32_bf16 v[184:187], v[28:31], a[80:83], v[184:187]
    ds_read_b128 v[24:27], v3 offset:3072
    ds_read_b128 v[60:63], v244 offset:1792
    v_mfma_f32_16x16x32_bf16 v[188:191], v[28:31], a[84:87], v[188:191]
    v_fmac_f32 v71, v163, v240
    s_waitcnt lgkmcnt(6)
    v_mfma_f32_16x16x32_bf16 v[192:195], v[32:35], a[80:83], v[192:195]
    ds_read_b128 v[28:31], v3 offset:4096
    buffer_load_dwordx4 v3, s[28:31], s27 offen offset:2048 lds
    v_mfma_f32_16x16x32_bf16 v[196:199], v[32:35], a[84:87], v[196:199]
    v_fmac_f32 v72, v168, v240
    v_fmac_f32 v73, v169, v240
    v_mfma_f32_16x16x32_bf16 v[200:203], v[8:11], a[80:83], v[200:203]
    ds_read_b128 v[32:35], v3 offset:5120
    v_fmac_f32 v74, v170, v240
    v_mfma_f32_16x16x32_bf16 v[204:207], v[8:11], a[84:87], v[204:207]
    buffer_load_dwordx4 v3, s[28:31], s27 offen offset:3072 lds
    s_waitcnt lgkmcnt(5)
    v_mfma_f32_16x16x32_bf16 v[176:179], v[12:15], a[88:91], v[176:179]
    ds_read_b128 v[8:11], v3 offset:6144
    v_fmac_f32 v75, v171, v240
    v_mfma_f32_16x16x32_bf16 v[180:183], v[12:15], a[92:95], v[180:183]
    ds_read_b128 v[64:67], v244 offset:1808
    v_cvt_pk_bf16_f32 v160, v68, v69
    v_mfma_f32_16x16x32_bf16 v[184:187], v[16:19], a[88:91], v[184:187]
    ds_read_b128 v[12:15], v3 offset:7168
    v_cvt_pk_bf16_f32 v161, v70, v71
    v_mfma_f32_16x16x32_bf16 v[188:191], v[16:19], a[92:95], v[188:191]
    s_add_u32 m0, s26, 114688
    s_add_u32 s27, s42, 0
    s_waitcnt lgkmcnt(6)
    v_mfma_f32_16x16x32_bf16 v[192:195], v[20:23], a[88:91], v[192:195]
    ds_read_b128 v[16:19], v3 offset:8192
    buffer_load_dwordx4 v3, s[28:31], s27 offen offset:0 lds
    v_mfma_f32_16x16x32_bf16 v[196:199], v[20:23], a[92:95], v[196:199]
    v_cvt_pk_bf16_f32 v162, v72, v73
    v_cvt_pk_bf16_f32 v163, v74, v75
    v_mfma_f32_16x16x32_bf16 v[200:203], v[24:27], a[88:91], v[200:203]
    ds_read_b128 v[20:23], v3 offset:9216
    v_pk_max_i16 v160, v160, 0
    v_mfma_f32_16x16x32_bf16 v[204:207], v[24:27], a[92:95], v[204:207]
    v_pk_max_i16 v161, v161, 0
    s_waitcnt lgkmcnt(5)
    v_mfma_f32_16x16x32_bf16 v[176:179], v[28:31], a[96:99], v[176:179]
    ds_read_b128 v[24:27], v3 offset:10240
    buffer_load_dwordx4 v3, s[28:31], s27 offen offset:1024 lds
    v_mfma_f32_16x16x32_bf16 v[180:183], v[28:31], a[100:103], v[180:183]
    v_pk_max_i16 v162, v162, 0
    v_pk_max_i16 v163, v163, 0
    v_mfma_f32_16x16x32_bf16 v[184:187], v[32:35], a[96:99], v[184:187]
    ds_read_b128 v[28:31], v3 offset:11264
    buffer_store_dwordx4 v[160:163], v3, s[28:31], s50 offen offset:1024 sc1
    v_mfma_f32_16x16x32_bf16 v[188:191], v[32:35], a[100:103], v[188:191]
    v_fma_f32 v76, v36, v243, v44
    s_waitcnt lgkmcnt(4)
    v_mfma_f32_16x16x32_bf16 v[192:195], v[8:11], a[96:99], v[192:195]
    ds_read_b128 v[32:35], v3 offset:12288
    v_fma_f32 v77, v37, v243, v45
    v_mfma_f32_16x16x32_bf16 v[196:199], v[8:11], a[100:103], v[196:199]
    v_fma_f32 v78, v38, v243, v46
    buffer_load_dwordx4 v3, s[28:31], s27 offen offset:2048 lds
    v_mfma_f32_16x16x32_bf16 v[200:203], v[12:15], a[96:99], v[200:203]
    ds_read_b128 v[8:11], v3 offset:13312
    v_fma_f32 v79, v39, v243, v47
    v_mfma_f32_16x16x32_bf16 v[204:207], v[12:15], a[100:103], v[204:207]
    v_fma_f32 v80, v40, v243, v48
    s_waitcnt lgkmcnt(4)
    v_mfma_f32_16x16x32_bf16 v[176:179], v[16:19], a[104:107], v[176:179]
    ds_read_b128 v[12:15], v3 offset:14336
    v_fma_f32 v81, v41, v243, v49
    v_mfma_f32_16x16x32_bf16 v[180:183], v[16:19], a[108:111], v[180:183]
    v_fma_f32 v82, v42, v243, v50
    buffer_load_dwordx4 v3, s[28:31], s27 offen offset:3072 lds
    v_mfma_f32_16x16x32_bf16 v[184:187], v[20:23], a[104:107], v[184:187]
    ds_read_b128 v[16:19], v3 offset:15360
    v_fma_f32 v83, v43, v243, v51
    v_mfma_f32_16x16x32_bf16 v[188:191], v[20:23], a[108:111], v[188:191]
    v_fmac_f32 v76, v164, v241
    s_waitcnt lgkmcnt(4)
    v_mfma_f32_16x16x32_bf16 v[192:195], v[24:27], a[104:107], v[192:195]
    ds_read_b128 v[20:23], v3 offset:16384
    v_fmac_f32 v77, v165, v241
    v_mfma_f32_16x16x32_bf16 v[196:199], v[24:27], a[108:111], v[196:199]
    buffer_load_dword v84, v247, s[28:31], s44 offen offset:0 sc1
    v_fmac_f32 v78, v166, v241
    v_mfma_f32_16x16x32_bf16 v[200:203], v[28:31], a[104:107], v[200:203]
    ds_read_b128 v[24:27], v3 offset:17408
    v_fmac_f32 v79, v167, v241
    v_mfma_f32_16x16x32_bf16 v[204:207], v[28:31], a[108:111], v[204:207]
    v_fmac_f32 v80, v172, v241
    s_waitcnt lgkmcnt(4)
    v_mfma_f32_16x16x32_bf16 v[176:179], v[32:35], a[112:115], v[176:179]
    ds_read_b128 v[28:31], v3 offset:18432
    v_fmac_f32 v81, v173, v241
    v_mfma_f32_16x16x32_bf16 v[180:183], v[32:35], a[116:119], v[180:183]
    v_fmac_f32 v82, v174, v241
    v_fmac_f32 v83, v175, v241
    v_mfma_f32_16x16x32_bf16 v[184:187], v[8:11], a[112:115], v[184:187]
    ds_read_b128 v[32:35], v3 offset:19456
    v_cvt_pk_bf16_f32 v164, v76, v77
    v_mfma_f32_16x16x32_bf16 v[188:191], v[8:11], a[116:119], v[188:191]
    v_cvt_pk_bf16_f32 v165, v78, v79
    s_waitcnt lgkmcnt(4)
    v_mfma_f32_16x16x32_bf16 v[192:195], v[12:15], a[112:115], v[192:195]
    ds_read_b128 v[8:11], v3 offset:20480
    v_cvt_pk_bf16_f32 v166, v80, v81
    v_mfma_f32_16x16x32_bf16 v[196:199], v[12:15], a[116:119], v[196:199]
    v_cvt_pk_bf16_f32 v167, v82, v83
    v_mfma_f32_16x16x32_bf16 v[200:203], v[16:19], a[112:115], v[200:203]
    ds_read_b128 v[12:15], v3 offset:21504
    v_pk_max_i16 v164, v164, 0
    v_mfma_f32_16x16x32_bf16 v[204:207], v[16:19], a[116:119], v[204:207]
    v_pk_max_i16 v165, v165, 0
    s_waitcnt lgkmcnt(4)
    v_mfma_f32_16x16x32_bf16 v[176:179], v[20:23], a[120:123], v[176:179]
    ds_read_b128 v[16:19], v3 offset:22528
    v_pk_max_i16 v166, v166, 0
    v_mfma_f32_16x16x32_bf16 v[180:183], v[20:23], a[124:127], v[180:183]
    v_pk_max_i16 v167, v167, 0
    v_mfma_f32_16x16x32_bf16 v[184:187], v[24:27], a[120:123], v[184:187]
    ds_read_b128 v[20:23], v3 offset:23552
    buffer_store_dwordx4 v[164:167], v3, s[28:31], s51 offen offset:1024 sc1
    v_mfma_f32_16x16x32_bf16 v[188:191], v[24:27], a[124:127], v[188:191]
    s_waitcnt lgkmcnt(4)
    v_mfma_f32_16x16x32_bf16 v[192:195], v[28:31], a[120:123], v[192:195]
    ds_read_b128 v[24:27], v3 offset:24576
    v_mfma_f32_16x16x32_bf16 v[196:199], v[28:31], a[124:127], v[196:199]
    v_mfma_f32_16x16x32_bf16 v[200:203], v[32:35], a[120:123], v[200:203]
    ds_read_b128 v[28:31], v3 offset:25600
    v_mfma_f32_16x16x32_bf16 v[204:207], v[32:35], a[124:127], v[204:207]
    s_waitcnt lgkmcnt(4)
    v_mfma_f32_16x16x32_bf16 v[176:179], v[8:11], a[128:131], v[176:179]
    ds_read_b128 v[32:35], v3 offset:26624
    v_mfma_f32_16x16x32_bf16 v[180:183], v[8:11], a[132:135], v[180:183]
    v_mfma_f32_16x16x32_bf16 v[184:187], v[12:15], a[128:131], v[184:187]
    ds_read_b128 v[8:11], v3 offset:27648
    v_mfma_f32_16x16x32_bf16 v[188:191], v[12:15], a[132:135], v[188:191]
    s_waitcnt lgkmcnt(4)
    v_mfma_f32_16x16x32_bf16 v[192:195], v[16:19], a[128:131], v[192:195]
    ds_read_b128 v[12:15], v3 offset:28672
    v_mfma_f32_16x16x32_bf16 v[196:199], v[16:19], a[132:135], v[196:199]
    v_mfma_f32_16x16x32_bf16 v[200:203], v[20:23], a[128:131], v[200:203]
    ds_read_b128 v[16:19], v3 offset:29696
    v_mfma_f32_16x16x32_bf16 v[204:207], v[20:23], a[132:135], v[204:207]
    s_waitcnt lgkmcnt(4)
    v_mfma_f32_16x16x32_bf16 v[176:179], v[24:27], a[136:139], v[176:179]
    ds_read_b128 v[20:23], v3 offset:30720
    v_mfma_f32_16x16x32_bf16 v[180:183], v[24:27], a[140:143], v[180:183]
    v_mfma_f32_16x16x32_bf16 v[184:187], v[28:31], a[136:139], v[184:187]
    ds_read_b128 v[24:27], v3 offset:31744
    v_mfma_f32_16x16x32_bf16 v[188:191], v[28:31], a[140:143], v[188:191]
    s_barrier
    s_waitcnt lgkmcnt(4)
    v_mfma_f32_16x16x32_bf16 v[192:195], v[32:35], a[136:139], v[192:195]
    ds_read_b128 v[28:31], v3 offset:32768
    s_add_u32 m0, s26, 131072
    v_mfma_f32_16x16x32_bf16 v[196:199], v[32:35], a[140:143], v[196:199]
    s_add_u32 s27, s42, 16384
    buffer_load_dwordx4 v3, s[28:31], s27 offen offset:0 lds
    v_mfma_f32_16x16x32_bf16 v[200:203], v[8:11], a[136:139], v[200:203]
    ds_read_b128 v[32:35], v3 offset:33792
    buffer_load_dwordx4 v3, s[28:31], s27 offen offset:1024 lds
    v_mfma_f32_16x16x32_bf16 v[204:207], v[8:11], a[140:143], v[204:207]
    s_waitcnt lgkmcnt(4)
    v_mfma_f32_16x16x32_bf16 v[208:211], v[12:15], a[0:3], 0
    ds_read_b128 v[8:11], v3 offset:34816
    v_mfma_f32_16x16x32_bf16 v[212:215], v[12:15], a[4:7], 0
    v_mfma_f32_16x16x32_bf16 v[216:219], v[16:19], a[0:3], 0
    ds_read_b128 v[12:15], v3 offset:35840
    buffer_load_dwordx4 v3, s[28:31], s27 offen offset:2048 lds
    v_mfma_f32_16x16x32_bf16 v[220:223], v[16:19], a[4:7], 0
    s_waitcnt lgkmcnt(4)
    v_mfma_f32_16x16x32_bf16 v[224:227], v[20:23], a[0:3], 0
    ds_read_b128 v[16:19], v3 offset:36864
    v_mfma_f32_16x16x32_bf16 v[228:231], v[20:23], a[4:7], 0
    s_mul_i32 s50, s20, 2048
    ds_read_b128 v[36:39], v244 offset:768
    v_mfma_f32_16x16x32_bf16 v[232:235], v[24:27], a[0:3], 0
    ds_read_b128 v[20:23], v3 offset:37888
    buffer_load_dwordx4 v3, s[28:31], s27 offen offset:3072 lds
    v_mfma_f32_16x16x32_bf16 v[236:239], v[24:27], a[4:7], 0
    s_add_u32 s50, s50, 20480
    s_waitcnt lgkmcnt(5)
    v_mfma_f32_16x16x32_bf16 v[208:211], v[28:31], a[8:11], v[208:211]
    ds_read_b128 v[24:27], v3 offset:38912
    s_add_u32 s51, s50, s61
    v_mfma_f32_16x16x32_bf16 v[212:215], v[28:31], a[12:15], v[212:215]
    s_add_u32 s50, s50, s60
    v_mfma_f32_16x16x32_bf16 v[216:219], v[32:35], a[8:11], v[216:219]
    ds_read_b128 v[28:31], v3 offset:39936
    s_add_u32 m0, s26, 0
    v_mfma_f32_16x16x32_bf16 v[220:223], v[32:35], a[12:15], v[220:223]
    s_add_u32 s27, s42, 32768
    s_waitcnt lgkmcnt(5)
    v_mfma_f32_16x16x32_bf16 v[224:227], v[8:11], a[8:11], v[224:227]
    ds_read_b128 v[32:35], v3 offset:40960
    buffer_load_dwordx4 v3, s[28:31], s27 offen offset:0 lds
    v_mfma_f32_16x16x32_bf16 v[228:231], v[8:11], a[12:15], v[228:231]
    v_fma_f32 v68, v52, v242, v60
    v_fma_f32 v69, v53, v242, v61
    v_mfma_f32_16x16x32_bf16 v[232:235], v[12:15], a[8:11], v[232:235]
    ds_read_b128 v[8:11], v3 offset:41984
    ds_read_b128 v[40:43], v244 offset:784
    v_mfma_f32_16x16x32_bf16 v[236:239], v[12:15], a[12:15], v[236:239]
    v_fma_f32 v70, v54, v242, v62
    s_waitcnt lgkmcnt(5)
    v_mfma_f32_16x16x32_bf16 v[208:211], v[16:19], a[16:19], v[208:211]
    ds_read_b128 v[12:15], v3 offset:43008
    buffer_load_dwordx4 v3, s[28:31], s27 offen offset:1024 lds
    v_mfma_f32_16x16x32_bf16 v[212:215], v[16:19], a[20:23], v[212:215]
    v_fma_f32 v71, v55, v242, v63
    v_fma_f32 v72, v56, v242, v64
    v_mfma_f32_16x16x32_bf16 v[216:219], v[20:23], a[16:19], v[216:219]
    ds_read_b128 v[16:19], v3 offset:44032
    v_fma_f32 v73, v57, v242, v65
    v_mfma_f32_16x16x32_bf16 v[220:223], v[20:23], a[20:23], v[220:223]
    v_fma_f32 v74, v58, v242, v66
    s_waitcnt lgkmcnt(5)
    v_mfma_f32_16x16x32_bf16 v[224:227], v[24:27], a[16:19], v[224:227]
    ds_read_b128 v[20:23], v3 offset:45056
    ds_read_b128 v[44:47], v244 offset:1920
    v_mfma_f32_16x16x32_bf16 v[228:231], v[24:27], a[20:23], v[228:231]
    v_fma_f32 v75, v59, v242, v67
    buffer_load_dwordx4 v3, s[28:31], s27 offen offset:2048 lds
    v_mfma_f32_16x16x32_bf16 v[232:235], v[28:31], a[16:19], v[232:235]
    ds_read_b128 v[24:27], v3 offset:46080
    v_fmac_f32 v68, v176, v240
    v_mfma_f32_16x16x32_bf16 v[236:239], v[28:31], a[20:23], v[236:239]
    v_fmac_f32 v69, v177, v240
    s_waitcnt vmcnt(8)
    v_cmp_ne_u32 vcc, 0, v84
    s_nop 0
    s_cmp_eq_u64 vcc, -1
    s_cbranch_scc0 k8_kernel_slow8
k8_kernel_back9:
    s_waitcnt lgkmcnt(6)
    v_mfma_f32_16x16x32_bf16 v[208:211], v[32:35], a[24:27], v[208:211]
    ds_read_b128 v[28:31], v3 offset:47104
    v_fmac_f32 v70, v178, v240
    v_mfma_f32_16x16x32_bf16 v[212:215], v[32:35], a[28:31], v[212:215]
    v_fmac_f32 v71, v179, v240
    buffer_load_dwordx4 v3, s[28:31], s27 offen offset:3072 lds
    v_mfma_f32_16x16x32_bf16 v[216:219], v[8:11], a[24:27], v[216:219]
    ds_read_b128 v[32:35], v3 offset:48128
    ds_read_b128 v[48:51], v244 offset:1936
    v_mfma_f32_16x16x32_bf16 v[220:223], v[8:11], a[28:31], v[220:223]
    v_fmac_f32 v72, v184, v240
    s_waitcnt lgkmcnt(6)
    v_mfma_f32_16x16x32_bf16 v[224:227], v[12:15], a[24:27], v[224:227]
    ds_read_b128 v[8:11], v3 offset:49152
    v_fmac_f32 v73, v185, v240
    v_mfma_f32_16x16x32_bf16 v[228:231], v[12:15], a[28:31], v[228:231]
    v_fmac_f32 v74, v186, v240
    buffer_load_dwordx4 a[144:147], v3, s[28:31], s52 offen offset:0 sc1
    v_mfma_f32_16x16x32_bf16 v[232:235], v[16:19], a[24:27], v[232:235]
    ds_read_b128 v[12:15], v3 offset:50176
    buffer_load_dwordx4 a[148:151], v3, s[28:31], s53 offen offset:0 sc1
    v_mfma_f32_16x16x32_bf16 v[236:239], v[16:19], a[28:31], v[236:239]
    v_fmac_f32 v75, v187, v240
    s_waitcnt lgkmcnt(5)
    v_mfma_f32_16x16x32_bf16 v[208:211], v[20:23], a[32:35], v[208:211]
    ds_read_b128 v[16:19], v3 offset:51200
    v_cvt_pk_bf16_f32 v176, v68, v69
    v_mfma_f32_16x16x32_bf16 v[212:215], v[20:23], a[36:39], v[212:215]
    v_cvt_pk_bf16_f32 v177, v70, v71
    buffer_load_dwordx4 a[152:155], v3, s[28:31], s52 offen offset:1024 sc1
    v_mfma_f32_16x16x32_bf16 v[216:219], v[24:27], a[32:35], v[216:219]
    ds_read_b128 v[20:23], v3 offset:52224
    v_cvt_pk_bf16_f32 v178, v72, v73
    v_mfma_f32_16x16x32_bf16 v[220:223], v[24:27], a[36:39], v[220:223]
    v_cvt_pk_bf16_f32 v179, v74, v75
    s_waitcnt lgkmcnt(5)
    v_mfma_f32_16x16x32_bf16 v[224:227], v[28:31], a[32:35], v[224:227]
    ds_read_b128 v[24:27], v3 offset:53248
    v_pk_max_i16 v176, v176, 0
    v_mfma_f32_16x16x32_bf16 v[228:231], v[28:31], a[36:39], v[228:231]
    v_pk_max_i16 v177, v177, 0
    buffer_load_dwordx4 a[156:159], v3, s[28:31], s53 offen offset:1024 sc1
    v_mfma_f32_16x16x32_bf16 v[232:235], v[32:35], a[32:35], v[232:235]
    ds_read_b128 v[28:31], v3 offset:54272
    v_pk_max_i16 v178, v178, 0
    v_mfma_f32_16x16x32_bf16 v[236:239], v[32:35], a[36:39], v[236:239]
    v_pk_max_i16 v179, v179, 0
    s_waitcnt lgkmcnt(4)
    v_mfma_f32_16x16x32_bf16 v[208:211], v[8:11], a[40:43], v[208:211]
    ds_read_b128 v[32:35], v3 offset:55296
    buffer_store_dwordx4 v[176:179], v3, s[28:31], s50 offen offset:0 sc1
    v_mfma_f32_16x16x32_bf16 v[212:215], v[8:11], a[44:47], v[212:215]
    v_fma_f32 v76, v52, v243, v60
    v_fma_f32 v77, v53, v243, v61
    v_mfma_f32_16x16x32_bf16 v[216:219], v[12:15], a[40:43], v[216:219]
    ds_read_b128 v[8:11], v3 offset:56320
    v_fma_f32 v78, v54, v243, v62
    v_mfma_f32_16x16x32_bf16 v[220:223], v[12:15], a[44:47], v[220:223]
    buffer_load_dwordx4 a[160:163], v3, s[28:31], s52 offen offset:2048 sc1
    s_waitcnt lgkmcnt(4)
    v_mfma_f32_16x16x32_bf16 v[224:227], v[16:19], a[40:43], v[224:227]
    ds_read_b128 v[12:15], v3 offset:57344
    v_fma_f32 v79, v55, v243, v63
    v_mfma_f32_16x16x32_bf16 v[228:231], v[16:19], a[44:47], v[228:231]
    v_fma_f32 v80, v56, v243, v64
    v_fma_f32 v81, v57, v243, v65
    v_mfma_f32_16x16x32_bf16 v[232:235], v[20:23], a[40:43], v[232:235]
    ds_read_b128 v[16:19], v3 offset:58368
    v_fma_f32 v82, v58, v243, v66
    v_mfma_f32_16x16x32_bf16 v[236:239], v[20:23], a[44:47], v[236:239]
    buffer_load_dwordx4 a[164:167], v3, s[28:31], s53 offen offset:2048 sc1
    s_waitcnt lgkmcnt(4)
    v_mfma_f32_16x16x32_bf16 v[208:211], v[24:27], a[48:51], v[208:211]
    ds_read_b128 v[20:23], v3 offset:59392
    v_fma_f32 v83, v59, v243, v67
    v_mfma_f32_16x16x32_bf16 v[212:215], v[24:27], a[52:55], v[212:215]
    v_fmac_f32 v76, v180, v241
    v_fmac_f32 v77, v181, v241
    v_mfma_f32_16x16x32_bf16 v[216:219], v[28:31], a[48:51], v[216:219]
    ds_read_b128 v[24:27], v3 offset:60416
    v_fmac_f32 v78, v182, v241
    v_mfma_f32_16x16x32_bf16 v[220:223], v[28:31], a[52:55], v[220:223]
    buffer_load_dwordx4 a[168:171], v3, s[28:31], s52 offen offset:3072 sc1
    s_waitcnt lgkmcnt(4)
    v_mfma_f32_16x16x32_bf16 v[224:227], v[32:35], a[48:51], v[224:227]
    ds_read_b128 v[28:31], v3 offset:61440
    v_fmac_f32 v79, v183, v241
    v_mfma_f32_16x16x32_bf16 v[228:231], v[32:35], a[52:55], v[228:231]
    v_fmac_f32 v80, v188, v241
    v_fmac_f32 v81, v189, v241
    v_mfma_f32_16x16x32_bf16 v[232:235], v[8:11], a[48:51], v[232:235]
    ds_read_b128 v[32:35], v3 offset:62464
    buffer_load_dwordx4 a[172:175], v3, s[28:31], s53 offen offset:3072 sc1
    v_mfma_f32_16x16x32_bf16 v[236:239], v[8:11], a[52:55], v[236:239]
    v_fmac_f32 v82, v190, v241
    s_waitcnt lgkmcnt(4)
    v_mfma_f32_16x16x32_bf16 v[208:211], v[12:15], a[56:59], v[208:211]
    ds_read_b128 v[8:11], v3 offset:63488
    v_fmac_f32 v83, v191, v241
    v_mfma_f32_16x16x32_bf16 v[212:215], v[12:15], a[60:63], v[212:215]
    v_cvt_pk_bf16_f32 v180, v76, v77
    v_cvt_pk_bf16_f32 v181, v78, v79
    v_mfma_f32_16x16x32_bf16 v[216:219], v[16:19], a[56:59], v[216:219]
    ds_read_b128 v[12:15], v3 offset:64512
    s_add_u32 s52, s52, 4096
    v_mfma_f32_16x16x32_bf16 v[220:223], v[16:19], a[60:63], v[220:223]
    buffer_load_dwordx4 a[176:179], v3, s[28:31], s52 offen offset:0 sc1
    v_cvt_pk_bf16_f32 v182, v80, v81
    v_cvt_pk_bf16_f32 v183, v82, v83
    s_waitcnt vmcnt(18)
    s_barrier
    s_cmp_lg_u32 s18, 0
    s_cbranch_scc1 k8_kernel_sig10
    s_mov_b64 exec, 0xff
    buffer_store_dwordx4 v[244:247], v94, s[28:31], s44 offen offset:512 sc1
    s_mov_b64 exec, -1
k8_kernel_sig10:
    s_waitcnt lgkmcnt(4)
    v_mfma_f32_16x16x32_bf16 v[224:227], v[20:23], a[56:59], v[224:227]
    ds_read_b128 v[16:19], v6 offset:0
    v_pk_max_i16 v180, v180, 0
    v_mfma_f32_16x16x32_bf16 v[228:231], v[20:23], a[60:63], v[228:231]
    v_pk_max_i16 v181, v181, 0
    v_mfma_f32_16x16x32_bf16 v[232:235], v[24:27], a[56:59], v[232:235]
    ds_read_b128 v[20:23], v6 offset:1024
    v_pk_max_i16 v182, v182, 0
    v_mfma_f32_16x16x32_bf16 v[236:239], v[24:27], a[60:63], v[236:239]
    v_pk_max_i16 v183, v183, 0
    s_waitcnt lgkmcnt(4)
    v_mfma_f32_16x16x32_bf16 v[208:211], v[28:31], a[64:67], v[208:211]
    ds_read_b128 v[24:27], v6 offset:2048
    s_add_u32 s53, s53, 4096
    v_mfma_f32_16x16x32_bf16 v[212:215], v[28:31], a[68:71], v[212:215]
    buffer_load_dwordx4 a[180:183], v3, s[28:31], s53 offen offset:0 sc1
    buffer_store_dwordx4 v[180:183], v3, s[28:31], s51 offen offset:0 sc1
    v_mfma_f32_16x16x32_bf16 v[216:219], v[32:35], a[64:67], v[216:219]
    ds_read_b128 v[28:31], v6 offset:3072
    v_mfma_f32_16x16x32_bf16 v[220:223], v[32:35], a[68:71], v[220:223]
    v_fma_f32 v68, v36, v242, v44
    s_waitcnt lgkmcnt(4)
    v_mfma_f32_16x16x32_bf16 v[224:227], v[8:11], a[64:67], v[224:227]
    ds_read_b128 v[32:35], v6 offset:4096
    ds_read_b128 v[52:55], v244 offset:896
    v_mfma_f32_16x16x32_bf16 v[228:231], v[8:11], a[68:71], v[228:231]
    buffer_load_dwordx4 a[184:187], v3, s[28:31], s52 offen offset:1024 sc1
    v_fma_f32 v69, v37, v242, v45
    v_mfma_f32_16x16x32_bf16 v[232:235], v[12:15], a[64:67], v[232:235]
    ds_read_b128 v[8:11], v6 offset:5120
    v_fma_f32 v70, v38, v242, v46
    v_mfma_f32_16x16x32_bf16 v[236:239], v[12:15], a[68:71], v[236:239]
    v_fma_f32 v71, v39, v242, v47
    s_waitcnt lgkmcnt(5)
    v_mfma_f32_16x16x32_bf16 v[208:211], v[16:19], a[72:75], v[208:211]
    ds_read_b128 v[12:15], v6 offset:6144
    v_fma_f32 v72, v40, v242, v48
    v_mfma_f32_16x16x32_bf16 v[212:215], v[16:19], a[76:79], v[212:215]
    buffer_load_dwordx4 a[188:191], v3, s[28:31], s53 offen offset:1024 sc1
    v_fma_f32 v73, v41, v242, v49
    v_mfma_f32_16x16x32_bf16 v[216:219], v[20:23], a[72:75], v[216:219]
    ds_read_b128 v[16:19], v6 offset:7168
    ds_read_b128 v[56:59], v244 offset:912
    v_mfma_f32_16x16x32_bf16 v[220:223], v[20:23], a[76:79], v[220:223]
    v_fma_f32 v74, v42, v242, v50
    s_waitcnt lgkmcnt(6)
    v_mfma_f32_16x16x32_bf16 v[224:227], v[24:27], a[72:75], v[224:227]
    ds_read_b128 v[20:23], v6 offset:8192
    buffer_load_dwordx4 a[192:195], v3, s[28:31], s52 offen offset:2048 sc1
    v_mfma_f32_16x16x32_bf16 v[228:231], v[24:27], a[76:79], v[228:231]
    v_fma_f32 v75, v43, v242, v51
    v_fmac_f32 v68, v192, v240
    v_mfma_f32_16x16x32_bf16 v[232:235], v[28:31], a[72:75], v[232:235]
    ds_read_b128 v[24:27], v6 offset:9216
    v_fmac_f32 v69, v193, v240
    v_mfma_f32_16x16x32_bf16 v[236:239], v[28:31], a[76:79], v[236:239]
    v_fmac_f32 v70, v194, v240
    s_waitcnt lgkmcnt(5)
    v_mfma_f32_16x16x32_bf16 v[208:211], v[32:35], a[80:83], v[208:211]
    ds_read_b128 v[28:31], v6 offset:10240
    buffer_load_dwordx4 a[196:199], v3, s[28:31], s53 offen offset:2048 sc1
    v_mfma_f32_16x16x32_bf16 v[212:215], v[32:35], a[84:87], v[212:215]
    ds_read_b128 v[60:63], v244 offset:2048
    v_fmac_f32 v71, v195, v240
    v_mfma_f32_16x16x32_bf16 v[216:219], v[8:11], a[80:83], v[216:219]
    ds_read_b128 v[32:35], v6 offset:11264
    v_fmac_f32 v72, v200, v240
    v_mfma_f32_16x16x32_bf16 v[220:223], v[8:11], a[84:87], v[220:223]
    v_fmac_f32 v73, v201, v240
    s_waitcnt lgkmcnt(6)
    v_mfma_f32_16x16x32_bf16 v[224:227], v[12:15], a[80:83], v[224:227]
    ds_read_b128 v[8:11], v6 offset:12288
    v_fmac_f32 v74, v202, v240
    v_mfma_f32_16x16x32_bf16 v[228:231], v[12:15], a[84:87], v[228:231]
    v_fmac_f32 v75, v203, v240
    v_mfma_f32_16x16x32_bf16 v[232:235], v[16:19], a[80:83], v[232:235]
    ds_read_b128 v[12:15], v6 offset:13312
    buffer_load_dwordx4 a[200:203], v3, s[28:31], s52 offen offset:3072 sc1
    v_mfma_f32_16x16x32_bf16 v[236:239], v[16:19], a[84:87], v[236:239]
    ds_read_b128 v[64:67], v244 offset:2064
    s_waitcnt lgkmcnt(6)
    v_mfma_f32_16x16x32_bf16 v[208:211], v[20:23], a[88:91], v[208:211]
    ds_read_b128 v[16:19], v6 offset:14336
    v_cvt_pk_bf16_f32 v192, v68, v69
    v_mfma_f32_16x16x32_bf16 v[212:215], v[20:23], a[92:95], v[212:215]
    v_cvt_pk_bf16_f32 v193, v70, v71
    v_cvt_pk_bf16_f32 v194, v72, v73
    v_mfma_f32_16x16x32_bf16 v[216:219], v[24:27], a[88:91], v[216:219]
    ds_read_b128 v[20:23], v6 offset:15360
    buffer_load_dwordx4 a[204:207], v3, s[28:31], s53 offen offset:3072 sc1
    v_mfma_f32_16x16x32_bf16 v[220:223], v[24:27], a[92:95], v[220:223]
    v_cvt_pk_bf16_f32 v195, v74, v75
    s_waitcnt lgkmcnt(5)
    v_mfma_f32_16x16x32_bf16 v[224:227], v[28:31], a[88:91], v[224:227]
    ds_read_b128 v[24:27], v6 offset:16384
    v_pk_max_i16 v192, v192, 0
    v_mfma_f32_16x16x32_bf16 v[228:231], v[28:31], a[92:95], v[228:231]
    v_pk_max_i16 v193, v193, 0
    v_pk_max_i16 v194, v194, 0
    v_mfma_f32_16x16x32_bf16 v[232:235], v[32:35], a[88:91], v[232:235]
    ds_read_b128 v[28:31], v6 offset:17408
    s_add_u32 s52, s52, 4096
    v_mfma_f32_16x16x32_bf16 v[236:239], v[32:35], a[92:95], v[236:239]
    buffer_load_dwordx4 a[208:211], v3, s[28:31], s52 offen offset:0 sc1
    s_waitcnt lgkmcnt(5)
    v_mfma_f32_16x16x32_bf16 v[208:211], v[8:11], a[96:99], v[208:211]
    ds_read_b128 v[32:35], v6 offset:18432
    v_pk_max_i16 v195, v195, 0
    v_mfma_f32_16x16x32_bf16 v[212:215], v[8:11], a[100:103], v[212:215]
    buffer_store_dwordx4 v[192:195], v3, s[28:31], s50 offen offset:1024 sc1
    v_fma_f32 v76, v36, v243, v44
    v_mfma_f32_16x16x32_bf16 v[216:219], v[12:15], a[96:99], v[216:219]
    ds_read_b128 v[8:11], v6 offset:19456
    s_add_u32 s53, s53, 4096
    v_mfma_f32_16x16x32_bf16 v[220:223], v[12:15], a[100:103], v[220:223]
    buffer_load_dwordx4 a[212:215], v3, s[28:31], s53 offen offset:0 sc1
    s_waitcnt lgkmcnt(4)
    v_mfma_f32_16x16x32_bf16 v[224:227], v[16:19], a[96:99], v[224:227]
    ds_read_b128 v[12:15], v6 offset:20480
    v_fma_f32 v77, v37, v243, v45
    v_mfma_f32_16x16x32_bf16 v[228:231], v[16:19], a[100:103], v[228:231]
    v_fma_f32 v78, v38, v243, v46
    v_fma_f32 v79, v39, v243, v47
    v_mfma_f32_16x16x32_bf16 v[232:235], v[20:23], a[96:99], v[232:235]
    ds_read_b128 v[16:19], v6 offset:21504
    v_fma_f32 v80, v40, v243, v48
    v_mfma_f32_16x16x32_bf16 v[236:239], v[20:23], a[100:103], v[236:239]
    buffer_load_dwordx4 a[216:219], v3, s[28:31], s52 offen offset:1024 sc1
    s_waitcnt lgkmcnt(4)
    v_mfma_f32_16x16x32_bf16 v[208:211], v[24:27], a[104:107], v[208:211]
    ds_read_b128 v[20:23], v6 offset:22528
    v_fma_f32 v81, v41, v243, v49
    v_mfma_f32_16x16x32_bf16 v[212:215], v[24:27], a[108:111], v[212:215]
    v_fma_f32 v82, v42, v243, v50
    v_fma_f32 v83, v43, v243, v51
    v_mfma_f32_16x16x32_bf16 v[216:219], v[28:31], a[104:107], v[216:219]
    ds_read_b128 v[24:27], v6 offset:23552
    v_fmac_f32 v76, v196, v241
    v_mfma_f32_16x16x32_bf16 v[220:223], v[28:31], a[108:111], v[220:223]
    v_fmac_f32 v77, v197, v241
    s_waitcnt lgkmcnt(4)
    v_mfma_f32_16x16x32_bf16 v[224:227], v[32:35], a[104:107], v[224:227]
    ds_read_b128 v[28:31], v6 offset:24576
    v_fmac_f32 v78, v198, v241
    v_mfma_f32_16x16x32_bf16 v[228:231], v[32:35], a[108:111], v[228:231]
    buffer_load_dwordx4 a[220:223], v3, s[28:31], s53 offen offset:1024 sc1
    v_fmac_f32 v79, v199, v241
    v_mfma_f32_16x16x32_bf16 v[232:235], v[8:11], a[104:107], v[232:235]
    ds_read_b128 v[32:35], v6 offset:25600
    v_fmac_f32 v80, v204, v241
    v_mfma_f32_16x16x32_bf16 v[236:239], v[8:11], a[108:111], v[236:239]
    v_fmac_f32 v81, v205, v241
    s_waitcnt lgkmcnt(4)
    v_mfma_f32_16x16x32_bf16 v[208:211], v[12:15], a[112:115], v[208:211]
    ds_read_b128 v[8:11], v6 offset:26624
    v_fmac_f32 v82, v206, v241
    v_mfma_f32_16x16x32_bf16 v[212:215], v[12:15], a[116:119], v[212:215]
    buffer_load_dwordx4 a[224:227], v3, s[28:31], s52 offen offset:2048 sc1
    v_fmac_f32 v83, v207, v241
    v_mfma_f32_16x16x32_bf16 v[216:219], v[16:19], a[112:115], v[216:219]
    ds_read_b128 v[12:15], v6 offset:27648
    v_cvt_pk_bf16_f32 v196, v76, v77
    v_mfma_f32_16x16x32_bf16 v[220:223], v[16:19], a[116:119], v[220:223]
    v_cvt_pk_bf16_f32 v197, v78, v79
    s_waitcnt lgkmcnt(4)
    v_mfma_f32_16x16x32_bf16 v[224:227], v[20:23], a[112:115], v[224:227]
    ds_read_b128 v[16:19], v6 offset:28672
    v_cvt_pk_bf16_f32 v198, v80, v81
    v_mfma_f32_16x16x32_bf16 v[228:231], v[20:23], a[116:119], v[228:231]
    buffer_load_dwordx4 a[228:231], v3, s[28:31], s53 offen offset:2048 sc1
    v_cvt_pk_bf16_f32 v199, v82, v83
    v_mfma_f32_16x16x32_bf16 v[232:235], v[24:27], a[112:115], v[232:235]
    ds_read_b128 v[20:23], v6 offset:29696
    v_pk_max_i16 v196, v196, 0
    v_mfma_f32_16x16x32_bf16 v[236:239], v[24:27], a[116:119], v[236:239]
    v_pk_max_i16 v197, v197, 0
    s_waitcnt lgkmcnt(4)
    v_mfma_f32_16x16x32_bf16 v[208:211], v[28:31], a[120:123], v[208:211]
    ds_read_b128 v[24:27], v6 offset:30720
    buffer_load_dwordx4 a[232:235], v3, s[28:31], s52 offen offset:3072 sc1
    v_mfma_f32_16x16x32_bf16 v[212:215], v[28:31], a[124:127], v[212:215]
    v_pk_max_i16 v198, v198, 0
    v_pk_max_i16 v199, v199, 0
    v_mfma_f32_16x16x32_bf16 v[216:219], v[32:35], a[120:123], v[216:219]
    ds_read_b128 v[28:31], v6 offset:31744
    buffer_store_dwordx4 v[196:199], v3, s[28:31], s51 offen offset:1024 sc1
    v_mfma_f32_16x16x32_bf16 v[220:223], v[32:35], a[124:127], v[220:223]
    s_barrier
    s_waitcnt lgkmcnt(4)
    v_mfma_f32_16x16x32_bf16 v[224:227], v[8:11], a[120:123], v[224:227]
    ds_read_b128 v[32:35], v6 offset:32768
    buffer_load_dwordx4 a[236:239], v3, s[28:31], s53 offen offset:3072 sc1
    v_mfma_f32_16x16x32_bf16 v[228:231], v[8:11], a[124:127], v[228:231]
    v_mfma_f32_16x16x32_bf16 v[232:235], v[12:15], a[120:123], v[232:235]
    ds_read_b128 v[8:11], v6 offset:33792
    v_mfma_f32_16x16x32_bf16 v[236:239], v[12:15], a[124:127], v[236:239]
    s_waitcnt lgkmcnt(4)
    v_mfma_f32_16x16x32_bf16 v[208:211], v[16:19], a[128:131], v[208:211]
    ds_read_b128 v[12:15], v6 offset:34816
    v_mfma_f32_16x16x32_bf16 v[212:215], v[16:19], a[132:135], v[212:215]
    v_mfma_f32_16x16x32_bf16 v[216:219], v[20:23], a[128:131], v[216:219]
    ds_read_b128 v[16:19], v6 offset:35840
    s_add_u32 m0, s26, 16384
    v_mfma_f32_16x16x32_bf16 v[220:223], v[20:23], a[132:135], v[220:223]
    s_add_u32 s27, s42, 49152
    s_waitcnt lgkmcnt(4)
    v_mfma_f32_16x16x32_bf16 v[224:227], v[24:27], a[128:131], v[224:227]
    buffer_load_dwordx4 v3, s[28:31], s27 offen offset:0 lds
    v_mfma_f32_16x16x32_bf16 v[228:231], v[24:27], a[132:135], v[228:231]
    v_mfma_f32_16x16x32_bf16 v[232:235], v[28:31], a[128:131], v[232:235]
    buffer_load_dwordx4 v3, s[28:31], s27 offen offset:1024 lds
    v_mfma_f32_16x16x32_bf16 v[236:239], v[28:31], a[132:135], v[236:239]
    s_waitcnt lgkmcnt(2)
    v_mfma_f32_16x16x32_bf16 v[208:211], v[32:35], a[136:139], v[208:211]
    v_mfma_f32_16x16x32_bf16 v[212:215], v[32:35], a[140:143], v[212:215]
    v_mfma_f32_16x16x32_bf16 v[216:219], v[8:11], a[136:139], v[216:219]
    buffer_load_dwordx4 v3, s[28:31], s27 offen offset:2048 lds
    v_mfma_f32_16x16x32_bf16 v[220:223], v[8:11], a[140:143], v[220:223]
    s_waitcnt lgkmcnt(0)
    v_mfma_f32_16x16x32_bf16 v[224:227], v[12:15], a[136:139], v[224:227]
    v_mfma_f32_16x16x32_bf16 v[228:231], v[12:15], a[140:143], v[228:231]
    v_mfma_f32_16x16x32_bf16 v[232:235], v[16:19], a[136:139], v[232:235]
    buffer_load_dwordx4 v3, s[28:31], s27 offen offset:3072 lds
    v_mfma_f32_16x16x32_bf16 v[236:239], v[16:19], a[140:143], v[236:239]
    s_barrier
    ds_read_b128 v[12:15], v6 offset:49152
    ds_read_b128 v[16:19], v6 offset:50176
    ds_read_b128 v[20:23], v6 offset:51200
    ds_read_b128 v[24:27], v6 offset:52224
    ds_read_b128 v[28:31], v6 offset:53248
    ds_read_b128 v[32:35], v6 offset:54272
    s_waitcnt vmcnt(30) lgkmcnt(4)
    v_mfma_f32_16x16x32_bf16 v[96:99], v[12:15], a[144:147], 0
    ds_read_b128 v[8:11], v6 offset:55296
    s_add_u32 m0, s26, 32768
    v_mfma_f32_16x16x32_bf16 v[100:103], v[12:15], a[148:151], 0
    s_add_u32 s27, s42, 65536
    buffer_load_dwordx4 v3, s[28:31], s27 offen offset:0 lds
    v_mfma_f32_16x16x32_bf16 v[104:107], v[16:19], a[144:147], 0
    ds_read_b128 v[12:15], v6 offset:56320
    buffer_load_dwordx4 v3, s[28:31], s27 offen offset:1024 lds
    v_mfma_f32_16x16x32_bf16 v[108:111], v[16:19], a[148:151], 0
    s_waitcnt lgkmcnt(4)
    v_mfma_f32_16x16x32_bf16 v[112:115], v[20:23], a[144:147], 0
    ds_read_b128 v[16:19], v6 offset:57344
    v_mfma_f32_16x16x32_bf16 v[116:119], v[20:23], a[148:151], 0
    s_mul_i32 s50, s20, 2048
    v_mfma_f32_16x16x32_bf16 v[120:123], v[24:27], a[144:147], 0
    ds_read_b128 v[20:23], v6 offset:58368
    buffer_load_dwordx4 v3, s[28:31], s27 offen offset:2048 lds
    v_mfma_f32_16x16x32_bf16 v[124:127], v[24:27], a[148:151], 0
    ds_read_b128 v[36:39], v244 offset:1024
    s_waitcnt lgkmcnt(5)
    v_mfma_f32_16x16x32_bf16 v[128:131], v[28:31], a[144:147], 0
    ds_read_b128 v[24:27], v6 offset:59392
    s_add_u32 s50, s50, 28672
    v_mfma_f32_16x16x32_bf16 v[132:135], v[28:31], a[148:151], 0
    s_add_u32 s51, s50, s61
    s_add_u32 s50, s50, s60
    v_mfma_f32_16x16x32_bf16 v[136:139], v[32:35], a[144:147], 0
    ds_read_b128 v[28:31], v6 offset:60416
    buffer_load_dwordx4 v3, s[28:31], s27 offen offset:3072 lds
    v_mfma_f32_16x16x32_bf16 v[140:143], v[32:35], a[148:151], 0
    v_fma_f32 v68, v52, v242, v60
    s_waitcnt lgkmcnt(5)
    v_mfma_f32_16x16x32_bf16 v[144:147], v[8:11], a[144:147], 0
    ds_read_b128 v[32:35], v6 offset:61440
    v_fma_f32 v69, v53, v242, v61
    v_mfma_f32_16x16x32_bf16 v[148:151], v[8:11], a[148:151], 0
    ds_read_b128 v[40:43], v244 offset:1040
    v_fma_f32 v70, v54, v242, v62
    v_mfma_f32_16x16x32_bf16 v[152:155], v[12:15], a[144:147], 0
    ds_read_b128 v[8:11], v6 offset:62464
    s_add_u32 m0, s26, 49152
    v_mfma_f32_16x16x32_bf16 v[156:159], v[12:15], a[148:151], 0
    s_add_u32 s27, s42, 81920
    s_waitcnt lgkmcnt(6)
    v_mfma_f32_16x16x32_bf16 v[160:163], v[16:19], a[144:147], 0
    ds_read_b128 v[12:15], v6 offset:63488
    buffer_load_dwordx4 v3, s[28:31], s27 offen offset:0 lds
    v_mfma_f32_16x16x32_bf16 v[164:167], v[16:19], a[148:151], 0
    v_fma_f32 v71, v55, v242, v63
    v_fma_f32 v72, v56, v242, v64
    v_fma_f32 v73, v57, v242, v65
    v_fma_f32 v74, v58, v242, v66
    s_waitcnt vmcnt(33)
    v_mfma_f32_16x16x32_bf16 v[96:99], v[20:23], a[152:155], v[96:99]
    ds_read_b128 v[16:19], v6 offset:64512
    buffer_load_dwordx4 v3, s[28:31], s27 offen offset:1024 lds
    v_mfma_f32_16x16x32_bf16 v[100:103], v[20:23], a[156:159], v[100:103]
    ds_read_b128 v[44:47], v244 offset:2176
    v_fma_f32 v75, v59, v242, v67
    s_waitcnt vmcnt(11)
    s_barrier
    s_cmp_lg_u32 s18, 0
    s_cbranch_scc1 k8_kernel_sig11
    s_mov_b64 exec, 0xff
    buffer_store_dwordx4 v[244:247], v94, s[28:31], s44 offen offset:1024 sc1
    s_mov_b64 exec, -1
k8_kernel_sig11:
    s_waitcnt lgkmcnt(6)
    v_mfma_f32_16x16x32_bf16 v[104:107], v[24:27], a[152:155], v[104:107]
    ds_read_b128 v[20:23], v7 offset:0
    v_fmac_f32 v68, v208, v240
    v_mfma_f32_16x16x32_bf16 v[108:111], v[24:27], a[156:159], v[108:111]
    v_fmac_f32 v69, v209, v240
    v_mfma_f32_16x16x32_bf16 v[112:115], v[28:31], a[152:155], v[112:115]
    ds_read_b128 v[24:27], v7 offset:1024
    buffer_load_dwordx4 v3, s[28:31], s27 offen offset:2048 lds
    v_mfma_f32_16x16x32_bf16 v[116:119], v[28:31], a[156:159], v[116:119]
    v_fmac_f32 v70, v210, v240
    s_waitcnt lgkmcnt(5)
    v_mfma_f32_16x16x32_bf16 v[120:123], v[32:35], a[152:155], v[120:123]
    ds_read_b128 v[28:31], v7 offset:2048
    v_fmac_f32 v71, v211, v240
    v_mfma_f32_16x16x32_bf16 v[124:127], v[32:35], a[156:159], v[124:127]
    ds_read_b128 v[48:51], v244 offset:2192
    v_fmac_f32 v72, v216, v240
    v_mfma_f32_16x16x32_bf16 v[128:131], v[8:11], a[152:155], v[128:131]
    ds_read_b128 v[32:35], v7 offset:3072
    buffer_load_dwordx4 v3, s[28:31], s27 offen offset:3072 lds
    v_mfma_f32_16x16x32_bf16 v[132:135], v[8:11], a[156:159], v[132:135]
    v_fmac_f32 v73, v217, v240
    s_waitcnt lgkmcnt(6)
    v_mfma_f32_16x16x32_bf16 v[136:139], v[12:15], a[152:155], v[136:139]
    ds_read_b128 v[8:11], v7 offset:4096
    v_fmac_f32 v74, v218, v240
    v_mfma_f32_16x16x32_bf16 v[140:143], v[12:15], a[156:159], v[140:143]
    v_fmac_f32 v75, v219, v240
    v_cvt_pk_bf16_f32 v208, v68, v69
    v_mfma_f32_16x16x32_bf16 v[144:147], v[16:19], a[152:155], v[144:147]
    ds_read_b128 v[12:15], v7 offset:5120
    s_add_u32 m0, s26, 65536
    v_mfma_f32_16x16x32_bf16 v[148:151], v[16:19], a[156:159], v[148:151]
    s_add_u32 s27, s42, 98304
    s_waitcnt lgkmcnt(5)
    v_mfma_f32_16x16x32_bf16 v[152:155], v[20:23], a[152:155], v[152:155]
    ds_read_b128 v[16:19], v7 offset:6144
    buffer_load_dwordx4 v3, s[28:31], s27 offen offset:0 lds
    v_mfma_f32_16x16x32_bf16 v[156:159], v[20:23], a[156:159], v[156:159]
    v_cvt_pk_bf16_f32 v209, v70, v71
    v_cvt_pk_bf16_f32 v210, v72, v73
    v_mfma_f32_16x16x32_bf16 v[160:163], v[24:27], a[152:155], v[160:163]
    ds_read_b128 v[20:23], v7 offset:7168
    buffer_load_dword v85, v247, s[28:31], s44 offen offset:512 sc1
    v_mfma_f32_16x16x32_bf16 v[164:167], v[24:27], a[156:159], v[164:167]
    v_cvt_pk_bf16_f32 v211, v74, v75
    v_pk_max_i16 v208, v208, 0
    buffer_load_dwordx4 v3, s[28:31], s27 offen offset:1024 lds
    v_pk_max_i16 v209, v209, 0
    v_pk_max_i16 v210, v210, 0
    s_waitcnt lgkmcnt(4)
    v_mfma_f32_16x16x32_bf16 v[96:99], v[28:31], a[160:163], v[96:99]
    ds_read_b128 v[24:27], v7 offset:8192
    v_pk_max_i16 v211, v211, 0
    v_mfma_f32_16x16x32_bf16 v[100:103], v[28:31], a[164:167], v[100:103]
    buffer_store_dwordx4 v[208:211], v3, s[28:31], s50 offen offset:0 sc1
    v_mfma_f32_16x16x32_bf16 v[104:107], v[32:35], a[160:163], v[104:107]
    ds_read_b128 v[28:31], v7 offset:9216
    buffer_load_dwordx4 v3, s[28:31], s27 offen offset:2048 lds
    v_mfma_f32_16x16x32_bf16 v[108:111], v[32:35], a[164:167], v[108:111]
    v_fma_f32 v76, v52, v243, v60
    s_waitcnt lgkmcnt(4)
    v_mfma_f32_16x16x32_bf16 v[112:115], v[8:11], a[160:163], v[112:115]
    ds_read_b128 v[32:35], v7 offset:10240
    v_fma_f32 v77, v53, v243, v61
    v_mfma_f32_16x16x32_bf16 v[116:119], v[8:11], a[164:167], v[116:119]
    v_fma_f32 v78, v54, v243, v62
    v_fma_f32 v79, v55, v243, v63
    v_mfma_f32_16x16x32_bf16 v[120:123], v[12:15], a[160:163], v[120:123]
    ds_read_b128 v[8:11], v7 offset:11264
    buffer_load_dwordx4 v3, s[28:31], s27 offen offset:3072 lds
    v_mfma_f32_16x16x32_bf16 v[124:127], v[12:15], a[164:167], v[124:127]
    v_fma_f32 v80, v56, v243, v64
    s_waitcnt lgkmcnt(4)
    v_mfma_f32_16x16x32_bf16 v[128:131], v[16:19], a[160:163], v[128:131]
    ds_read_b128 v[12:15], v7 offset:12288
    v_fma_f32 v81, v57, v243, v65
    v_mfma_f32_16x16x32_bf16 v[132:135], v[16:19], a[164:167], v[132:135]
    v_fma_f32 v82, v58, v243, v66
    v_fma_f32 v83, v59, v243, v67
    v_mfma_f32_16x16x32_bf16 v[136:139], v[20:23], a[160:163], v[136:139]
    ds_read_b128 v[16:19], v7 offset:13312
    s_add_u32 m0, s26, 81920
    v_mfma_f32_16x16x32_bf16 v[140:143], v[20:23], a[164:167], v[140:143]
    s_add_u32 s27, s42, 114688
    s_waitcnt lgkmcnt(4)
    v_mfma_f32_16x16x32_bf16 v[144:147], v[24:27], a[160:163], v[144:147]
    ds_read_b128 v[20:23], v7 offset:14336
    buffer_load_dwordx4 v3, s[28:31], s27 offen offset:0 lds
    v_mfma_f32_16x16x32_bf16 v[148:151], v[24:27], a[164:167], v[148:151]
    v_fmac_f32 v76, v212, v241
    v_fmac_f32 v77, v213, v241
    v_mfma_f32_16x16x32_bf16 v[152:155], v[28:31], a[160:163], v[152:155]
    ds_read_b128 v[24:27], v7 offset:15360
    v_fmac_f32 v78, v214, v241
    v_mfma_f32_16x16x32_bf16 v[156:159], v[28:31], a[164:167], v[156:159]
    v_fmac_f32 v79, v215, v241
    buffer_load_dwordx4 v3, s[28:31], s27 offen offset:1024 lds
    v_fmac_f32 v80, v220, v241
    v_fmac_f32 v81, v221, v241
    s_waitcnt vmcnt(16)
    s_barrier
    s_waitcnt lgkmcnt(4)
    v_mfma_f32_16x16x32_bf16 v[160:163], v[32:35], a[160:163], v[160:163]
    ds_read_b128 v[28:31], v3 offset:0
    v_fmac_f32 v82, v222, v241
    v_mfma_f32_16x16x32_bf16 v[164:167], v[32:35], a[164:167], v[164:167]
    v_fmac_f32 v83, v223, v241
    v_mfma_f32_16x16x32_bf16 v[96:99], v[8:11], a[168:171], v[96:99]
    ds_read_b128 v[32:35], v3 offset:1024
    buffer_load_dwordx4 v3, s[28:31], s27 offen offset:2048 lds
    v_mfma_f32_16x16x32_bf16 v[100:103], v[8:11], a[172:175], v[100:103]
    v_cvt_pk_bf16_f32 v212, v76, v77
    s_waitcnt lgkmcnt(4)
    v_mfma_f32_16x16x32_bf16 v[104:107], v[12:15], a[168:171], v[104:107]
    ds_read_b128 v[8:11], v3 offset:2048
    v_cvt_pk_bf16_f32 v213, v78, v79
    v_mfma_f32_16x16x32_bf16 v[108:111], v[12:15], a[172:175], v[108:111]
    v_cvt_pk_bf16_f32 v214, v80, v81
    v_cvt_pk_bf16_f32 v215, v82, v83
    v_mfma_f32_16x16x32_bf16 v[112:115], v[16:19], a[168:171], v[112:115]
    ds_read_b128 v[12:15], v3 offset:3072
    buffer_load_dwordx4 v3, s[28:31], s27 offen offset:3072 lds
    v_mfma_f32_16x16x32_bf16 v[116:119], v[16:19], a[172:175], v[116:119]
    v_pk_max_i16 v212, v212, 0
    s_waitcnt lgkmcnt(4)
    v_mfma_f32_16x16x32_bf16 v[120:123], v[20:23], a[168:171], v[120:123]
    ds_read_b128 v[16:19], v3 offset:4096
    v_pk_max_i16 v213, v213, 0
    v_mfma_f32_16x16x32_bf16 v[124:127], v[20:23], a[172:175], v[124:127]
    v_pk_max_i16 v214, v214, 0
    v_pk_max_i16 v215, v215, 0
    v_mfma_f32_16x16x32_bf16 v[128:131], v[24:27], a[168:171], v[128:131]
    ds_read_b128 v[20:23], v3 offset:5120
    s_add_u32 m0, s26, 98304
    v_mfma_f32_16x16x32_bf16 v[132:135], v[24:27], a[172:175], v[132:135]
    s_add_u32 s27, s42, 131072
    s_waitcnt lgkmcnt(4)
    v_mfma_f32_16x16x32_bf16 v[136:139], v[28:31], a[168:171], v[136:139]
    ds_read_b128 v[24:27], v3 offset:6144
    buffer_load_dwordx4 v3, s[28:31], s27 offen offset:0 lds
    v_mfma_f32_16x16x32_bf16 v[140:143], v[28:31], a[172:175], v[140:143]
    buffer_store_dwordx4 v[212:215], v3, s[28:31], s51 offen offset:0 sc1
    v_mfma_f32_16x16x32_bf16 v[144:147], v[32:35], a[168:171], v[144:147]
    ds_read_b128 v[28:31], v3 offset:7168
    v_fma_f32 v68, v36, v242, v44
    v_mfma_f32_16x16x32_bf16 v[148:151], v[32:35], a[172:175], v[148:151]
    v_fma_f32 v69, v37, v242, v45
    s_waitcnt lgkmcnt(4)
    v_mfma_f32_16x16x32_bf16 v[152:155], v[8:11], a[168:171], v[152:155]
    ds_read_b128 v[32:35], v3 offset:8192
    buffer_load_dwordx4 v3, s[28:31], s27 offen offset:1024 lds
    v_mfma_f32_16x16x32_bf16 v[156:159], v[8:11], a[172:175], v[156:159]
    v_fma_f32 v70, v38, v242, v46
    v_fma_f32 v71, v39, v242, v47
    v_mfma_f32_16x16x32_bf16 v[160:163], v[12:15], a[168:171], v[160:163]
    ds_read_b128 v[8:11], v3 offset:9216
    v_fma_f32 v72, v40, v242, v48
    v_mfma_f32_16x16x32_bf16 v[164:167], v[12:15], a[172:175], v[164:167]
    v_fma_f32 v73, v41, v242, v49
    buffer_load_dwordx4 v3, s[28:31], s27 offen offset:2048 lds
    v_fma_f32 v74, v42, v242, v50
    v_fma_f32 v75, v43, v242, v51
    s_waitcnt lgkmcnt(4)
    v_mfma_f32_16x16x32_bf16 v[96:99], v[16:19], a[176:179], v[96:99]
    ds_read_b128 v[12:15], v3 offset:10240
    v_fmac_f32 v68, v224, v240
    v_mfma_f32_16x16x32_bf16 v[100:103], v[16:19], a[180:183], v[100:103]
    v_fmac_f32 v69, v225, v240
    v_mfma_f32_16x16x32_bf16 v[104:107], v[20:23], a[176:179], v[104:107]
    ds_read_b128 v[16:19], v3 offset:11264
    buffer_load_dwordx4 v3, s[28:31], s27 offen offset:3072 lds
    v_mfma_f32_16x16x32_bf16 v[108:111], v[20:23], a[180:183], v[108:111]
    v_fmac_f32 v70, v226, v240
    s_waitcnt lgkmcnt(4)
    v_mfma_f32_16x16x32_bf16 v[112:115], v[24:27], a[176:179], v[112:115]
    ds_read_b128 v[20:23], v3 offset:12288
    v_fmac_f32 v71, v227, v240
    v_mfma_f32_16x16x32_bf16 v[116:119], v[24:27], a[180:183], v[116:119]
    v_fmac_f32 v72, v232, v240
    v_fmac_f32 v73, v233, v240
    v_mfma_f32_16x16x32_bf16 v[120:123], v[28:31], a[176:179], v[120:123]
    ds_read_b128 v[24:27], v3 offset:13312
    s_add_u32 m0, s26, 114688
    v_mfma_f32_16x16x32_bf16 v[124:127], v[28:31], a[180:183], v[124:127]
    s_add_u32 s27, s42, 147456
    s_waitcnt lgkmcnt(4)
    v_mfma_f32_16x16x32_bf16 v[128:131], v[32:35], a[176:179], v[128:131]
    ds_read_b128 v[28:31], v3 offset:14336
    buffer_load_dwordx4 v3, s[28:31], s27 offen offset:0 lds
    v_mfma_f32_16x16x32_bf16 v[132:135], v[32:35], a[180:183], v[132:135]
    v_fmac_f32 v74, v234, v240
    v_fmac_f32 v75, v235, v240
    v_mfma_f32_16x16x32_bf16 v[136:139], v[8:11], a[176:179], v[136:139]
    ds_read_b128 v[32:35], v3 offset:15360
    v_cvt_pk_bf16_f32 v224, v68, v69
    v_mfma_f32_16x16x32_bf16 v[140:143], v[8:11], a[180:183], v[140:143]
    v_cvt_pk_bf16_f32 v225, v70, v71
    s_waitcnt lgkmcnt(4)
    v_mfma_f32_16x16x32_bf16 v[144:147], v[12:15], a[176:179], v[144:147]
    ds_read_b128 v[8:11], v3 offset:16384
    buffer_load_dwordx4 v3, s[28:31], s27 offen offset:1024 lds
    v_mfma_f32_16x16x32_bf16 v[148:151], v[12:15], a[180:183], v[148:151]
    v_cvt_pk_bf16_f32 v226, v72, v73
    v_cvt_pk_bf16_f32 v227, v74, v75
    v_mfma_f32_16x16x32_bf16 v[152:155], v[16:19], a[176:179], v[152:155]
    ds_read_b128 v[12:15], v3 offset:17408
    v_pk_max_i16 v224, v224, 0
    v_mfma_f32_16x16x32_bf16 v[156:159], v[16:19], a[180:183], v[156:159]
    v_pk_max_i16 v225, v225, 0
    s_waitcnt lgkmcnt(4)
    v_mfma_f32_16x16x32_bf16 v[160:163], v[20:23], a[176:179], v[160:163]
    ds_read_b128 v[16:19], v3 offset:18432
    buffer_load_dwordx4 v3, s[28:31], s27 offen offset:2048 lds
    v_mfma_f32_16x16x32_bf16 v[164:167], v[20:23], a[180:183], v[164:167]
    v_pk_max_i16 v226, v226, 0
    v_pk_max_i16 v227, v227, 0
    buffer_store_dwordx4 v[224:227], v3, s[28:31], s50 offen offset:1024 sc1
    v_fma_f32 v76, v36, v243, v44
    v_mfma_f32_16x16x32_bf16 v[96:99], v[24:27], a[184:187], v[96:99]
    ds_read_b128 v[20:23], v3 offset:19456
    buffer_load_dwordx4 v3, s[28:31], s27 offen offset:3072 lds
    v_mfma_f32_16x16x32_bf16 v[100:103], v[24:27], a[188:191], v[100:103]
    v_fma_f32 v77, v37, v243, v45
    s_waitcnt vmcnt(18)
    v_cmp_ne_u32 vcc, 0, v85
    s_nop 0
    s_cmp_eq_u64 vcc, -1
    s_cbranch_scc0 k8_kernel_slow12
k8_kernel_back13:
    s_waitcnt lgkmcnt(4)
    v_mfma_f32_16x16x32_bf16 v[104:107], v[28:31], a[184:187], v[104:107]
    ds_read_b128 v[24:27], v3 offset:20480
    v_fma_f32 v78, v38, v243, v46
    v_mfma_f32_16x16x32_bf16 v[108:111], v[28:31], a[188:191], v[108:111]
    v_fma_f32 v79, v39, v243, v47
    v_fma_f32 v80, v40, v243, v48
    v_mfma_f32_16x16x32_bf16 v[112:115], v[32:35], a[184:187], v[112:115]
    ds_read_b128 v[28:31], v3 offset:21504
    s_add_u32 s52, s52, 4096
    v_mfma_f32_16x16x32_bf16 v[116:119], v[32:35], a[188:191], v[116:119]
    buffer_load_dwordx4 a[240:243], v3, s[28:31], s52 offen offset:0 sc1
    s_waitcnt lgkmcnt(4)
    v_mfma_f32_16x16x32_bf16 v[120:123], v[8:11], a[184:187], v[120:123]
    ds_read_b128 v[32:35], v3 offset:22528
    v_fma_f32 v81, v41, v243, v49
    v_mfma_f32_16x16x32_bf16 v[124:127], v[8:11], a[188:191], v[124:127]
    v_fma_f32 v82, v42, v243, v50
    v_fma_f32 v83, v43, v243, v51
    v_mfma_f32_16x16x32_bf16 v[128:131], v[12:15], a[184:187], v[128:131]
    ds_read_b128 v[8:11], v3 offset:23552
    v_fmac_f32 v76, v228, v241
    v_mfma_f32_16x16x32_bf16 v[132:135], v[12:15], a[188:191], v[132:135]
    s_add_u32 s53, s53, 4096
    s_waitcnt lgkmcnt(4)
    v_mfma_f32_16x16x32_bf16 v[136:139], v[16:19], a[184:187], v[136:139]
    ds_read_b128 v[12:15], v3 offset:24576
    buffer_load_dwordx4 a[244:247], v3, s[28:31], s53 offen offset:0 sc1
    v_mfma_f32_16x16x32_bf16 v[140:143], v[16:19], a[188:191], v[140:143]
    v_fmac_f32 v77, v229, v241
    v_fmac_f32 v78, v230, v241
    v_mfma_f32_16x16x32_bf16 v[144:147], v[20:23], a[184:187], v[144:147]
    ds_read_b128 v[16:19], v3 offset:25600
    v_fmac_f32 v79, v231, v241
    v_mfma_f32_16x16x32_bf16 v[148:151], v[20:23], a[188:191], v[148:151]
    v_fmac_f32 v80, v236, v241
    s_waitcnt lgkmcnt(4)
    v_mfma_f32_16x16x32_bf16 v[152:155], v[24:27], a[184:187], v[152:155]
    ds_read_b128 v[20:23], v3 offset:26624
    buffer_load_dwordx4 a[248:251], v3, s[28:31], s52 offen offset:1024 sc1
    v_mfma_f32_16x16x32_bf16 v[156:159], v[24:27], a[188:191], v[156:159]
    v_fmac_f32 v81, v237, v241
    v_fmac_f32 v82, v238, v241
    v_mfma_f32_16x16x32_bf16 v[160:163], v[28:31], a[184:187], v[160:163]
    ds_read_b128 v[24:27], v3 offset:27648
    v_fmac_f32 v83, v239, v241
    v_mfma_f32_16x16x32_bf16 v[164:167], v[28:31], a[188:191], v[164:167]
    v_cvt_pk_bf16_f32 v228, v76, v77
    buffer_load_dwordx4 a[252:255], v3, s[28:31], s53 offen offset:1024 sc1
    v_cvt_pk_bf16_f32 v229, v78, v79
    v_cvt_pk_bf16_f32 v230, v80, v81
    s_waitcnt lgkmcnt(4)
    v_mfma_f32_16x16x32_bf16 v[96:99], v[32:35], a[192:195], v[96:99]
    ds_read_b128 v[28:31], v3 offset:28672
    v_cvt_pk_bf16_f32 v231, v82, v83
    v_mfma_f32_16x16x32_bf16 v[100:103], v[32:35], a[196:199], v[100:103]
    v_pk_max_i16 v228, v228, 0
    v_mfma_f32_16x16x32_bf16 v[104:107], v[8:11], a[192:195], v[104:107]
    ds_read_b128 v[32:35], v3 offset:29696
    buffer_load_dwordx4 a[144:147], v3, s[28:31], s52 offen offset:2048 sc1
    v_mfma_f32_16x16x32_bf16 v[108:111], v[8:11], a[196:199], v[108:111]
    v_pk_max_i16 v229, v229, 0
    s_waitcnt lgkmcnt(4)
    v_mfma_f32_16x16x32_bf16 v[112:115], v[12:15], a[192:195], v[112:115]
    ds_read_b128 v[8:11], v3 offset:30720
    v_pk_max_i16 v230, v230, 0
    v_mfma_f32_16x16x32_bf16 v[116:119], v[12:15], a[196:199], v[116:119]
    v_pk_max_i16 v231, v231, 0
    buffer_store_dwordx4 v[228:231], v3, s[28:31], s51 offen offset:1024 sc1
    v_mfma_f32_16x16x32_bf16 v[120:123], v[16:19], a[192:195], v[120:123]
    ds_read_b128 v[12:15], v3 offset:31744
    buffer_load_dwordx4 a[148:151], v3, s[28:31], s53 offen offset:2048 sc1
    v_mfma_f32_16x16x32_bf16 v[124:127], v[16:19], a[196:199], v[124:127]
    s_barrier
    s_waitcnt lgkmcnt(4)
    v_mfma_f32_16x16x32_bf16 v[128:131], v[20:23], a[192:195], v[128:131]
    ds_read_b128 v[16:19], v3 offset:32768
    v_mfma_f32_16x16x32_bf16 v[132:135], v[20:23], a[196:199], v[132:135]
    v_mfma_f32_16x16x32_bf16 v[136:139], v[24:27], a[192:195], v[136:139]
    ds_read_b128 v[20:23], v3 offset:33792
    buffer_load_dwordx4 a[152:155], v3, s[28:31], s52 offen offset:3072 sc1
    v_mfma_f32_16x16x32_bf16 v[140:143], v[24:27], a[196:199], v[140:143]
    s_waitcnt lgkmcnt(4)
    v_mfma_f32_16x16x32_bf16 v[144:147], v[28:31], a[192:195], v[144:147]
    ds_read_b128 v[24:27], v3 offset:34816
    v_mfma_f32_16x16x32_bf16 v[148:151], v[28:31], a[196:199], v[148:151]
    v_mfma_f32_16x16x32_bf16 v[152:155], v[32:35], a[192:195], v[152:155]
    ds_read_b128 v[28:31], v3 offset:35840
    buffer_load_dwordx4 a[156:159], v3, s[28:31], s53 offen offset:3072 sc1
    v_mfma_f32_16x16x32_bf16 v[156:159], v[32:35], a[196:199], v[156:159]
    s_waitcnt lgkmcnt(4)
    v_mfma_f32_16x16x32_bf16 v[160:163], v[8:11], a[192:195], v[160:163]
    ds_read_b128 v[32:35], v3 offset:36864
    v_mfma_f32_16x16x32_bf16 v[164:167], v[8:11], a[196:199], v[164:167]
    v_mfma_f32_16x16x32_bf16 v[96:99], v[12:15], a[200:203], v[96:99]
    ds_read_b128 v[8:11], v3 offset:37888
    s_add_u32 s52, s52, 4096
    v_mfma_f32_16x16x32_bf16 v[100:103], v[12:15], a[204:207], v[100:103]
    buffer_load_dwordx4 a[160:163], v3, s[28:31], s52 offen offset:0 sc1
    s_waitcnt lgkmcnt(4)
    v_mfma_f32_16x16x32_bf16 v[104:107], v[16:19], a[200:203], v[104:107]
    ds_read_b128 v[12:15], v3 offset:38912
    v_mfma_f32_16x16x32_bf16 v[108:111], v[16:19], a[204:207], v[108:111]
    v_mfma_f32_16x16x32_bf16 v[112:115], v[20:23], a[200:203], v[112:115]
    ds_read_b128 v[16:19], v3 offset:39936
    s_add_u32 s53, s53, 4096
    v_mfma_f32_16x16x32_bf16 v[116:119], v[20:23], a[204:207], v[116:119]
    buffer_load_dwordx4 a[164:167], v3, s[28:31], s53 offen offset:0 sc1
    s_waitcnt lgkmcnt(4)
    v_mfma_f32_16x16x32_bf16 v[120:123], v[24:27], a[200:203], v[120:123]
    ds_read_b128 v[20:23], v3 offset:40960
    v_mfma_f32_16x16x32_bf16 v[124:127], v[24:27], a[204:207], v[124:127]
    v_mfma_f32_16x16x32_bf16 v[128:131], v[28:31], a[200:203], v[128:131]
    ds_read_b128 v[24:27], v3 offset:41984
    buffer_load_dwordx4 a[168:171], v3, s[28:31], s52 offen offset:1024 sc1
    v_mfma_f32_16x16x32_bf16 v[132:135], v[28:31], a[204:207], v[132:135]
    s_waitcnt lgkmcnt(4)
    v_mfma_f32_16x16x32_bf16 v[136:139], v[32:35], a[200:203], v[136:139]
    ds_read_b128 v[28:31], v3 offset:43008
    v_mfma_f32_16x16x32_bf16 v[140:143], v[32:35], a[204:207], v[140:143]
    v_mfma_f32_16x16x32_bf16 v[144:147], v[8:11], a[200:203], v[144:147]
    ds_read_b128 v[32:35], v3 offset:44032
    buffer_load_dwordx4 a[172:175], v3, s[28:31], s53 offen offset:1024 sc1
    v_mfma_f32_16x16x32_bf16 v[148:151], v[8:11], a[204:207], v[148:151]
    s_waitcnt lgkmcnt(4)
    v_mfma_f32_16x16x32_bf16 v[152:155], v[12:15], a[200:203], v[152:155]
    ds_read_b128 v[8:11], v3 offset:45056
    v_mfma_f32_16x16x32_bf16 v[156:159], v[12:15], a[204:207], v[156:159]
    v_mfma_f32_16x16x32_bf16 v[160:163], v[16:19], a[200:203], v[160:163]
    ds_read_b128 v[12:15], v3 offset:46080
    buffer_load_dwordx4 a[176:179], v3, s[28:31], s52 offen offset:2048 sc1
    v_mfma_f32_16x16x32_bf16 v[164:167], v[16:19], a[204:207], v[164:167]
    s_waitcnt lgkmcnt(4)
    v_mfma_f32_16x16x32_bf16 v[96:99], v[20:23], a[208:211], v[96:99]
    ds_read_b128 v[16:19], v3 offset:47104
    v_mfma_f32_16x16x32_bf16 v[100:103], v[20:23], a[212:215], v[100:103]
    v_mfma_f32_16x16x32_bf16 v[104:107], v[24:27], a[208:211], v[104:107]
    ds_read_b128 v[20:23], v3 offset:48128
    buffer_load_dwordx4 a[180:183], v3, s[28:31], s53 offen offset:2048 sc1
    v_mfma_f32_16x16x32_bf16 v[108:111], v[24:27], a[212:215], v[108:111]
    s_waitcnt lgkmcnt(4)
    v_mfma_f32_16x16x32_bf16 v[112:115], v[28:31], a[208:211], v[112:115]
    ds_read_b128 v[24:27], v3 offset:49152
    v_mfma_f32_16x16x32_bf16 v[116:119], v[28:31], a[212:215], v[116:119]
    v_mfma_f32_16x16x32_bf16 v[120:123], v[32:35], a[208:211], v[120:123]
    ds_read_b128 v[28:31], v3 offset:50176
    buffer_load_dwordx4 a[184:187], v3, s[28:31], s52 offen offset:3072 sc1
    v_mfma_f32_16x16x32_bf16 v[124:127], v[32:35], a[212:215], v[124:127]
    s_waitcnt lgkmcnt(4)
    v_mfma_f32_16x16x32_bf16 v[128:131], v[8:11], a[208:211], v[128:131]
    ds_read_b128 v[32:35], v3 offset:51200
    v_mfma_f32_16x16x32_bf16 v[132:135], v[8:11], a[212:215], v[132:135]
    v_mfma_f32_16x16x32_bf16 v[136:139], v[12:15], a[208:211], v[136:139]
    ds_read_b128 v[8:11], v3 offset:52224
    buffer_load_dwordx4 a[188:191], v3, s[28:31], s53 offen offset:3072 sc1
    v_mfma_f32_16x16x32_bf16 v[140:143], v[12:15], a[212:215], v[140:143]
    s_waitcnt lgkmcnt(4)
    v_mfma_f32_16x16x32_bf16 v[144:147], v[16:19], a[208:211], v[144:147]
    ds_read_b128 v[12:15], v3 offset:53248
    v_mfma_f32_16x16x32_bf16 v[148:151], v[16:19], a[212:215], v[148:151]
    v_mfma_f32_16x16x32_bf16 v[152:155], v[20:23], a[208:211], v[152:155]
    ds_read_b128 v[16:19], v3 offset:54272
    s_add_u32 m0, s26, 131072
    v_mfma_f32_16x16x32_bf16 v[156:159], v[20:23], a[212:215], v[156:159]
    s_add_u32 s27, s42, 163840
    s_waitcnt lgkmcnt(4)
    v_mfma_f32_16x16x32_bf16 v[160:163], v[24:27], a[208:211], v[160:163]
    ds_read_b128 v[20:23], v3 offset:55296
    buffer_load_dwordx4 v3, s[28:31], s27 offen offset:0 lds
    v_mfma_f32_16x16x32_bf16 v[164:167], v[24:27], a[212:215], v[164:167]
    v_mfma_f32_16x16x32_bf16 v[96:99], v[28:31], a[216:219], v[96:99]
    ds_read_b128 v[24:27], v3 offset:56320
    buffer_load_dwordx4 v3, s[28:31], s27 offen offset:1024 lds
    v_mfma_f32_16x16x32_bf16 v[100:103], v[28:31], a[220:223], v[100:103]
    s_waitcnt lgkmcnt(4)
    v_mfma_f32_16x16x32_bf16 v[104:107], v[32:35], a[216:219], v[104:107]
    ds_read_b128 v[28:31], v3 offset:57344
    v_mfma_f32_16x16x32_bf16 v[108:111], v[32:35], a[220:223], v[108:111]
    v_mfma_f32_16x16x32_bf16 v[112:115], v[8:11], a[216:219], v[112:115]
    ds_read_b128 v[32:35], v3 offset:58368
    buffer_load_dwordx4 v3, s[28:31], s27 offen offset:2048 lds
    v_mfma_f32_16x16x32_bf16 v[116:119], v[8:11], a[220:223], v[116:119]
    s_waitcnt lgkmcnt(4)
    v_mfma_f32_16x16x32_bf16 v[120:123], v[12:15], a[216:219], v[120:123]
    ds_read_b128 v[8:11], v3 offset:59392
    v_mfma_f32_16x16x32_bf16 v[124:127], v[12:15], a[220:223], v[124:127]
    v_mfma_f32_16x16x32_bf16 v[128:131], v[16:19], a[216:219], v[128:131]
    ds_read_b128 v[12:15], v3 offset:60416
    buffer_load_dwordx4 v3, s[28:31], s27 offen offset:3072 lds
    v_mfma_f32_16x16x32_bf16 v[132:135], v[16:19], a[220:223], v[132:135]
    s_waitcnt lgkmcnt(4)
    v_mfma_f32_16x16x32_bf16 v[136:139], v[20:23], a[216:219], v[136:139]
    ds_read_b128 v[16:19], v3 offset:61440
    v_mfma_f32_16x16x32_bf16 v[140:143], v[20:23], a[220:223], v[140:143]
    v_mfma_f32_16x16x32_bf16 v[144:147], v[24:27], a[216:219], v[144:147]
    ds_read_b128 v[20:23], v3 offset:62464
    s_add_u32 m0, s26, 0
    v_mfma_f32_16x16x32_bf16 v[148:151], v[24:27], a[220:223], v[148:151]
    s_add_u32 s27, s42, 180224
    s_waitcnt lgkmcnt(4)
    v_mfma_f32_16x16x32_bf16 v[152:155], v[28:31], a[216:219], v[152:155]
    ds_read_b128 v[24:27], v3 offset:63488
    buffer_load_dwordx4 v3, s[28:31], s27 offen offset:0 lds
    v_mfma_f32_16x16x32_bf16 v[156:159], v[28:31], a[220:223], v[156:159]
    buffer_load_dword v86, v247, s[28:31], s44 offen offset:1024 sc1
    v_mfma_f32_16x16x32_bf16 v[160:163], v[32:35], a[216:219], v[160:163]
    ds_read_b128 v[28:31], v3 offset:64512
    buffer_load_dwordx4 v3, s[28:31], s27 offen offset:1024 lds
    v_mfma_f32_16x16x32_bf16 v[164:167], v[32:35], a[220:223], v[164:167]
    s_waitcnt vmcnt(18)
    s_barrier
    s_cmp_lg_u32 s18, 0
    s_cbranch_scc1 k8_kernel_sig14
    s_mov_b64 exec, 0xff
    buffer_store_dwordx4 v[244:247], v94, s[28:31], s44 offen offset:1536 sc1
    s_mov_b64 exec, -1
k8_kernel_sig14:
    s_waitcnt lgkmcnt(4)
    v_mfma_f32_16x16x32_bf16 v[96:99], v[8:11], a[224:227], v[96:99]
    ds_read_b128 v[32:35], v6 offset:0
    v_mfma_f32_16x16x32_bf16 v[100:103], v[8:11], a[228:231], v[100:103]
    v_mfma_f32_16x16x32_bf16 v[104:107], v[12:15], a[224:227], v[104:107]
    ds_read_b128 v[8:11], v6 offset:1024
    buffer_load_dwordx4 v3, s[28:31], s27 offen offset:2048 lds
    v_mfma_f32_16x16x32_bf16 v[108:111], v[12:15], a[228:231], v[108:111]
    s_waitcnt lgkmcnt(4)
    v_mfma_f32_16x16x32_bf16 v[112:115], v[16:19], a[224:227], v[112:115]
    ds_read_b128 v[12:15], v6 offset:2048
    v_mfma_f32_16x16x32_bf16 v[116:119], v[16:19], a[228:231], v[116:119]
    v_mfma_f32_16x16x32_bf16 v[120:123], v[20:23], a[224:227], v[120:123]
    ds_read_b128 v[16:19], v6 offset:3072
    buffer_load_dwordx4 v3, s[28:31], s27 offen offset:3072 lds
    v_mfma_f32_16x16x32_bf16 v[124:127], v[20:23], a[228:231], v[124:127]
    s_waitcnt lgkmcnt(4)
    v_mfma_f32_16x16x32_bf16 v[128:131], v[24:27], a[224:227], v[128:131]
    ds_read_b128 v[20:23], v6 offset:4096
    v_mfma_f32_16x16x32_bf16 v[132:135], v[24:27], a[228:231], v[132:135]
    v_mfma_f32_16x16x32_bf16 v[136:139], v[28:31], a[224:227], v[136:139]
    ds_read_b128 v[24:27], v6 offset:5120
    s_add_u32 m0, s26, 16384
    v_mfma_f32_16x16x32_bf16 v[140:143], v[28:31], a[228:231], v[140:143]
    s_add_u32 s27, s42, 196608
    s_waitcnt lgkmcnt(4)
    v_mfma_f32_16x16x32_bf16 v[144:147], v[32:35], a[224:227], v[144:147]
    ds_read_b128 v[28:31], v6 offset:6144
    buffer_load_dwordx4 v3, s[28:31], s27 offen offset:0 lds
    v_mfma_f32_16x16x32_bf16 v[148:151], v[32:35], a[228:231], v[148:151]
    v_mfma_f32_16x16x32_bf16 v[152:155], v[8:11], a[224:227], v[152:155]
    ds_read_b128 v[32:35], v6 offset:7168
    buffer_load_dwordx4 v3, s[28:31], s27 offen offset:1024 lds
    v_mfma_f32_16x16x32_bf16 v[156:159], v[8:11], a[228:231], v[156:159]
    s_waitcnt lgkmcnt(4)
    v_mfma_f32_16x16x32_bf16 v[160:163], v[12:15], a[224:227], v[160:163]
    ds_read_b128 v[8:11], v6 offset:8192
    v_mfma_f32_16x16x32_bf16 v[164:167], v[12:15], a[228:231], v[164:167]
    v_mfma_f32_16x16x32_bf16 v[96:99], v[16:19], a[232:235], v[96:99]
    ds_read_b128 v[12:15], v6 offset:9216
    buffer_load_dwordx4 v3, s[28:31], s27 offen offset:2048 lds
    v_mfma_f32_16x16x32_bf16 v[100:103], v[16:19], a[236:239], v[100:103]
    s_waitcnt lgkmcnt(4)
    v_mfma_f32_16x16x32_bf16 v[104:107], v[20:23], a[232:235], v[104:107]
    ds_read_b128 v[16:19], v6 offset:10240
    v_mfma_f32_16x16x32_bf16 v[108:111], v[20:23], a[236:239], v[108:111]
    v_mfma_f32_16x16x32_bf16 v[112:115], v[24:27], a[232:235], v[112:115]
    ds_read_b128 v[20:23], v6 offset:11264
    buffer_load_dwordx4 v3, s[28:31], s27 offen offset:3072 lds
    v_mfma_f32_16x16x32_bf16 v[116:119], v[24:27], a[236:239], v[116:119]
    s_waitcnt lgkmcnt(4)
    v_mfma_f32_16x16x32_bf16 v[120:123], v[28:31], a[232:235], v[120:123]
    ds_read_b128 v[24:27], v6 offset:12288
    v_mfma_f32_16x16x32_bf16 v[124:127], v[28:31], a[236:239], v[124:127]
    v_mfma_f32_16x16x32_bf16 v[128:131], v[32:35], a[232:235], v[128:131]
    ds_read_b128 v[28:31], v6 offset:13312
    s_add_u32 m0, s26, 32768
    v_mfma_f32_16x16x32_bf16 v[132:135], v[32:35], a[236:239], v[132:135]
    s_add_u32 s27, s42, 212992
    s_waitcnt lgkmcnt(4)
    v_mfma_f32_16x16x32_bf16 v[136:139], v[8:11], a[232:235], v[136:139]
    ds_read_b128 v[32:35], v6 offset:14336
    buffer_load_dwordx4 v3, s[28:31], s27 offen offset:0 lds
    v_mfma_f32_16x16x32_bf16 v[140:143], v[8:11], a[236:239], v[140:143]
    v_mfma_f32_16x16x32_bf16 v[144:147], v[12:15], a[232:235], v[144:147]
    ds_read_b128 v[8:11], v6 offset:15360
    buffer_load_dwordx4 v3, s[28:31], s27 offen offset:1024 lds
    v_mfma_f32_16x16x32_bf16 v[148:151], v[12:15], a[236:239], v[148:151]
    s_waitcnt lgkmcnt(4)
    v_mfma_f32_16x16x32_bf16 v[152:155], v[16:19], a[232:235], v[152:155]
    ds_read_b128 v[12:15], v6 offset:16384
    v_mfma_f32_16x16x32_bf16 v[156:159], v[16:19], a[236:239], v[156:159]
    v_mfma_f32_16x16x32_bf16 v[160:163], v[20:23], a[232:235], v[160:163]
    ds_read_b128 v[16:19], v6 offset:17408
    buffer_load_dwordx4 v3, s[28:31], s27 offen offset:2048 lds
    v_mfma_f32_16x16x32_bf16 v[164:167], v[20:23], a[236:239], v[164:167]
    s_waitcnt lgkmcnt(4)
    v_mfma_f32_16x16x32_bf16 v[96:99], v[24:27], a[240:243], v[96:99]
    ds_read_b128 v[20:23], v6 offset:18432
    v_mfma_f32_16x16x32_bf16 v[100:103], v[24:27], a[244:247], v[100:103]
    v_mfma_f32_16x16x32_bf16 v[104:107], v[28:31], a[240:243], v[104:107]
    ds_read_b128 v[24:27], v6 offset:19456
    buffer_load_dwordx4 v3, s[28:31], s27 offen offset:3072 lds
    v_mfma_f32_16x16x32_bf16 v[108:111], v[28:31], a[244:247], v[108:111]
    s_waitcnt lgkmcnt(4)
    v_mfma_f32_16x16x32_bf16 v[112:115], v[32:35], a[240:243], v[112:115]
    ds_read_b128 v[28:31], v6 offset:20480
    v_mfma_f32_16x16x32_bf16 v[116:119], v[32:35], a[244:247], v[116:119]
    v_mfma_f32_16x16x32_bf16 v[120:123], v[8:11], a[240:243], v[120:123]
    ds_read_b128 v[32:35], v6 offset:21504
    v_mfma_f32_16x16x32_bf16 v[124:127], v[8:11], a[244:247], v[124:127]
    s_waitcnt lgkmcnt(4)
    v_mfma_f32_16x16x32_bf16 v[128:131], v[12:15], a[240:243], v[128:131]
    ds_read_b128 v[8:11], v6 offset:22528
    v_mfma_f32_16x16x32_bf16 v[132:135], v[12:15], a[244:247], v[132:135]
    v_mfma_f32_16x16x32_bf16 v[136:139], v[16:19], a[240:243], v[136:139]
    ds_read_b128 v[12:15], v6 offset:23552
    v_mfma_f32_16x16x32_bf16 v[140:143], v[16:19], a[244:247], v[140:143]
    s_waitcnt lgkmcnt(4)
    v_mfma_f32_16x16x32_bf16 v[144:147], v[20:23], a[240:243], v[144:147]
    ds_read_b128 v[16:19], v6 offset:24576
    v_mfma_f32_16x16x32_bf16 v[148:151], v[20:23], a[244:247], v[148:151]
    v_mfma_f32_16x16x32_bf16 v[152:155], v[24:27], a[240:243], v[152:155]
    ds_read_b128 v[20:23], v6 offset:25600
    v_mfma_f32_16x16x32_bf16 v[156:159], v[24:27], a[244:247], v[156:159]
    s_waitcnt lgkmcnt(4)
    v_mfma_f32_16x16x32_bf16 v[160:163], v[28:31], a[240:243], v[160:163]
    ds_read_b128 v[24:27], v6 offset:26624
    v_mfma_f32_16x16x32_bf16 v[164:167], v[28:31], a[244:247], v[164:167]
    v_mfma_f32_16x16x32_bf16 v[96:99], v[32:35], a[248:251], v[96:99]
    ds_read_b128 v[28:31], v6 offset:27648
    v_mfma_f32_16x16x32_bf16 v[100:103], v[32:35], a[252:255], v[100:103]
    s_waitcnt vmcnt(11)
    v_cmp_ne_u32 vcc, 0, v86
    s_nop 0
    s_cmp_eq_u64 vcc, -1
    s_cbranch_scc0 k8_kernel_slow15
k8_kernel_back16:
    s_waitcnt lgkmcnt(4)
    v_mfma_f32_16x16x32_bf16 v[104:107], v[8:11], a[248:251], v[104:107]
    ds_read_b128 v[32:35], v6 offset:28672
    v_mfma_f32_16x16x32_bf16 v[108:111], v[8:11], a[252:255], v[108:111]
    v_mfma_f32_16x16x32_bf16 v[112:115], v[12:15], a[248:251], v[112:115]
    ds_read_b128 v[8:11], v6 offset:29696
    s_add_u32 s52, s52, 4096
    v_mfma_f32_16x16x32_bf16 v[116:119], v[12:15], a[252:255], v[116:119]
    buffer_load_dwordx4 a[192:195], v3, s[28:31], s52 offen offset:0 sc1
    s_waitcnt lgkmcnt(4)
    v_mfma_f32_16x16x32_bf16 v[120:123], v[16:19], a[248:251], v[120:123]
    ds_read_b128 v[12:15], v6 offset:30720
    s_add_u32 s53, s53, 4096
    v_mfma_f32_16x16x32_bf16 v[124:127], v[16:19], a[252:255], v[124:127]
    buffer_load_dwordx4 a[196:199], v3, s[28:31], s53 offen offset:0 sc1
    v_mfma_f32_16x16x32_bf16 v[128:131], v[20:23], a[248:251], v[128:131]
    ds_read_b128 v[16:19], v6 offset:31744
    buffer_load_dwordx4 a[200:203], v3, s[28:31], s52 offen offset:1024 sc1
    v_mfma_f32_16x16x32_bf16 v[132:135], v[20:23], a[252:255], v[132:135]
    s_barrier
    s_waitcnt lgkmcnt(4)
    v_mfma_f32_16x16x32_bf16 v[136:139], v[24:27], a[248:251], v[136:139]
    ds_read_b128 v[20:23], v6 offset:32768
    v_mfma_f32_16x16x32_bf16 v[140:143], v[24:27], a[252:255], v[140:143]
    v_mfma_f32_16x16x32_bf16 v[144:147], v[28:31], a[248:251], v[144:147]
    ds_read_b128 v[24:27], v6 offset:33792
    buffer_load_dwordx4 a[204:207], v3, s[28:31], s53 offen offset:1024 sc1
    v_mfma_f32_16x16x32_bf16 v[148:151], v[28:31], a[252:255], v[148:151]
    s_waitcnt lgkmcnt(4)
    v_mfma_f32_16x16x32_bf16 v[152:155], v[32:35], a[248:251], v[152:155]
    ds_read_b128 v[28:31], v6 offset:34816
    v_mfma_f32_16x16x32_bf16 v[156:159], v[32:35], a[252:255], v[156:159]
    v_mfma_f32_16x16x32_bf16 v[160:163], v[8:11], a[248:251], v[160:163]
    ds_read_b128 v[32:35], v6 offset:35840
    buffer_load_dwordx4 a[208:211], v3, s[28:31], s52 offen offset:2048 sc1
    v_mfma_f32_16x16x32_bf16 v[164:167], v[8:11], a[252:255], v[164:167]
    s_waitcnt lgkmcnt(4)
    v_mfma_f32_16x16x32_bf16 v[96:99], v[12:15], a[144:147], v[96:99]
    ds_read_b128 v[8:11], v6 offset:36864
    v_mfma_f32_16x16x32_bf16 v[100:103], v[12:15], a[148:151], v[100:103]
    v_mfma_f32_16x16x32_bf16 v[104:107], v[16:19], a[144:147], v[104:107]
    ds_read_b128 v[12:15], v6 offset:37888
    buffer_load_dwordx4 a[212:215], v3, s[28:31], s53 offen offset:2048 sc1
    v_mfma_f32_16x16x32_bf16 v[108:111], v[16:19], a[148:151], v[108:111]
    s_waitcnt lgkmcnt(4)
    v_mfma_f32_16x16x32_bf16 v[112:115], v[20:23], a[144:147], v[112:115]
    ds_read_b128 v[16:19], v6 offset:38912
    v_mfma_f32_16x16x32_bf16 v[116:119], v[20:23], a[148:151], v[116:119]
    v_mfma_f32_16x16x32_bf16 v[120:123], v[24:27], a[144:147], v[120:123]
    ds_read_b128 v[20:23], v6 offset:39936
    buffer_load_dwordx4 a[216:219], v3, s[28:31], s52 offen offset:3072 sc1
    v_mfma_f32_16x16x32_bf16 v[124:127], v[24:27], a[148:151], v[124:127]
    s_waitcnt lgkmcnt(4)
    v_mfma_f32_16x16x32_bf16 v[128:131], v[28:31], a[144:147], v[128:131]
    ds_read_b128 v[24:27], v6 offset:40960
    v_mfma_f32_16x16x32_bf16 v[132:135], v[28:31], a[148:151], v[132:135]
    v_mfma_f32_16x16x32_bf16 v[136:139], v[32:35], a[144:147], v[136:139]
    ds_read_b128 v[28:31], v6 offset:41984
    buffer_load_dwordx4 a[220:223], v3, s[28:31], s53 offen offset:3072 sc1
    v_mfma_f32_16x16x32_bf16 v[140:143], v[32:35], a[148:151], v[140:143]
    s_waitcnt lgkmcnt(4)
    v_mfma_f32_16x16x32_bf16 v[144:147], v[8:11], a[144:147], v[144:147]
    ds_read_b128 v[32:35], v6 offset:43008
    v_mfma_f32_16x16x32_bf16 v[148:151], v[8:11], a[148:151], v[148:151]
    v_mfma_f32_16x16x32_bf16 v[152:155], v[12:15], a[144:147], v[152:155]
    ds_read_b128 v[8:11], v6 offset:44032
    s_add_u32 s52, s52, 4096
    v_mfma_f32_16x16x32_bf16 v[156:159], v[12:15], a[148:151], v[156:159]
    buffer_load_dwordx4 a[224:227], v3, s[28:31], s52 offen offset:0 sc1
    s_waitcnt lgkmcnt(4)
    v_mfma_f32_16x16x32_bf16 v[160:163], v[16:19], a[144:147], v[160:163]
    ds_read_b128 v[12:15], v6 offset:45056
    v_mfma_f32_16x16x32_bf16 v[164:167], v[16:19], a[148:151], v[164:167]
    v_mfma_f32_16x16x32_bf16 v[96:99], v[20:23], a[152:155], v[96:99]
    ds_read_b128 v[16:19], v6 offset:46080
    s_add_u32 s53, s53, 4096
    v_mfma_f32_16x16x32_bf16 v[100:103], v[20:23], a[156:159], v[100:103]
    buffer_load_dwordx4 a[228:231], v3, s[28:31], s53 offen offset:0 sc1
    s_waitcnt lgkmcnt(4)
    v_mfma_f32_16x16x32_bf16 v[104:107], v[24:27], a[152:155], v[104:107]
    ds_read_b128 v[20:23], v6 offset:47104
    v_mfma_f32_16x16x32_bf16 v[108:111], v[24:27], a[156:159], v[108:111]
    v_mfma_f32_16x16x32_bf16 v[112:115], v[28:31], a[152:155], v[112:115]
    ds_read_b128 v[24:27], v6 offset:48128
    buffer_load_dwordx4 a[232:235], v3, s[28:31], s52 offen offset:1024 sc1
    v_mfma_f32_16x16x32_bf16 v[116:119], v[28:31], a[156:159], v[116:119]
    s_waitcnt lgkmcnt(4)
    v_mfma_f32_16x16x32_bf16 v[120:123], v[32:35], a[152:155], v[120:123]
    ds_read_b128 v[28:31], v6 offset:49152
    v_mfma_f32_16x16x32_bf16 v[124:127], v[32:35], a[156:159], v[124:127]
    v_mfma_f32_16x16x32_bf16 v[128:131], v[8:11], a[152:155], v[128:131]
    ds_read_b128 v[32:35], v6 offset:50176
    buffer_load_dwordx4 a[236:239], v3, s[28:31], s53 offen offset:1024 sc1
    v_mfma_f32_16x16x32_bf16 v[132:135], v[8:11], a[156:159], v[132:135]
    s_waitcnt lgkmcnt(4)
    v_mfma_f32_16x16x32_bf16 v[136:139], v[12:15], a[152:155], v[136:139]
    ds_read_b128 v[8:11], v6 offset:51200
    v_mfma_f32_16x16x32_bf16 v[140:143], v[12:15], a[156:159], v[140:143]
    v_mfma_f32_16x16x32_bf16 v[144:147], v[16:19], a[152:155], v[144:147]
    ds_read_b128 v[12:15], v6 offset:52224
    buffer_load_dwordx4 a[240:243], v3, s[28:31], s52 offen offset:2048 sc1
    v_mfma_f32_16x16x32_bf16 v[148:151], v[16:19], a[156:159], v[148:151]
    s_waitcnt lgkmcnt(4)
    v_mfma_f32_16x16x32_bf16 v[152:155], v[20:23], a[152:155], v[152:155]
    ds_read_b128 v[16:19], v6 offset:53248
    v_mfma_f32_16x16x32_bf16 v[156:159], v[20:23], a[156:159], v[156:159]
    v_mfma_f32_16x16x32_bf16 v[160:163], v[24:27], a[152:155], v[160:163]
    ds_read_b128 v[20:23], v6 offset:54272
    buffer_load_dwordx4 a[244:247], v3, s[28:31], s53 offen offset:2048 sc1
    v_mfma_f32_16x16x32_bf16 v[164:167], v[24:27], a[156:159], v[164:167]
    s_waitcnt lgkmcnt(4)
    v_mfma_f32_16x16x32_bf16 v[96:99], v[28:31], a[160:163], v[96:99]
    ds_read_b128 v[24:27], v6 offset:55296
    v_mfma_f32_16x16x32_bf16 v[100:103], v[28:31], a[164:167], v[100:103]
    v_mfma_f32_16x16x32_bf16 v[104:107], v[32:35], a[160:163], v[104:107]
    ds_read_b128 v[28:31], v6 offset:56320
    s_add_u32 m0, s26, 49152
    v_mfma_f32_16x16x32_bf16 v[108:111], v[32:35], a[164:167], v[108:111]
    s_add_u32 s27, s42, 229376
    s_waitcnt lgkmcnt(4)
    v_mfma_f32_16x16x32_bf16 v[112:115], v[8:11], a[160:163], v[112:115]
    ds_read_b128 v[32:35], v6 offset:57344
    buffer_load_dwordx4 v3, s[28:31], s27 offen offset:0 lds
    v_mfma_f32_16x16x32_bf16 v[116:119], v[8:11], a[164:167], v[116:119]
    v_mfma_f32_16x16x32_bf16 v[120:123], v[12:15], a[160:163], v[120:123]
    ds_read_b128 v[8:11], v6 offset:58368
    buffer_load_dwordx4 v3, s[28:31], s27 offen offset:1024 lds
    v_mfma_f32_16x16x32_bf16 v[124:127], v[12:15], a[164:167], v[124:127]
    s_waitcnt lgkmcnt(4)
    v_mfma_f32_16x16x32_bf16 v[128:131], v[16:19], a[160:163], v[128:131]
    ds_read_b128 v[12:15], v6 offset:59392
    v_mfma_f32_16x16x32_bf16 v[132:135], v[16:19], a[164:167], v[132:135]
    v_mfma_f32_16x16x32_bf16 v[136:139], v[20:23], a[160:163], v[136:139]
    ds_read_b128 v[16:19], v6 offset:60416
    buffer_load_dwordx4 v3, s[28:31], s27 offen offset:2048 lds
    v_mfma_f32_16x16x32_bf16 v[140:143], v[20:23], a[164:167], v[140:143]
    s_waitcnt lgkmcnt(4)
    v_mfma_f32_16x16x32_bf16 v[144:147], v[24:27], a[160:163], v[144:147]
    ds_read_b128 v[20:23], v6 offset:61440
    v_mfma_f32_16x16x32_bf16 v[148:151], v[24:27], a[164:167], v[148:151]
    v_mfma_f32_16x16x32_bf16 v[152:155], v[28:31], a[160:163], v[152:155]
    ds_read_b128 v[24:27], v6 offset:62464
    buffer_load_dwordx4 v3, s[28:31], s27 offen offset:3072 lds
    v_mfma_f32_16x16x32_bf16 v[156:159], v[28:31], a[164:167], v[156:159]
    s_waitcnt lgkmcnt(4)
    v_mfma_f32_16x16x32_bf16 v[160:163], v[32:35], a[160:163], v[160:163]
    ds_read_b128 v[28:31], v6 offset:63488
    v_mfma_f32_16x16x32_bf16 v[164:167], v[32:35], a[164:167], v[164:167]
    v_mfma_f32_16x16x32_bf16 v[96:99], v[8:11], a[168:171], v[96:99]
    ds_read_b128 v[32:35], v6 offset:64512
    s_add_u32 m0, s26, 65536
    v_mfma_f32_16x16x32_bf16 v[100:103], v[8:11], a[172:175], v[100:103]
    s_add_u32 s27, s42, 245760
    buffer_load_dwordx4 v3, s[28:31], s27 offen offset:0 lds
    s_waitcnt vmcnt(27)
    s_barrier
    s_waitcnt lgkmcnt(4)
    v_mfma_f32_16x16x32_bf16 v[104:107], v[12:15], a[168:171], v[104:107]
    ds_read_b128 v[8:11], v7 offset:0
    v_mfma_f32_16x16x32_bf16 v[108:111], v[12:15], a[172:175], v[108:111]
    v_mfma_f32_16x16x32_bf16 v[112:115], v[16:19], a[168:171], v[112:115]
    ds_read_b128 v[12:15], v7 offset:1024
    buffer_load_dwordx4 v3, s[28:31], s27 offen offset:1024 lds
    v_mfma_f32_16x16x32_bf16 v[116:119], v[16:19], a[172:175], v[116:119]
    s_waitcnt lgkmcnt(4)
    v_mfma_f32_16x16x32_bf16 v[120:123], v[20:23], a[168:171], v[120:123]
    ds_read_b128 v[16:19], v7 offset:2048
    v_mfma_f32_16x16x32_bf16 v[124:127], v[20:23], a[172:175], v[124:127]
    v_mfma_f32_16x16x32_bf16 v[128:131], v[24:27], a[168:171], v[128:131]
    ds_read_b128 v[20:23], v7 offset:3072
    buffer_load_dwordx4 v3, s[28:31], s27 offen offset:2048 lds
    v_mfma_f32_16x16x32_bf16 v[132:135], v[24:27], a[172:175], v[132:135]
    s_waitcnt lgkmcnt(4)
    v_mfma_f32_16x16x32_bf16 v[136:139], v[28:31], a[168:171], v[136:139]
    ds_read_b128 v[24:27], v7 offset:4096
    v_mfma_f32_16x16x32_bf16 v[140:143], v[28:31], a[172:175], v[140:143]
    v_mfma_f32_16x16x32_bf16 v[144:147], v[32:35], a[168:171], v[144:147]
    ds_read_b128 v[28:31], v7 offset:5120
    buffer_load_dwordx4 v3, s[28:31], s27 offen offset:3072 lds
    v_mfma_f32_16x16x32_bf16 v[148:151], v[32:35], a[172:175], v[148:151]
    s_waitcnt lgkmcnt(4)
    v_mfma_f32_16x16x32_bf16 v[152:155], v[8:11], a[168:171], v[152:155]
    ds_read_b128 v[32:35], v7 offset:6144
    buffer_load_dword v87, v247, s[28:31], s44 offen offset:1536 sc1
    v_mfma_f32_16x16x32_bf16 v[156:159], v[8:11], a[172:175], v[156:159]
    v_mfma_f32_16x16x32_bf16 v[160:163], v[12:15], a[168:171], v[160:163]
    ds_read_b128 v[8:11], v7 offset:7168
    buffer_load_dwordx4 a[248:251], v3, s[28:31], s52 offen offset:3072 sc1
    v_mfma_f32_16x16x32_bf16 v[164:167], v[12:15], a[172:175], v[164:167]
    s_waitcnt lgkmcnt(4)
    v_mfma_f32_16x16x32_bf16 v[96:99], v[16:19], a[176:179], v[96:99]
    ds_read_b128 v[12:15], v7 offset:8192
    v_mfma_f32_16x16x32_bf16 v[100:103], v[16:19], a[180:183], v[100:103]
    v_mfma_f32_16x16x32_bf16 v[104:107], v[20:23], a[176:179], v[104:107]
    ds_read_b128 v[16:19], v7 offset:9216
    buffer_load_dwordx4 a[252:255], v3, s[28:31], s53 offen offset:3072 sc1
    v_mfma_f32_16x16x32_bf16 v[108:111], v[20:23], a[180:183], v[108:111]
    s_waitcnt lgkmcnt(4)
    v_mfma_f32_16x16x32_bf16 v[112:115], v[24:27], a[176:179], v[112:115]
    ds_read_b128 v[20:23], v7 offset:10240
    v_mfma_f32_16x16x32_bf16 v[116:119], v[24:27], a[180:183], v[116:119]
    v_mfma_f32_16x16x32_bf16 v[120:123], v[28:31], a[176:179], v[120:123]
    ds_read_b128 v[24:27], v7 offset:11264
    s_add_u32 m0, s26, 81920
    v_mfma_f32_16x16x32_bf16 v[124:127], v[28:31], a[180:183], v[124:127]
    s_add_u32 s27, s42, 262144
    s_waitcnt lgkmcnt(4)
    v_mfma_f32_16x16x32_bf16 v[128:131], v[32:35], a[176:179], v[128:131]
    ds_read_b128 v[28:31], v7 offset:12288
    buffer_load_dwordx4 v3, s[28:31], s27 offen offset:0 lds
    v_mfma_f32_16x16x32_bf16 v[132:135], v[32:35], a[180:183], v[132:135]
    v_mfma_f32_16x16x32_bf16 v[136:139], v[8:11], a[176:179], v[136:139]
    ds_read_b128 v[32:35], v7 offset:13312
    buffer_load_dwordx4 v3, s[28:31], s27 offen offset:1024 lds
    v_mfma_f32_16x16x32_bf16 v[140:143], v[8:11], a[180:183], v[140:143]
    s_waitcnt lgkmcnt(4)
    v_mfma_f32_16x16x32_bf16 v[144:147], v[12:15], a[176:179], v[144:147]
    ds_read_b128 v[8:11], v7 offset:14336
    v_mfma_f32_16x16x32_bf16 v[148:151], v[12:15], a[180:183], v[148:151]
    v_mfma_f32_16x16x32_bf16 v[152:155], v[16:19], a[176:179], v[152:155]
    ds_read_b128 v[12:15], v7 offset:15360
    buffer_load_dwordx4 v3, s[28:31], s27 offen offset:2048 lds
    v_mfma_f32_16x16x32_bf16 v[156:159], v[16:19], a[180:183], v[156:159]
    s_waitcnt lgkmcnt(4)
    v_mfma_f32_16x16x32_bf16 v[160:163], v[20:23], a[176:179], v[160:163]
    ds_read_b128 v[16:19], v3 offset:0
    v_mfma_f32_16x16x32_bf16 v[164:167], v[20:23], a[180:183], v[164:167]
    v_mfma_f32_16x16x32_bf16 v[96:99], v[24:27], a[184:187], v[96:99]
    ds_read_b128 v[20:23], v3 offset:1024
    buffer_load_dwordx4 v3, s[28:31], s27 offen offset:3072 lds
    v_mfma_f32_16x16x32_bf16 v[100:103], v[24:27], a[188:191], v[100:103]
    s_waitcnt lgkmcnt(4)
    v_mfma_f32_16x16x32_bf16 v[104:107], v[28:31], a[184:187], v[104:107]
    ds_read_b128 v[24:27], v3 offset:2048
    v_mfma_f32_16x16x32_bf16 v[108:111], v[28:31], a[188:191], v[108:111]
    v_mfma_f32_16x16x32_bf16 v[112:115], v[32:35], a[184:187], v[112:115]
    ds_read_b128 v[28:31], v3 offset:3072
    s_add_u32 m0, s26, 98304
    v_mfma_f32_16x16x32_bf16 v[116:119], v[32:35], a[188:191], v[116:119]
    s_add_u32 s27, s42, 278528
    s_waitcnt lgkmcnt(4)
    v_mfma_f32_16x16x32_bf16 v[120:123], v[8:11], a[184:187], v[120:123]
    ds_read_b128 v[32:35], v3 offset:4096
    buffer_load_dwordx4 v3, s[28:31], s27 offen offset:0 lds
    v_mfma_f32_16x16x32_bf16 v[124:127], v[8:11], a[188:191], v[124:127]
    v_mfma_f32_16x16x32_bf16 v[128:131], v[12:15], a[184:187], v[128:131]
    ds_read_b128 v[8:11], v3 offset:5120
    buffer_load_dwordx4 v3, s[28:31], s27 offen offset:1024 lds
    v_mfma_f32_16x16x32_bf16 v[132:135], v[12:15], a[188:191], v[132:135]
    s_waitcnt lgkmcnt(4)
    v_mfma_f32_16x16x32_bf16 v[136:139], v[16:19], a[184:187], v[136:139]
    ds_read_b128 v[12:15], v3 offset:6144
    v_mfma_f32_16x16x32_bf16 v[140:143], v[16:19], a[188:191], v[140:143]
    v_mfma_f32_16x16x32_bf16 v[144:147], v[20:23], a[184:187], v[144:147]
    ds_read_b128 v[16:19], v3 offset:7168
    buffer_load_dwordx4 v3, s[28:31], s27 offen offset:2048 lds
    v_mfma_f32_16x16x32_bf16 v[148:151], v[20:23], a[188:191], v[148:151]
    s_waitcnt lgkmcnt(4)
    v_mfma_f32_16x16x32_bf16 v[152:155], v[24:27], a[184:187], v[152:155]
    ds_read_b128 v[20:23], v3 offset:8192
    v_mfma_f32_16x16x32_bf16 v[156:159], v[24:27], a[188:191], v[156:159]
    v_mfma_f32_16x16x32_bf16 v[160:163], v[28:31], a[184:187], v[160:163]
    ds_read_b128 v[24:27], v3 offset:9216
    buffer_load_dwordx4 v3, s[28:31], s27 offen offset:3072 lds
    v_mfma_f32_16x16x32_bf16 v[164:167], v[28:31], a[188:191], v[164:167]
    s_waitcnt vmcnt(31) lgkmcnt(4)
    v_mfma_f32_16x16x32_bf16 v[96:99], v[32:35], a[192:195], v[96:99]
    ds_read_b128 v[28:31], v3 offset:10240
    v_mfma_f32_16x16x32_bf16 v[100:103], v[32:35], a[196:199], v[100:103]
    v_mfma_f32_16x16x32_bf16 v[104:107], v[8:11], a[192:195], v[104:107]
    ds_read_b128 v[32:35], v3 offset:11264
    v_mfma_f32_16x16x32_bf16 v[108:111], v[8:11], a[196:199], v[108:111]
    s_waitcnt lgkmcnt(4)
    v_mfma_f32_16x16x32_bf16 v[112:115], v[12:15], a[192:195], v[112:115]
    ds_read_b128 v[8:11], v3 offset:12288
    v_mfma_f32_16x16x32_bf16 v[116:119], v[12:15], a[196:199], v[116:119]
    v_mfma_f32_16x16x32_bf16 v[120:123], v[16:19], a[192:195], v[120:123]
    ds_read_b128 v[12:15], v3 offset:13312
    v_mfma_f32_16x16x32_bf16 v[124:127], v[16:19], a[196:199], v[124:127]
    s_waitcnt lgkmcnt(4)
    v_mfma_f32_16x16x32_bf16 v[128:131], v[20:23], a[192:195], v[128:131]
    ds_read_b128 v[16:19], v3 offset:14336
    v_mfma_f32_16x16x32_bf16 v[132:135], v[20:23], a[196:199], v[132:135]
    v_mfma_f32_16x16x32_bf16 v[136:139], v[24:27], a[192:195], v[136:139]
    ds_read_b128 v[20:23], v3 offset:15360
    v_mfma_f32_16x16x32_bf16 v[140:143], v[24:27], a[196:199], v[140:143]
    s_barrier
    s_waitcnt lgkmcnt(4)
    v_mfma_f32_16x16x32_bf16 v[144:147], v[28:31], a[192:195], v[144:147]
    ds_read_b128 v[24:27], v3 offset:16384
    s_add_u32 m0, s26, 114688
    v_mfma_f32_16x16x32_bf16 v[148:151], v[28:31], a[196:199], v[148:151]
    s_add_u32 s27, s42, 294912
    buffer_load_dwordx4 v3, s[28:31], s27 offen offset:0 lds
    v_mfma_f32_16x16x32_bf16 v[152:155], v[32:35], a[192:195], v[152:155]
    ds_read_b128 v[28:31], v3 offset:17408
    buffer_load_dwordx4 v3, s[28:31], s27 offen offset:1024 lds
    v_mfma_f32_16x16x32_bf16 v[156:159], v[32:35], a[196:199], v[156:159]
    s_waitcnt lgkmcnt(4)
    v_mfma_f32_16x16x32_bf16 v[160:163], v[8:11], a[192:195], v[160:163]
    ds_read_b128 v[32:35], v3 offset:18432
    buffer_load_dwordx4 v3, s[28:31], s27 offen offset:2048 lds
    v_mfma_f32_16x16x32_bf16 v[164:167], v[8:11], a[196:199], v[164:167]
    s_waitcnt vmcnt(32)
    v_mfma_f32_16x16x32_bf16 v[96:99], v[12:15], a[200:203], v[96:99]
    ds_read_b128 v[8:11], v3 offset:19456
    v_mfma_f32_16x16x32_bf16 v[100:103], v[12:15], a[204:207], v[100:103]
    s_waitcnt vmcnt(13)
    v_cmp_ne_u32 vcc, 0, v87
    s_nop 0
    s_cmp_eq_u64 vcc, -1
    s_cbranch_scc0 k8_kernel_slow17
k8_kernel_back18:
    s_waitcnt lgkmcnt(4)
    v_mfma_f32_16x16x32_bf16 v[104:107], v[16:19], a[200:203], v[104:107]
    ds_read_b128 v[12:15], v3 offset:20480
    buffer_load_dwordx4 v3, s[28:31], s27 offen offset:3072 lds
    v_mfma_f32_16x16x32_bf16 v[108:111], v[16:19], a[204:207], v[108:111]
    v_mfma_f32_16x16x32_bf16 v[112:115], v[20:23], a[200:203], v[112:115]
    ds_read_b128 v[16:19], v3 offset:21504
    v_mfma_f32_16x16x32_bf16 v[116:119], v[20:23], a[204:207], v[116:119]
    s_waitcnt lgkmcnt(4)
    v_mfma_f32_16x16x32_bf16 v[120:123], v[24:27], a[200:203], v[120:123]
    ds_read_b128 v[20:23], v3 offset:22528
    s_add_u32 s52, s52, 4096
    v_mfma_f32_16x16x32_bf16 v[124:127], v[24:27], a[204:207], v[124:127]
    buffer_load_dwordx4 a[144:147], v3, s[28:31], s52 offen offset:0 sc1
    v_mfma_f32_16x16x32_bf16 v[128:131], v[28:31], a[200:203], v[128:131]
    ds_read_b128 v[24:27], v3 offset:23552
    v_mfma_f32_16x16x32_bf16 v[132:135], v[28:31], a[204:207], v[132:135]
    s_waitcnt lgkmcnt(4)
    v_mfma_f32_16x16x32_bf16 v[136:139], v[32:35], a[200:203], v[136:139]
    ds_read_b128 v[28:31], v3 offset:24576
    s_add_u32 s53, s53, 4096
    v_mfma_f32_16x16x32_bf16 v[140:143], v[32:35], a[204:207], v[140:143]
    buffer_load_dwordx4 a[148:151], v3, s[28:31], s53 offen offset:0 sc1
    v_mfma_f32_16x16x32_bf16 v[144:147], v[8:11], a[200:203], v[144:147]
    ds_read_b128 v[32:35], v3 offset:25600
    v_mfma_f32_16x16x32_bf16 v[148:151], v[8:11], a[204:207], v[148:151]
    s_waitcnt lgkmcnt(4)
    v_mfma_f32_16x16x32_bf16 v[152:155], v[12:15], a[200:203], v[152:155]
    ds_read_b128 v[8:11], v3 offset:26624
    buffer_load_dwordx4 a[152:155], v3, s[28:31], s52 offen offset:1024 sc1
    v_mfma_f32_16x16x32_bf16 v[156:159], v[12:15], a[204:207], v[156:159]
    v_mfma_f32_16x16x32_bf16 v[160:163], v[16:19], a[200:203], v[160:163]
    ds_read_b128 v[12:15], v3 offset:27648
    v_mfma_f32_16x16x32_bf16 v[164:167], v[16:19], a[204:207], v[164:167]
    s_waitcnt lgkmcnt(4)
    v_mfma_f32_16x16x32_bf16 v[96:99], v[20:23], a[208:211], v[96:99]
    ds_read_b128 v[16:19], v3 offset:28672
    buffer_load_dwordx4 a[156:159], v3, s[28:31], s53 offen offset:1024 sc1
    v_mfma_f32_16x16x32_bf16 v[100:103], v[20:23], a[212:215], v[100:103]
    v_mfma_f32_16x16x32_bf16 v[104:107], v[24:27], a[208:211], v[104:107]
    ds_read_b128 v[20:23], v3 offset:29696
    v_mfma_f32_16x16x32_bf16 v[108:111], v[24:27], a[212:215], v[108:111]
    s_waitcnt lgkmcnt(4)
    v_mfma_f32_16x16x32_bf16 v[112:115], v[28:31], a[208:211], v[112:115]
    ds_read_b128 v[24:27], v3 offset:30720
    buffer_load_dwordx4 a[160:163], v3, s[28:31], s52 offen offset:2048 sc1
    v_mfma_f32_16x16x32_bf16 v[116:119], v[28:31], a[212:215], v[116:119]
    v_mfma_f32_16x16x32_bf16 v[120:123], v[32:35], a[208:211], v[120:123]
    ds_read_b128 v[28:31], v3 offset:31744
    v_mfma_f32_16x16x32_bf16 v[124:127], v[32:35], a[212:215], v[124:127]
    s_waitcnt lgkmcnt(4)
    v_mfma_f32_16x16x32_bf16 v[128:131], v[8:11], a[208:211], v[128:131]
    ds_read_b128 v[32:35], v3 offset:32768
    buffer_load_dwordx4 a[164:167], v3, s[28:31], s53 offen offset:2048 sc1
    v_mfma_f32_16x16x32_bf16 v[132:135], v[8:11], a[212:215], v[132:135]
    v_mfma_f32_16x16x32_bf16 v[136:139], v[12:15], a[208:211], v[136:139]
    ds_read_b128 v[8:11], v3 offset:33792
    v_mfma_f32_16x16x32_bf16 v[140:143], v[12:15], a[212:215], v[140:143]
    s_waitcnt lgkmcnt(4)
    v_mfma_f32_16x16x32_bf16 v[144:147], v[16:19], a[208:211], v[144:147]
    ds_read_b128 v[12:15], v3 offset:34816
    buffer_load_dwordx4 a[168:171], v3, s[28:31], s52 offen offset:3072 sc1
    v_mfma_f32_16x16x32_bf16 v[148:151], v[16:19], a[212:215], v[148:151]
    v_mfma_f32_16x16x32_bf16 v[152:155], v[20:23], a[208:211], v[152:155]
    ds_read_b128 v[16:19], v3 offset:35840
    v_mfma_f32_16x16x32_bf16 v[156:159], v[20:23], a[212:215], v[156:159]
    s_waitcnt lgkmcnt(4)
    v_mfma_f32_16x16x32_bf16 v[160:163], v[24:27], a[208:211], v[160:163]
    ds_read_b128 v[20:23], v3 offset:36864
    buffer_load_dwordx4 a[172:175], v3, s[28:31], s53 offen offset:3072 sc1
    v_mfma_f32_16x16x32_bf16 v[164:167], v[24:27], a[212:215], v[164:167]
    v_mfma_f32_16x16x32_bf16 v[96:99], v[28:31], a[216:219], v[96:99]
    ds_read_b128 v[24:27], v3 offset:37888
    v_mfma_f32_16x16x32_bf16 v[100:103], v[28:31], a[220:223], v[100:103]
    s_waitcnt lgkmcnt(4)
    v_mfma_f32_16x16x32_bf16 v[104:107], v[32:35], a[216:219], v[104:107]
    ds_read_b128 v[28:31], v3 offset:38912
    s_add_u32 s52, s52, 4096
    v_mfma_f32_16x16x32_bf16 v[108:111], v[32:35], a[220:223], v[108:111]
    buffer_load_dwordx4 a[176:179], v3, s[28:31], s52 offen offset:0 sc1
    v_mfma_f32_16x16x32_bf16 v[112:115], v[8:11], a[216:219], v[112:115]
    ds_read_b128 v[32:35], v3 offset:39936
    v_mfma_f32_16x16x32_bf16 v[116:119], v[8:11], a[220:223], v[116:119]
    s_waitcnt lgkmcnt(4)
    v_mfma_f32_16x16x32_bf16 v[120:123], v[12:15], a[216:219], v[120:123]
    ds_read_b128 v[8:11], v3 offset:40960
    s_add_u32 s53, s53, 4096
    v_mfma_f32_16x16x32_bf16 v[124:127], v[12:15], a[220:223], v[124:127]
    buffer_load_dwordx4 a[180:183], v3, s[28:31], s53 offen offset:0 sc1
    buffer_load_dwordx4 a[184:187], v3, s[28:31], s52 offen offset:1024 sc1
    v_mfma_f32_16x16x32_bf16 v[128:131], v[16:19], a[216:219], v[128:131]
    ds_read_b128 v[12:15], v3 offset:41984
    v_mfma_f32_16x16x32_bf16 v[132:135], v[16:19], a[220:223], v[132:135]
    s_waitcnt lgkmcnt(4)
    v_mfma_f32_16x16x32_bf16 v[136:139], v[20:23], a[216:219], v[136:139]
    ds_read_b128 v[16:19], v3 offset:43008
    buffer_load_dwordx4 a[188:191], v3, s[28:31], s53 offen offset:1024 sc1
    v_mfma_f32_16x16x32_bf16 v[140:143], v[20:23], a[220:223], v[140:143]
    buffer_load_dwordx4 a[192:195], v3, s[28:31], s52 offen offset:2048 sc1
    v_mfma_f32_16x16x32_bf16 v[144:147], v[24:27], a[216:219], v[144:147]
    ds_read_b128 v[20:23], v3 offset:44032
    v_mfma_f32_16x16x32_bf16 v[148:151], v[24:27], a[220:223], v[148:151]
    s_waitcnt lgkmcnt(4)
    v_mfma_f32_16x16x32_bf16 v[152:155], v[28:31], a[216:219], v[152:155]
    ds_read_b128 v[24:27], v3 offset:45056
    buffer_load_dwordx4 a[196:199], v3, s[28:31], s53 offen offset:2048 sc1
    v_mfma_f32_16x16x32_bf16 v[156:159], v[28:31], a[220:223], v[156:159]
    buffer_load_dwordx4 a[200:203], v3, s[28:31], s52 offen offset:3072 sc1
    v_mfma_f32_16x16x32_bf16 v[160:163], v[32:35], a[216:219], v[160:163]
    ds_read_b128 v[28:31], v3 offset:46080
    v_mfma_f32_16x16x32_bf16 v[164:167], v[32:35], a[220:223], v[164:167]
    buffer_load_dwordx4 a[204:207], v3, s[28:31], s53 offen offset:3072 sc1
    s_waitcnt lgkmcnt(4)
    v_mfma_f32_16x16x32_bf16 v[96:99], v[8:11], a[224:227], v[96:99]
    ds_read_b128 v[32:35], v3 offset:47104
    s_add_u32 m0, s26, 131072
    v_mfma_f32_16x16x32_bf16 v[100:103], v[8:11], a[228:231], v[100:103]
    s_add_u32 s27, s42, 311296
    buffer_load_dwordx4 v3, s[28:31], s27 offen offset:0 lds
    v_mfma_f32_16x16x32_bf16 v[104:107], v[12:15], a[224:227], v[104:107]
    ds_read_b128 v[8:11], v3 offset:48128
    v_mfma_f32_16x16x32_bf16 v[108:111], v[12:15], a[228:231], v[108:111]
    s_barrier
    s_waitcnt lgkmcnt(4)
    v_mfma_f32_16x16x32_bf16 v[112:115], v[16:19], a[224:227], v[112:115]
    ds_read_b128 v[12:15], v3 offset:49152
    buffer_load_dwordx4 v3, s[28:31], s27 offen offset:1024 lds
    v_mfma_f32_16x16x32_bf16 v[116:119], v[16:19], a[228:231], v[116:119]
    v_mfma_f32_16x16x32_bf16 v[120:123], v[20:23], a[224:227], v[120:123]
    ds_read_b128 v[16:19], v3 offset:50176
    v_mfma_f32_16x16x32_bf16 v[124:127], v[20:23], a[228:231], v[124:127]
    s_waitcnt lgkmcnt(4)
    v_mfma_f32_16x16x32_bf16 v[128:131], v[24:27], a[224:227], v[128:131]
    ds_read_b128 v[20:23], v3 offset:51200
    buffer_load_dwordx4 v3, s[28:31], s27 offen offset:2048 lds
    v_mfma_f32_16x16x32_bf16 v[132:135], v[24:27], a[228:231], v[132:135]
    v_mfma_f32_16x16x32_bf16 v[136:139], v[28:31], a[224:227], v[136:139]
    ds_read_b128 v[24:27], v3 offset:52224
    v_mfma_f32_16x16x32_bf16 v[140:143], v[28:31], a[228:231], v[140:143]
    s_waitcnt lgkmcnt(4)
    v_mfma_f32_16x16x32_bf16 v[144:147], v[32:35], a[224:227], v[144:147]
    ds_read_b128 v[28:31], v3 offset:53248
    buffer_load_dwordx4 v3, s[28:31], s27 offen offset:3072 lds
    v_mfma_f32_16x16x32_bf16 v[148:151], v[32:35], a[228:231], v[148:151]
    v_mfma_f32_16x16x32_bf16 v[152:155], v[8:11], a[224:227], v[152:155]
    ds_read_b128 v[32:35], v3 offset:54272
    v_mfma_f32_16x16x32_bf16 v[156:159], v[8:11], a[228:231], v[156:159]
    s_waitcnt lgkmcnt(4)
    v_mfma_f32_16x16x32_bf16 v[160:163], v[12:15], a[224:227], v[160:163]
    ds_read_b128 v[8:11], v3 offset:55296
    s_add_u32 m0, s26, 0
    v_mfma_f32_16x16x32_bf16 v[164:167], v[12:15], a[228:231], v[164:167]
    s_add_u32 s27, s42, 327680
    buffer_load_dwordx4 v3, s[28:31], s27 offen offset:0 lds
    v_mfma_f32_16x16x32_bf16 v[96:99], v[16:19], a[232:235], v[96:99]
    ds_read_b128 v[12:15], v3 offset:56320
    v_mfma_f32_16x16x32_bf16 v[100:103], v[16:19], a[236:239], v[100:103]
    s_waitcnt lgkmcnt(4)
    v_mfma_f32_16x16x32_bf16 v[104:107], v[20:23], a[232:235], v[104:107]
    ds_read_b128 v[16:19], v3 offset:57344
    buffer_load_dwordx4 v3, s[28:31], s27 offen offset:1024 lds
    v_mfma_f32_16x16x32_bf16 v[108:111], v[20:23], a[236:239], v[108:111]
    v_mfma_f32_16x16x32_bf16 v[112:115], v[24:27], a[232:235], v[112:115]
    ds_read_b128 v[20:23], v3 offset:58368
    v_mfma_f32_16x16x32_bf16 v[116:119], v[24:27], a[236:239], v[116:119]
    s_waitcnt lgkmcnt(4)
    v_mfma_f32_16x16x32_bf16 v[120:123], v[28:31], a[232:235], v[120:123]
    ds_read_b128 v[24:27], v3 offset:59392
    buffer_load_dwordx4 v3, s[28:31], s27 offen offset:2048 lds
    v_mfma_f32_16x16x32_bf16 v[124:127], v[28:31], a[236:239], v[124:127]
    v_mfma_f32_16x16x32_bf16 v[128:131], v[32:35], a[232:235], v[128:131]
    ds_read_b128 v[28:31], v3 offset:60416
    v_mfma_f32_16x16x32_bf16 v[132:135], v[32:35], a[236:239], v[132:135]
    s_waitcnt lgkmcnt(4)
    v_mfma_f32_16x16x32_bf16 v[136:139], v[8:11], a[232:235], v[136:139]
    ds_read_b128 v[32:35], v3 offset:61440
    buffer_load_dwordx4 v3, s[28:31], s27 offen offset:3072 lds
    v_mfma_f32_16x16x32_bf16 v[140:143], v[8:11], a[236:239], v[140:143]
    v_mfma_f32_16x16x32_bf16 v[144:147], v[12:15], a[232:235], v[144:147]
    ds_read_b128 v[8:11], v3 offset:62464
    v_mfma_f32_16x16x32_bf16 v[148:151], v[12:15], a[236:239], v[148:151]
    s_waitcnt lgkmcnt(4)
    v_mfma_f32_16x16x32_bf16 v[152:155], v[16:19], a[232:235], v[152:155]
    ds_read_b128 v[12:15], v3 offset:63488
    v_mfma_f32_16x16x32_bf16 v[156:159], v[16:19], a[236:239], v[156:159]
    v_mfma_f32_16x16x32_bf16 v[160:163], v[20:23], a[232:235], v[160:163]
    ds_read_b128 v[16:19], v3 offset:64512
    v_mfma_f32_16x16x32_bf16 v[164:167], v[20:23], a[236:239], v[164:167]
    s_waitcnt lgkmcnt(4)
    v_mfma_f32_16x16x32_bf16 v[96:99], v[24:27], a[240:243], v[96:99]
    ds_read_b128 v[20:23], v6 offset:0
    v_mfma_f32_16x16x32_bf16 v[100:103], v[24:27], a[244:247], v[100:103]
    v_mfma_f32_16x16x32_bf16 v[104:107], v[28:31], a[240:243], v[104:107]
    ds_read_b128 v[24:27], v6 offset:1024
    v_mfma_f32_16x16x32_bf16 v[108:111], v[28:31], a[244:247], v[108:111]
    s_waitcnt lgkmcnt(4)
    v_mfma_f32_16x16x32_bf16 v[112:115], v[32:35], a[240:243], v[112:115]
    ds_read_b128 v[28:31], v6 offset:2048
    v_mfma_f32_16x16x32_bf16 v[116:119], v[32:35], a[244:247], v[116:119]
    v_mfma_f32_16x16x32_bf16 v[120:123], v[8:11], a[240:243], v[120:123]
    ds_read_b128 v[32:35], v6 offset:3072
    v_mfma_f32_16x16x32_bf16 v[124:127], v[8:11], a[244:247], v[124:127]
    s_waitcnt lgkmcnt(4)
    v_mfma_f32_16x16x32_bf16 v[128:131], v[12:15], a[240:243], v[128:131]
    ds_read_b128 v[8:11], v6 offset:4096
    v_mfma_f32_16x16x32_bf16 v[132:135], v[12:15], a[244:247], v[132:135]
    v_mfma_f32_16x16x32_bf16 v[136:139], v[16:19], a[240:243], v[136:139]
    ds_read_b128 v[12:15], v6 offset:5120
    v_mfma_f32_16x16x32_bf16 v[140:143], v[16:19], a[244:247], v[140:143]
    s_waitcnt lgkmcnt(4)
    v_mfma_f32_16x16x32_bf16 v[144:147], v[20:23], a[240:243], v[144:147]
    ds_read_b128 v[16:19], v6 offset:6144
    v_mfma_f32_16x16x32_bf16 v[148:151], v[20:23], a[244:247], v[148:151]
    v_mfma_f32_16x16x32_bf16 v[152:155], v[24:27], a[240:243], v[152:155]
    ds_read_b128 v[20:23], v6 offset:7168
    v_mfma_f32_16x16x32_bf16 v[156:159], v[24:27], a[244:247], v[156:159]
    s_waitcnt lgkmcnt(4)
    v_mfma_f32_16x16x32_bf16 v[160:163], v[28:31], a[240:243], v[160:163]
    ds_read_b128 v[24:27], v6 offset:8192
    v_mfma_f32_16x16x32_bf16 v[164:167], v[28:31], a[244:247], v[164:167]
    s_waitcnt vmcnt(36)
    v_mfma_f32_16x16x32_bf16 v[96:99], v[32:35], a[248:251], v[96:99]
    ds_read_b128 v[28:31], v6 offset:9216
    v_mfma_f32_16x16x32_bf16 v[100:103], v[32:35], a[252:255], v[100:103]
    s_waitcnt lgkmcnt(4)
    v_mfma_f32_16x16x32_bf16 v[104:107], v[8:11], a[248:251], v[104:107]
    ds_read_b128 v[32:35], v6 offset:10240
    v_mfma_f32_16x16x32_bf16 v[108:111], v[8:11], a[252:255], v[108:111]
    v_mfma_f32_16x16x32_bf16 v[112:115], v[12:15], a[248:251], v[112:115]
    ds_read_b128 v[8:11], v6 offset:11264
    v_mfma_f32_16x16x32_bf16 v[116:119], v[12:15], a[252:255], v[116:119]
    s_waitcnt vmcnt(0)
    s_barrier
    s_waitcnt lgkmcnt(4)
    v_mfma_f32_16x16x32_bf16 v[120:123], v[16:19], a[248:251], v[120:123]
    ds_read_b128 v[12:15], v6 offset:12288
    v_mfma_f32_16x16x32_bf16 v[124:127], v[16:19], a[252:255], v[124:127]
    v_mfma_f32_16x16x32_bf16 v[128:131], v[20:23], a[248:251], v[128:131]
    ds_read_b128 v[16:19], v6 offset:13312
    v_mfma_f32_16x16x32_bf16 v[132:135], v[20:23], a[252:255], v[132:135]
    s_waitcnt lgkmcnt(4)
    v_mfma_f32_16x16x32_bf16 v[136:139], v[24:27], a[248:251], v[136:139]
    ds_read_b128 v[20:23], v6 offset:21504
    v_mfma_f32_16x16x32_bf16 v[140:143], v[24:27], a[252:255], v[140:143]
    v_mfma_f32_16x16x32_bf16 v[144:147], v[28:31], a[248:251], v[144:147]
    ds_read_b128 v[24:27], v6 offset:22528
    v_mfma_f32_16x16x32_bf16 v[148:151], v[28:31], a[252:255], v[148:151]
    s_waitcnt lgkmcnt(4)
    v_mfma_f32_16x16x32_bf16 v[152:155], v[32:35], a[248:251], v[152:155]
    ds_read_b128 v[28:31], v6 offset:30720
    v_mfma_f32_16x16x32_bf16 v[156:159], v[32:35], a[252:255], v[156:159]
    v_mfma_f32_16x16x32_bf16 v[160:163], v[8:11], a[248:251], v[160:163]
    ds_read_b128 v[32:35], v6 offset:31744
    v_mfma_f32_16x16x32_bf16 v[164:167], v[8:11], a[252:255], v[164:167]
    s_waitcnt lgkmcnt(4)
    v_mfma_f32_16x16x32_bf16 v[96:99], v[12:15], a[144:147], v[96:99]
    ds_read_b128 v[8:11], v6 offset:39936
    v_mfma_f32_16x16x32_bf16 v[100:103], v[12:15], a[148:151], v[100:103]
    v_mfma_f32_16x16x32_bf16 v[104:107], v[16:19], a[144:147], v[104:107]
    ds_read_b128 v[12:15], v6 offset:40960
    v_mfma_f32_16x16x32_bf16 v[108:111], v[16:19], a[148:151], v[108:111]
    s_waitcnt lgkmcnt(4)
    v_mfma_f32_16x16x32_bf16 v[96:99], v[20:23], a[152:155], v[96:99]
    ds_read_b128 v[16:19], v6 offset:49152
    v_mfma_f32_16x16x32_bf16 v[100:103], v[20:23], a[156:159], v[100:103]
    v_mfma_f32_16x16x32_bf16 v[104:107], v[24:27], a[152:155], v[104:107]
    ds_read_b128 v[20:23], v6 offset:50176
    v_mfma_f32_16x16x32_bf16 v[108:111], v[24:27], a[156:159], v[108:111]
    s_waitcnt lgkmcnt(4)
    v_mfma_f32_16x16x32_bf16 v[96:99], v[28:31], a[160:163], v[96:99]
    ds_read_b128 v[24:27], v6 offset:58368
    v_mfma_f32_16x16x32_bf16 v[100:103], v[28:31], a[164:167], v[100:103]
    v_mfma_f32_16x16x32_bf16 v[104:107], v[32:35], a[160:163], v[104:107]
    ds_read_b128 v[28:31], v6 offset:59392
    v_mfma_f32_16x16x32_bf16 v[108:111], v[32:35], a[164:167], v[108:111]
    s_waitcnt lgkmcnt(4)
    v_mfma_f32_16x16x32_bf16 v[96:99], v[8:11], a[168:171], v[96:99]
    ds_read_b128 v[32:35], v7 offset:2048
    v_mfma_f32_16x16x32_bf16 v[100:103], v[8:11], a[172:175], v[100:103]
    v_mfma_f32_16x16x32_bf16 v[104:107], v[12:15], a[168:171], v[104:107]
    ds_read_b128 v[8:11], v7 offset:3072
    v_mfma_f32_16x16x32_bf16 v[108:111], v[12:15], a[172:175], v[108:111]
    s_waitcnt lgkmcnt(4)
    v_mfma_f32_16x16x32_bf16 v[96:99], v[16:19], a[176:179], v[96:99]
    ds_read_b128 v[12:15], v7 offset:11264
    v_mfma_f32_16x16x32_bf16 v[100:103], v[16:19], a[180:183], v[100:103]
    v_mfma_f32_16x16x32_bf16 v[104:107], v[20:23], a[176:179], v[104:107]
    ds_read_b128 v[16:19], v7 offset:12288
    v_mfma_f32_16x16x32_bf16 v[108:111], v[20:23], a[180:183], v[108:111]
    s_waitcnt lgkmcnt(4)
    v_mfma_f32_16x16x32_bf16 v[96:99], v[24:27], a[184:187], v[96:99]
    ds_read_b128 v[20:23], v6 offset:14336
    v_mfma_f32_16x16x32_bf16 v[100:103], v[24:27], a[188:191], v[100:103]
    v_mfma_f32_16x16x32_bf16 v[104:107], v[28:31], a[184:187], v[104:107]
    ds_read_b128 v[24:27], v6 offset:15360
    v_mfma_f32_16x16x32_bf16 v[108:111], v[28:31], a[188:191], v[108:111]
    s_waitcnt lgkmcnt(4)
    v_mfma_f32_16x16x32_bf16 v[96:99], v[32:35], a[192:195], v[96:99]
    ds_read_b128 v[28:31], v6 offset:23552
    v_mfma_f32_16x16x32_bf16 v[100:103], v[32:35], a[196:199], v[100:103]
    v_mfma_f32_16x16x32_bf16 v[104:107], v[8:11], a[192:195], v[104:107]
    ds_read_b128 v[32:35], v6 offset:24576
    v_mfma_f32_16x16x32_bf16 v[108:111], v[8:11], a[196:199], v[108:111]
    s_waitcnt lgkmcnt(4)
    v_mfma_f32_16x16x32_bf16 v[96:99], v[12:15], a[200:203], v[96:99]
    ds_read_b128 v[8:11], v6 offset:32768
    v_mfma_f32_16x16x32_bf16 v[100:103], v[12:15], a[204:207], v[100:103]
    v_mfma_f32_16x16x32_bf16 v[104:107], v[16:19], a[200:203], v[104:107]
    ds_read_b128 v[12:15], v6 offset:33792
    v_mfma_f32_16x16x32_bf16 v[108:111], v[16:19], a[204:207], v[108:111]
    s_waitcnt lgkmcnt(4)
    v_mfma_f32_16x16x32_bf16 v[112:115], v[20:23], a[144:147], v[112:115]
    ds_read_b128 v[16:19], v6 offset:41984
    v_mfma_f32_16x16x32_bf16 v[116:119], v[20:23], a[148:151], v[116:119]
    v_mfma_f32_16x16x32_bf16 v[120:123], v[24:27], a[144:147], v[120:123]
    ds_read_b128 v[20:23], v6 offset:43008
    v_mfma_f32_16x16x32_bf16 v[124:127], v[24:27], a[148:151], v[124:127]
    s_waitcnt lgkmcnt(4)
    v_mfma_f32_16x16x32_bf16 v[112:115], v[28:31], a[152:155], v[112:115]
    ds_read_b128 v[24:27], v6 offset:51200
    s_lshl_b32 s54, s19, 6
    v_mfma_f32_16x16x32_bf16 v[116:119], v[28:31], a[156:159], v[116:119]
    s_add_u32 s54, s54, s23
    v_mfma_f32_16x16x32_bf16 v[120:123], v[32:35], a[152:155], v[120:123]
    ds_read_b128 v[28:31], v6 offset:52224
    s_mul_i32 s54, s54, 36864
    v_mfma_f32_16x16x32_bf16 v[124:127], v[32:35], a[156:159], v[124:127]
    s_mul_i32 s49, s20, 4608
    s_waitcnt lgkmcnt(4)
    v_mfma_f32_16x16x32_bf16 v[112:115], v[8:11], a[160:163], v[112:115]
    ds_read_b128 v[32:35], v6 offset:60416
    s_add_u32 s48, s54, s49
    v_mfma_f32_16x16x32_bf16 v[116:119], v[8:11], a[164:167], v[116:119]
    s_add_u32 s48, s48, 44150784
    s_add_u32 s49, s48, 18432
    v_mfma_f32_16x16x32_bf16 v[120:123], v[12:15], a[160:163], v[120:123]
    ds_read_b128 v[8:11], v6 offset:61440
    s_add_u32 s50, s48, 4096
    v_mfma_f32_16x16x32_bf16 v[124:127], v[12:15], a[164:167], v[124:127]
    s_add_u32 s51, s49, 4096
    s_waitcnt lgkmcnt(4)
    v_mfma_f32_16x16x32_bf16 v[112:115], v[16:19], a[168:171], v[112:115]
    ds_read_b128 v[12:15], v7 offset:4096
    v_cvt_pk_bf16_f32 v36, v96, v97
    v_mfma_f32_16x16x32_bf16 v[116:119], v[16:19], a[172:175], v[116:119]
    v_cvt_pk_bf16_f32 v37, v98, v99
    v_cvt_pk_bf16_f32 v38, v104, v105
    v_mfma_f32_16x16x32_bf16 v[120:123], v[20:23], a[168:171], v[120:123]
    ds_read_b128 v[16:19], v7 offset:5120
    v_cvt_pk_bf16_f32 v39, v106, v107
    v_mfma_f32_16x16x32_bf16 v[124:127], v[20:23], a[172:175], v[124:127]
    buffer_store_dwordx4 v[36:39], v3, s[28:31], s48 offen offset:0 sc1
    s_waitcnt lgkmcnt(4)
    v_mfma_f32_16x16x32_bf16 v[112:115], v[24:27], a[176:179], v[112:115]
    ds_read_b128 v[20:23], v7 offset:13312
    v_cvt_pk_bf16_f32 v40, v100, v101
    v_mfma_f32_16x16x32_bf16 v[116:119], v[24:27], a[180:183], v[116:119]
    v_cvt_pk_bf16_f32 v41, v102, v103
    v_cvt_pk_bf16_f32 v42, v108, v109
    v_mfma_f32_16x16x32_bf16 v[120:123], v[28:31], a[176:179], v[120:123]
    ds_read_b128 v[24:27], v7 offset:14336
    v_cvt_pk_bf16_f32 v43, v110, v111
    v_mfma_f32_16x16x32_bf16 v[124:127], v[28:31], a[180:183], v[124:127]
    buffer_store_dwordx4 v[40:43], v3, s[28:31], s49 offen offset:0 sc1
    s_waitcnt lgkmcnt(4)
    v_mfma_f32_16x16x32_bf16 v[112:115], v[32:35], a[184:187], v[112:115]
    ds_read_b128 v[28:31], v6 offset:16384
    v_mfma_f32_16x16x32_bf16 v[116:119], v[32:35], a[188:191], v[116:119]
    v_mfma_f32_16x16x32_bf16 v[120:123], v[8:11], a[184:187], v[120:123]
    ds_read_b128 v[32:35], v6 offset:17408
    v_mfma_f32_16x16x32_bf16 v[124:127], v[8:11], a[188:191], v[124:127]
    s_waitcnt lgkmcnt(4)
    v_mfma_f32_16x16x32_bf16 v[112:115], v[12:15], a[192:195], v[112:115]
    ds_read_b128 v[8:11], v6 offset:25600
    v_mfma_f32_16x16x32_bf16 v[116:119], v[12:15], a[196:199], v[116:119]
    v_mfma_f32_16x16x32_bf16 v[120:123], v[16:19], a[192:195], v[120:123]
    ds_read_b128 v[12:15], v6 offset:26624
    v_mfma_f32_16x16x32_bf16 v[124:127], v[16:19], a[196:199], v[124:127]
    s_waitcnt lgkmcnt(4)
    v_mfma_f32_16x16x32_bf16 v[112:115], v[20:23], a[200:203], v[112:115]
    ds_read_b128 v[16:19], v6 offset:34816
    v_mfma_f32_16x16x32_bf16 v[116:119], v[20:23], a[204:207], v[116:119]
    v_mfma_f32_16x16x32_bf16 v[120:123], v[24:27], a[200:203], v[120:123]
    ds_read_b128 v[20:23], v6 offset:35840
    v_mfma_f32_16x16x32_bf16 v[124:127], v[24:27], a[204:207], v[124:127]
    s_waitcnt lgkmcnt(4)
    v_mfma_f32_16x16x32_bf16 v[128:131], v[28:31], a[144:147], v[128:131]
    ds_read_b128 v[24:27], v6 offset:44032
    v_mfma_f32_16x16x32_bf16 v[132:135], v[28:31], a[148:151], v[132:135]
    v_mfma_f32_16x16x32_bf16 v[136:139], v[32:35], a[144:147], v[136:139]
    ds_read_b128 v[28:31], v6 offset:45056
    v_mfma_f32_16x16x32_bf16 v[140:143], v[32:35], a[148:151], v[140:143]
    s_waitcnt lgkmcnt(4)
    v_mfma_f32_16x16x32_bf16 v[128:131], v[8:11], a[152:155], v[128:131]
    ds_read_b128 v[32:35], v6 offset:53248
    v_cvt_pk_bf16_f32 v44, v112, v113
    v_mfma_f32_16x16x32_bf16 v[132:135], v[8:11], a[156:159], v[132:135]
    v_cvt_pk_bf16_f32 v45, v114, v115
    v_cvt_pk_bf16_f32 v46, v120, v121
    v_mfma_f32_16x16x32_bf16 v[136:139], v[12:15], a[152:155], v[136:139]
    ds_read_b128 v[8:11], v6 offset:54272
    v_cvt_pk_bf16_f32 v47, v122, v123
    v_mfma_f32_16x16x32_bf16 v[140:143], v[12:15], a[156:159], v[140:143]
    buffer_store_dwordx4 v[44:47], v3, s[28:31], s48 offen offset:1024 sc1
    s_waitcnt lgkmcnt(4)
    v_mfma_f32_16x16x32_bf16 v[128:131], v[16:19], a[160:163], v[128:131]
    ds_read_b128 v[12:15], v6 offset:62464
    v_cvt_pk_bf16_f32 v48, v116, v117
    v_mfma_f32_16x16x32_bf16 v[132:135], v[16:19], a[164:167], v[132:135]
    v_cvt_pk_bf16_f32 v49, v118, v119
    v_cvt_pk_bf16_f32 v50, v124, v125
    v_mfma_f32_16x16x32_bf16 v[136:139], v[20:23], a[160:163], v[136:139]
    ds_read_b128 v[16:19], v6 offset:63488
    v_cvt_pk_bf16_f32 v51, v126, v127
    v_mfma_f32_16x16x32_bf16 v[140:143], v[20:23], a[164:167], v[140:143]
    buffer_store_dwordx4 v[48:51], v3, s[28:31], s49 offen offset:1024 sc1
    s_waitcnt lgkmcnt(4)
    v_mfma_f32_16x16x32_bf16 v[128:131], v[24:27], a[168:171], v[128:131]
    ds_read_b128 v[20:23], v7 offset:6144
    v_mfma_f32_16x16x32_bf16 v[132:135], v[24:27], a[172:175], v[132:135]
    v_mfma_f32_16x16x32_bf16 v[136:139], v[28:31], a[168:171], v[136:139]
    ds_read_b128 v[24:27], v7 offset:7168
    v_mfma_f32_16x16x32_bf16 v[140:143], v[28:31], a[172:175], v[140:143]
    s_waitcnt lgkmcnt(4)
    v_mfma_f32_16x16x32_bf16 v[128:131], v[32:35], a[176:179], v[128:131]
    ds_read_b128 v[28:31], v7 offset:15360
    v_mfma_f32_16x16x32_bf16 v[132:135], v[32:35], a[180:183], v[132:135]
    v_mfma_f32_16x16x32_bf16 v[136:139], v[8:11], a[176:179], v[136:139]
    ds_read_b128 v[32:35], v3 offset:0
    v_mfma_f32_16x16x32_bf16 v[140:143], v[8:11], a[180:183], v[140:143]
    s_waitcnt lgkmcnt(4)
    v_mfma_f32_16x16x32_bf16 v[128:131], v[12:15], a[184:187], v[128:131]
    ds_read_b128 v[8:11], v6 offset:18432
    v_mfma_f32_16x16x32_bf16 v[132:135], v[12:15], a[188:191], v[132:135]
    v_mfma_f32_16x16x32_bf16 v[136:139], v[16:19], a[184:187], v[136:139]
    ds_read_b128 v[12:15], v6 offset:19456
    v_mfma_f32_16x16x32_bf16 v[140:143], v[16:19], a[188:191], v[140:143]
    s_waitcnt lgkmcnt(4)
    v_mfma_f32_16x16x32_bf16 v[128:131], v[20:23], a[192:195], v[128:131]
    ds_read_b128 v[16:19], v6 offset:27648
    v_mfma_f32_16x16x32_bf16 v[132:135], v[20:23], a[196:199], v[132:135]
    v_mfma_f32_16x16x32_bf16 v[136:139], v[24:27], a[192:195], v[136:139]
    ds_read_b128 v[20:23], v6 offset:28672
    v_mfma_f32_16x16x32_bf16 v[140:143], v[24:27], a[196:199], v[140:143]
    s_waitcnt lgkmcnt(4)
    v_mfma_f32_16x16x32_bf16 v[128:131], v[28:31], a[200:203], v[128:131]
    ds_read_b128 v[24:27], v6 offset:36864
    v_mfma_f32_16x16x32_bf16 v[132:135], v[28:31], a[204:207], v[132:135]
    v_mfma_f32_16x16x32_bf16 v[136:139], v[32:35], a[200:203], v[136:139]
    ds_read_b128 v[28:31], v6 offset:37888
    v_mfma_f32_16x16x32_bf16 v[140:143], v[32:35], a[204:207], v[140:143]
    s_waitcnt lgkmcnt(4)
    v_mfma_f32_16x16x32_bf16 v[144:147], v[8:11], a[144:147], v[144:147]
    ds_read_b128 v[32:35], v6 offset:46080
    v_mfma_f32_16x16x32_bf16 v[148:151], v[8:11], a[148:151], v[148:151]
    v_mfma_f32_16x16x32_bf16 v[152:155], v[12:15], a[144:147], v[152:155]
    ds_read_b128 v[8:11], v6 offset:47104
    v_mfma_f32_16x16x32_bf16 v[156:159], v[12:15], a[148:151], v[156:159]
    s_waitcnt lgkmcnt(4)
    v_mfma_f32_16x16x32_bf16 v[144:147], v[16:19], a[152:155], v[144:147]
    ds_read_b128 v[12:15], v6 offset:55296
    v_cvt_pk_bf16_f32 v52, v128, v129
    v_mfma_f32_16x16x32_bf16 v[148:151], v[16:19], a[156:159], v[148:151]
    v_cvt_pk_bf16_f32 v53, v130, v131
    v_cvt_pk_bf16_f32 v54, v136, v137
    v_mfma_f32_16x16x32_bf16 v[152:155], v[20:23], a[152:155], v[152:155]
    ds_read_b128 v[16:19], v6 offset:56320
    v_cvt_pk_bf16_f32 v55, v138, v139
    v_mfma_f32_16x16x32_bf16 v[156:159], v[20:23], a[156:159], v[156:159]
    buffer_store_dwordx4 v[52:55], v3, s[28:31], s48 offen offset:2048 sc1
    s_waitcnt lgkmcnt(4)
    v_mfma_f32_16x16x32_bf16 v[144:147], v[24:27], a[160:163], v[144:147]
    ds_read_b128 v[20:23], v6 offset:64512
    v_cvt_pk_bf16_f32 v56, v132, v133
    v_mfma_f32_16x16x32_bf16 v[148:151], v[24:27], a[164:167], v[148:151]
    v_cvt_pk_bf16_f32 v57, v134, v135
    v_cvt_pk_bf16_f32 v58, v140, v141
    v_mfma_f32_16x16x32_bf16 v[152:155], v[28:31], a[160:163], v[152:155]
    ds_read_b128 v[24:27], v7 offset:0
    v_cvt_pk_bf16_f32 v59, v142, v143
    v_mfma_f32_16x16x32_bf16 v[156:159], v[28:31], a[164:167], v[156:159]
    buffer_store_dwordx4 v[56:59], v3, s[28:31], s49 offen offset:2048 sc1
    s_waitcnt lgkmcnt(4)
    v_mfma_f32_16x16x32_bf16 v[144:147], v[32:35], a[168:171], v[144:147]
    ds_read_b128 v[28:31], v7 offset:8192
    v_mfma_f32_16x16x32_bf16 v[148:151], v[32:35], a[172:175], v[148:151]
    v_mfma_f32_16x16x32_bf16 v[152:155], v[8:11], a[168:171], v[152:155]
    ds_read_b128 v[32:35], v7 offset:9216
    v_mfma_f32_16x16x32_bf16 v[156:159], v[8:11], a[172:175], v[156:159]
    s_waitcnt lgkmcnt(4)
    v_mfma_f32_16x16x32_bf16 v[144:147], v[12:15], a[176:179], v[144:147]
    ds_read_b128 v[8:11], v3 offset:1024
    v_mfma_f32_16x16x32_bf16 v[148:151], v[12:15], a[180:183], v[148:151]
    v_mfma_f32_16x16x32_bf16 v[152:155], v[16:19], a[176:179], v[152:155]
    ds_read_b128 v[12:15], v3 offset:2048
    v_mfma_f32_16x16x32_bf16 v[156:159], v[16:19], a[180:183], v[156:159]
    s_waitcnt lgkmcnt(4)
    v_mfma_f32_16x16x32_bf16 v[144:147], v[20:23], a[184:187], v[144:147]
    ds_read_b128 v[16:19], v6 offset:20480
    v_mfma_f32_16x16x32_bf16 v[148:151], v[20:23], a[188:191], v[148:151]
    v_mfma_f32_16x16x32_bf16 v[152:155], v[24:27], a[184:187], v[152:155]
    ds_read_b128 v[20:23], v6 offset:29696
    v_mfma_f32_16x16x32_bf16 v[156:159], v[24:27], a[188:191], v[156:159]
    s_waitcnt lgkmcnt(4)
    v_mfma_f32_16x16x32_bf16 v[144:147], v[28:31], a[192:195], v[144:147]
    ds_read_b128 v[24:27], v6 offset:38912
    v_mfma_f32_16x16x32_bf16 v[148:151], v[28:31], a[196:199], v[148:151]
    v_mfma_f32_16x16x32_bf16 v[152:155], v[32:35], a[192:195], v[152:155]
    ds_read_b128 v[28:31], v6 offset:48128
    v_mfma_f32_16x16x32_bf16 v[156:159], v[32:35], a[196:199], v[156:159]
    s_waitcnt lgkmcnt(4)
    v_mfma_f32_16x16x32_bf16 v[144:147], v[8:11], a[200:203], v[144:147]
    ds_read_b128 v[32:35], v6 offset:57344
    v_mfma_f32_16x16x32_bf16 v[148:151], v[8:11], a[204:207], v[148:151]
    v_mfma_f32_16x16x32_bf16 v[152:155], v[12:15], a[200:203], v[152:155]
    ds_read_b128 v[8:11], v7 offset:1024
    v_mfma_f32_16x16x32_bf16 v[156:159], v[12:15], a[204:207], v[156:159]
    s_waitcnt lgkmcnt(4)
    v_mfma_f32_16x16x32_bf16 v[160:163], v[16:19], a[144:147], v[160:163]
    ds_read_b128 v[12:15], v7 offset:10240
    v_mfma_f32_16x16x32_bf16 v[164:167], v[16:19], a[148:151], v[164:167]
    v_mfma_f32_16x16x32_bf16 v[160:163], v[20:23], a[152:155], v[160:163]
    ds_read_b128 v[16:19], v3 offset:3072
    v_mfma_f32_16x16x32_bf16 v[164:167], v[20:23], a[156:159], v[164:167]
    s_waitcnt lgkmcnt(4)
    v_mfma_f32_16x16x32_bf16 v[160:163], v[24:27], a[160:163], v[160:163]
    v_cvt_pk_bf16_f32 v60, v144, v145
    v_cvt_pk_bf16_f32 v61, v146, v147
    v_mfma_f32_16x16x32_bf16 v[164:167], v[24:27], a[164:167], v[164:167]
    v_cvt_pk_bf16_f32 v62, v152, v153
    v_mfma_f32_16x16x32_bf16 v[160:163], v[28:31], a[168:171], v[160:163]
    v_cvt_pk_bf16_f32 v63, v154, v155
    buffer_store_dwordx4 v[60:63], v3, s[28:31], s48 offen offset:3072 sc1
    v_mfma_f32_16x16x32_bf16 v[164:167], v[28:31], a[172:175], v[164:167]
    v_cvt_pk_bf16_f32 v64, v148, v149
    s_waitcnt lgkmcnt(2)
    v_mfma_f32_16x16x32_bf16 v[160:163], v[32:35], a[176:179], v[160:163]
    v_cvt_pk_bf16_f32 v65, v150, v151
    v_cvt_pk_bf16_f32 v66, v156, v157
    v_mfma_f32_16x16x32_bf16 v[164:167], v[32:35], a[180:183], v[164:167]
    v_mfma_f32_16x16x32_bf16 v[160:163], v[8:11], a[184:187], v[160:163]
    v_cvt_pk_bf16_f32 v67, v158, v159
    buffer_store_dwordx4 v[64:67], v3, s[28:31], s49 offen offset:3072 sc1
    v_mfma_f32_16x16x32_bf16 v[164:167], v[8:11], a[188:191], v[164:167]
    s_waitcnt lgkmcnt(0)
    v_mfma_f32_16x16x32_bf16 v[160:163], v[12:15], a[192:195], v[160:163]
    v_mfma_f32_16x16x32_bf16 v[164:167], v[12:15], a[196:199], v[164:167]
    v_mfma_f32_16x16x32_bf16 v[160:163], v[16:19], a[200:203], v[160:163]
    v_mfma_f32_16x16x32_bf16 v[164:167], v[16:19], a[204:207], v[164:167]
    s_nop 6
    v_cvt_pk_bf16_f32 v68, v160, v161
    v_cvt_pk_bf16_f32 v69, v162, v163
    buffer_store_dwordx2 v[68:69], v245, s[28:31], s50 offen sc1
    v_cvt_pk_bf16_f32 v70, v164, v165
    v_cvt_pk_bf16_f32 v71, v166, v167
    buffer_store_dwordx2 v[70:71], v245, s[28:31], s51 offen sc1
    s_mov_b32 s36, s6
    s_mov_b32 s37, s7
    s_mov_b32 s38, 2359296
    s_mov_b32 s39, 0x00020000
    s_lshl_b32 s24, s21, 2
    s_add_u32 s24, s24, s19
    s_lshl_b32 s24, s24, 1
    s_lshr_b32 s25, s18, 1
    s_add_u32 s24, s24, s25
    s_mul_i32 s25, s20, 18
    s_and_b32 s27, s18, 1
    s_mul_i32 s27, s27, 9
    s_add_u32 s25, s25, s27
    s_mul_i32 s46, s24, 18432
    s_lshl_b32 s47, s25, 8
    s_add_u32 s46, s46, s47
    s_add_u32 s48, s46, 9940992
    s_add_u32 s46, s46, 44150784
    s_lshl_b32 s47, s25, 4
    s_mul_i32 s49, s24, 18432
    s_add_u32 s49, s49, s47
    s_add_u32 s47, s47, 22144
    v_lshlrev_b32 v60, 4, v5
    v_mul_u32_u24 v61, 1152, v4
    v_add_u32 v61, v61, v60
    buffer_load_dwordx4 v[180:183], v3, s[28:31], s48 offen offset:0 sc1
    buffer_load_dwordx4 v[192:195], v60, s[28:31], s47 offen offset:0
    buffer_load_dwordx4 v[184:187], v3, s[28:31], s48 offen offset:1024 sc1
    buffer_load_dwordx4 v[196:199], v60, s[28:31], s47 offen offset:64
    s_mov_b64 exec, 0xffff
    buffer_load_dwordx4 v[188:191], v3, s[28:31], s48 offen offset:2048 sc1
    buffer_load_dwordx4 v[200:203], v60, s[28:31], s47 offen offset:128
    s_mov_b64 exec, -1
    s_waitcnt vmcnt(6)
    s_barrier
    s_cmp_lg_u32 s18, 0
    s_cbranch_scc1 k8_kernel_sig19
    s_mov_b64 exec, 0xff
    buffer_store_dwordx4 v[244:247], v95, s[28:31], s45 offen offset:0 sc1
    s_mov_b64 exec, -1
k8_kernel_sig19:
    s_mov_b32 s3, 0xffff0000
    s_waitcnt vmcnt(0)
    v_lshlrev_b32 v8, 16, v180
    v_and_b32 v9, s3, v180
    v_lshlrev_b32 v32, 16, v192
    v_and_b32 v33, s3, v192
    v_lshlrev_b32 v10, 16, v181
    v_and_b32 v11, s3, v181
    v_lshlrev_b32 v34, 16, v193
    v_and_b32 v35, s3, v193
    v_lshlrev_b32 v12, 16, v182
    v_and_b32 v13, s3, v182
    v_lshlrev_b32 v36, 16, v194
    v_and_b32 v37, s3, v194
    v_lshlrev_b32 v14, 16, v183
    v_and_b32 v15, s3, v183
    v_lshlrev_b32 v38, 16, v195
    v_and_b32 v39, s3, v195
    v_lshlrev_b32 v16, 16, v184
    v_and_b32 v17, s3, v184
    v_lshlrev_b32 v40, 16, v196
    v_and_b32 v41, s3, v196
    v_lshlrev_b32 v18, 16, v185
    v_and_b32 v19, s3, v185
    v_lshlrev_b32 v42, 16, v197
    v_and_b32 v43, s3, v197
    v_lshlrev_b32 v20, 16, v186
    v_and_b32 v21, s3, v186
    v_lshlrev_b32 v44, 16, v198
    v_and_b32 v45, s3, v198
    v_lshlrev_b32 v22, 16, v187
    v_and_b32 v23, s3, v187
    v_lshlrev_b32 v46, 16, v199
    v_and_b32 v47, s3, v199
    v_lshlrev_b32 v24, 16, v188
    v_and_b32 v25, s3, v188
    v_lshlrev_b32 v48, 16, v200
    v_and_b32 v49, s3, v200
    v_lshlrev_b32 v26, 16, v189
    v_and_b32 v27, s3, v189
    v_lshlrev_b32 v50, 16, v201
    v_and_b32 v51, s3, v201
    v_lshlrev_b32 v28, 16, v190
    v_and_b32 v29, s3, v190
    v_lshlrev_b32 v52, 16, v202
    v_and_b32 v53, s3, v202
    v_lshlrev_b32 v30, 16, v191
    v_and_b32 v31, s3, v191
    v_lshlrev_b32 v54, 16, v203
    v_and_b32 v55, s3, v203
    s_cmp_lg_u32 s18, 1
    s_cbranch_scc1 k8_kernel_pend20
    s_mov_b32 s3, 0
    buffer_load_dword v84, v247, s[28:31], s45 offen sc1
    s_sleep 3
    buffer_load_dword v85, v247, s[28:31], s45 offen sc1
    s_sleep 3
    buffer_load_dword v86, v247, s[28:31], s45 offen sc1
    s_sleep 3
k8_kernel_pp21:
    buffer_load_dword v87, v247, s[28:31], s45 offen sc1
    s_waitcnt vmcnt(3)
    v_cmp_ne_u32 vcc, 0, v84
    s_nop 0
    s_cmp_eq_u64 vcc, -1
    s_cbranch_scc1 k8_kernel_pend20
    s_sleep 3
    buffer_load_dword v84, v247, s[28:31], s45 offen sc1
    s_waitcnt vmcnt(3)
    v_cmp_ne_u32 vcc, 0, v85
    s_nop 0
    s_cmp_eq_u64 vcc, -1
    s_cbranch_scc1 k8_kernel_pend20
    s_sleep 3
    buffer_load_dword v85, v247, s[28:31], s45 offen sc1
    s_waitcnt vmcnt(3)
    v_cmp_ne_u32 vcc, 0, v86
    s_nop 0
    s_cmp_eq_u64 vcc, -1
    s_cbranch_scc1 k8_kernel_pend20
    s_sleep 3
    buffer_load_dword v86, v247, s[28:31], s45 offen sc1
    s_waitcnt vmcnt(3)
    v_cmp_ne_u32 vcc, 0, v87
    s_nop 0
    s_cmp_eq_u64 vcc, -1
    s_cbranch_scc1 k8_kernel_pend20
    s_sleep 3
    s_add_u32 s3, s3, 1
    s_cmp_lt_u32 s3, 0x20000
    s_cbranch_scc1 k8_kernel_pp21
k8_kernel_pend20:
    s_barrier
    s_mov_b32 s47, s46
    buffer_load_dwordx4 v[100:103], v3, s[28:31], s47 offen offset:0 sc1
    s_add_u32 s47, s47, 2359296
    buffer_load_dwordx4 v[104:107], v3, s[28:31], s47 offen offset:0 sc1
    s_add_u32 s47, s47, 2359296
    buffer_load_dwordx4 v[108:111], v3, s[28:31], s47 offen offset:0 sc1
    s_add_u32 s47, s47, 2359296
    buffer_load_dwordx4 v[112:115], v3, s[28:31], s47 offen offset:0 sc1
    s_mov_b32 s47, s46
    buffer_load_dwordx4 v[116:119], v3, s[28:31], s47 offen offset:1024 sc1
    s_add_u32 s47, s47, 2359296
    buffer_load_dwordx4 v[120:123], v3, s[28:31], s47 offen offset:1024 sc1
    s_add_u32 s47, s47, 2359296
    buffer_load_dwordx4 v[124:127], v3, s[28:31], s47 offen offset:1024 sc1
    s_add_u32 s47, s47, 2359296
    buffer_load_dwordx4 v[128:131], v3, s[28:31], s47 offen offset:1024 sc1
    s_mov_b64 exec, 0xffff
    s_mov_b32 s47, s46
    buffer_load_dwordx4 v[132:135], v3, s[28:31], s47 offen offset:2048 sc1
    s_add_u32 s47, s47, 2359296
    buffer_load_dwordx4 v[136:139], v3, s[28:31], s47 offen offset:2048 sc1
    s_add_u32 s47, s47, 2359296
    buffer_load_dwordx4 v[140:143], v3, s[28:31], s47 offen offset:2048 sc1
    s_add_u32 s47, s47, 2359296
    buffer_load_dwordx4 v[144:147], v3, s[28:31], s47 offen offset:2048 sc1
    s_mov_b64 exec, -1
    s_mov_b32 s3, 0xffff0000
    s_waitcnt vmcnt(8)
    v_lshlrev_b32 v64, 16, v100
    v_and_b32 v65, s3, v100
    v_lshlrev_b32 v66, 16, v101
    v_and_b32 v67, s3, v101
    v_lshlrev_b32 v68, 16, v102
    v_and_b32 v69, s3, v102
    v_lshlrev_b32 v70, 16, v103
    v_and_b32 v71, s3, v103
    v_lshlrev_b32 v72, 16, v104
    v_and_b32 v73, s3, v104
    v_add_f32 v64, v64, v72
    v_add_f32 v65, v65, v73
    v_lshlrev_b32 v74, 16, v105
    v_and_b32 v75, s3, v105
    v_add_f32 v66, v66, v74
    v_add_f32 v67, v67, v75
    v_lshlrev_b32 v72, 16, v106
    v_and_b32 v73, s3, v106
    v_add_f32 v68, v68, v72
    v_add_f32 v69, v69, v73
    v_lshlrev_b32 v74, 16, v107
    v_and_b32 v75, s3, v107
    v_add_f32 v70, v70, v74
    v_add_f32 v71, v71, v75
    v_lshlrev_b32 v72, 16, v108
    v_and_b32 v73, s3, v108
    v_add_f32 v64, v64, v72
    v_add_f32 v65, v65, v73
    v_lshlrev_b32 v74, 16, v109
    v_and_b32 v75, s3, v109
    v_add_f32 v66, v66, v74
    v_add_f32 v67, v67, v75
    v_lshlrev_b32 v72, 16, v110
    v_and_b32 v73, s3, v110
    v_add_f32 v68, v68, v72
    v_add_f32 v69, v69, v73
    v_lshlrev_b32 v74, 16, v111
    v_and_b32 v75, s3, v111
    v_add_f32 v70, v70, v74
    v_add_f32 v71, v71, v75
    v_lshlrev_b32 v72, 16, v112
    v_and_b32 v73, s3, v112
    v_add_f32 v64, v64, v72
    v_add_f32 v65, v65, v73
    v_lshlrev_b32 v74, 16, v113
    v_and_b32 v75, s3, v113
    v_add_f32 v66, v66, v74
    v_add_f32 v67, v67, v75
    v_lshlrev_b32 v72, 16, v114
    v_and_b32 v73, s3, v114
    v_add_f32 v68, v68, v72
    v_add_f32 v69, v69, v73
    v_lshlrev_b32 v74, 16, v115
    v_and_b32 v75, s3, v115
    v_add_f32 v70, v70, v74
    v_add_f32 v71, v71, v75
    v_fma_f32 v64, v64, v32, v8
    v_fma_f32 v65, v65, v33, v9
    v_fma_f32 v66, v66, v34, v10
    v_fma_f32 v67, v67, v35, v11
    v_fma_f32 v68, v68, v36, v12
    v_fma_f32 v69, v69, v37, v13
    v_fma_f32 v70, v70, v38, v14
    v_fma_f32 v71, v71, v39, v15
    v_cvt_pk_bf16_f32 v160, v64, v65
    v_cvt_pk_bf16_f32 v161, v66, v67
    v_cvt_pk_bf16_f32 v162, v68, v69
    v_cvt_pk_bf16_f32 v163, v70, v71
    buffer_store_dwordx4 v[160:163], v61, s[36:39], s49 offen offset:0
    s_waitcnt vmcnt(5)
    v_lshlrev_b32 v64, 16, v116
    v_and_b32 v65, s3, v116
    v_lshlrev_b32 v66, 16, v117
    v_and_b32 v67, s3, v117
    v_lshlrev_b32 v68, 16, v118
    v_and_b32 v69, s3, v118
    v_lshlrev_b32 v70, 16, v119
    v_and_b32 v71, s3, v119
    v_lshlrev_b32 v72, 16, v120
    v_and_b32 v73, s3, v120
    v_add_f32 v64, v64, v72
    v_add_f32 v65, v65, v73
    v_lshlrev_b32 v74, 16, v121
    v_and_b32 v75, s3, v121
    v_add_f32 v66, v66, v74
    v_add_f32 v67, v67, v75
    v_lshlrev_b32 v72, 16, v122
    v_and_b32 v73, s3, v122
    v_add_f32 v68, v68, v72
    v_add_f32 v69, v69, v73
    v_lshlrev_b32 v74, 16, v123
    v_and_b32 v75, s3, v123
    v_add_f32 v70, v70, v74
    v_add_f32 v71, v71, v75
    v_lshlrev_b32 v72, 16, v124
    v_and_b32 v73, s3, v124
    v_add_f32 v64, v64, v72
    v_add_f32 v65, v65, v73
    v_lshlrev_b32 v74, 16, v125
    v_and_b32 v75, s3, v125
    v_add_f32 v66, v66, v74
    v_add_f32 v67, v67, v75
    v_lshlrev_b32 v72, 16, v126
    v_and_b32 v73, s3, v126
    v_add_f32 v68, v68, v72
    v_add_f32 v69, v69, v73
    v_lshlrev_b32 v74, 16, v127
    v_and_b32 v75, s3, v127
    v_add_f32 v70, v70, v74
    v_add_f32 v71, v71, v75
    v_lshlrev_b32 v72, 16, v128
    v_and_b32 v73, s3, v128
    v_add_f32 v64, v64, v72
    v_add_f32 v65, v65, v73
    v_lshlrev_b32 v74, 16, v129
    v_and_b32 v75, s3, v129
    v_add_f32 v66, v66, v74
    v_add_f32 v67, v67, v75
    v_lshlrev_b32 v72, 16, v130
    v_and_b32 v73, s3, v130
    v_add_f32 v68, v68, v72
    v_add_f32 v69, v69, v73
    v_lshlrev_b32 v74, 16, v131
    v_and_b32 v75, s3, v131
    v_add_f32 v70, v70, v74
    v_add_f32 v71, v71, v75
    v_fma_f32 v64, v64, v40, v16
    v_fma_f32 v65, v65, v41, v17
    v_fma_f32 v66, v66, v42, v18
    v_fma_f32 v67, v67, v43, v19
    v_fma_f32 v68, v68, v44, v20
    v_fma_f32 v69, v69, v45, v21
    v_fma_f32 v70, v70, v46, v22
    v_fma_f32 v71, v71, v47, v23
    v_cvt_pk_bf16_f32 v164, v64, v65
    v_cvt_pk_bf16_f32 v165, v66, v67
    v_cvt_pk_bf16_f32 v166, v68, v69
    v_cvt_pk_bf16_f32 v167, v70, v71
    buffer_store_dwordx4 v[164:167], v61, s[36:39], s49 offen offset:64
    s_waitcnt vmcnt(2)
    s_mov_b64 exec, 0xffff
    v_lshlrev_b32 v64, 16, v132
    v_and_b32 v65, s3, v132
    v_lshlrev_b32 v66, 16, v133
    v_and_b32 v67, s3, v133
    v_lshlrev_b32 v68, 16, v134
    v_and_b32 v69, s3, v134
    v_lshlrev_b32 v70, 16, v135
    v_and_b32 v71, s3, v135
    v_lshlrev_b32 v72, 16, v136
    v_and_b32 v73, s3, v136
    v_add_f32 v64, v64, v72
    v_add_f32 v65, v65, v73
    v_lshlrev_b32 v74, 16, v137
    v_and_b32 v75, s3, v137
    v_add_f32 v66, v66, v74
    v_add_f32 v67, v67, v75
    v_lshlrev_b32 v72, 16, v138
    v_and_b32 v73, s3, v138
    v_add_f32 v68, v68, v72
    v_add_f32 v69, v69, v73
    v_lshlrev_b32 v74, 16, v139
    v_and_b32 v75, s3, v139
    v_add_f32 v70, v70, v74
    v_add_f32 v71, v71, v75
    v_lshlrev_b32 v72, 16, v140
    v_and_b32 v73, s3, v140
    v_add_f32 v64, v64, v72
    v_add_f32 v65, v65, v73
    v_lshlrev_b32 v74, 16, v141
    v_and_b32 v75, s3, v141
    v_add_f32 v66, v66, v74
    v_add_f32 v67, v67, v75
    v_lshlrev_b32 v72, 16, v142
    v_and_b32 v73, s3, v142
    v_add_f32 v68, v68, v72
    v_add_f32 v69, v69, v73
    v_lshlrev_b32 v74, 16, v143
    v_and_b32 v75, s3, v143
    v_add_f32 v70, v70, v74
    v_add_f32 v71, v71, v75
    v_lshlrev_b32 v72, 16, v144
    v_and_b32 v73, s3, v144
    v_add_f32 v64, v64, v72
    v_add_f32 v65, v65, v73
    v_lshlrev_b32 v74, 16, v145
    v_and_b32 v75, s3, v145
    v_add_f32 v66, v66, v74
    v_add_f32 v67, v67, v75
    v_lshlrev_b32 v72, 16, v146
    v_and_b32 v73, s3, v146
    v_add_f32 v68, v68, v72
    v_add_f32 v69, v69, v73
    v_lshlrev_b32 v74, 16, v147
    v_and_b32 v75, s3, v147
    v_add_f32 v70, v70, v74
    v_add_f32 v71, v71, v75
    v_fma_f32 v64, v64, v48, v24
    v_fma_f32 v65, v65, v49, v25
    v_fma_f32 v66, v66, v50, v26
    v_fma_f32 v67, v67, v51, v27
    v_fma_f32 v68, v68, v52, v28
    v_fma_f32 v69, v69, v53, v29
    v_fma_f32 v70, v70, v54, v30
    v_fma_f32 v71, v71, v55, v31
    v_cvt_pk_bf16_f32 v168, v64, v65
    v_cvt_pk_bf16_f32 v169, v66, v67
    v_cvt_pk_bf16_f32 v170, v68, v69
    v_cvt_pk_bf16_f32 v171, v70, v71
    buffer_store_dwordx4 v[168:171], v61, s[36:39], s49 offen offset:128
    s_endpgm
k8_kernel_slow8:
    s_mov_b32 s3, 0
k8_kernel_poll22:
    buffer_load_dword v1, v247, s[28:31], s44 offen offset:0 sc1
    s_add_u32 s3, s3, 1
    s_waitcnt vmcnt(0)
    v_cmp_ne_u32 vcc, 0, v1
    s_nop 0
    s_cmp_eq_u64 vcc, -1
    s_cbranch_scc1 k8_kernel_back9
    s_sleep 4
    s_cmp_lt_u32 s3, 0x40000
    s_cbranch_scc1 k8_kernel_poll22
    s_branch k8_kernel_back9
k8_kernel_slow12:
    s_mov_b32 s3, 0
k8_kernel_poll23:
    buffer_load_dword v1, v247, s[28:31], s44 offen offset:512 sc1
    s_add_u32 s3, s3, 1
    s_waitcnt vmcnt(0)
    v_cmp_ne_u32 vcc, 0, v1
    s_nop 0
    s_cmp_eq_u64 vcc, -1
    s_cbranch_scc1 k8_kernel_back13
    s_sleep 4
    s_cmp_lt_u32 s3, 0x40000
    s_cbranch_scc1 k8_kernel_poll23
    s_branch k8_kernel_back13
k8_kernel_slow15:
    s_mov_b32 s3, 0
k8_kernel_poll24:
    buffer_load_dword v1, v247, s[28:31], s44 offen offset:1024 sc1
    s_add_u32 s3, s3, 1
    s_waitcnt vmcnt(0)
    v_cmp_ne_u32 vcc, 0, v1
    s_nop 0
    s_cmp_eq_u64 vcc, -1
    s_cbranch_scc1 k8_kernel_back16
    s_sleep 4
    s_cmp_lt_u32 s3, 0x40000
    s_cbranch_scc1 k8_kernel_poll24
    s_branch k8_kernel_back16
k8_kernel_slow17:
    s_mov_b32 s3, 0
k8_kernel_poll25:
    buffer_load_dword v1, v247, s[28:31], s44 offen offset:1536 sc1
    s_add_u32 s3, s3, 1
    s_waitcnt vmcnt(0)
    v_cmp_ne_u32 vcc, 0, v1
    s_nop 0
    s_cmp_eq_u64 vcc, -1
    s_cbranch_scc1 k8_kernel_back18
    s_sleep 4
    s_cmp_lt_u32 s3, 0x40000
    s_cbranch_scc1 k8_kernel_poll25
    s_branch k8_kernel_back18
k8_end:
    s_endpgm
k8_kernel_codeend:
.section .rodata,"a"
.p2align 6
.amdhsa_kernel k8_kernel
  .amdhsa_next_free_vgpr 504
  .amdhsa_next_free_sgpr 102
  .amdhsa_accum_offset 248
  .amdhsa_group_segment_fixed_size 0
  .amdhsa_kernarg_size 104
  .amdhsa_user_sgpr_count 2
  .amdhsa_user_sgpr_kernarg_segment_ptr 1
  .amdhsa_system_sgpr_workgroup_id_x 1
.end_amdhsa_kernel
```
